```python
import torch

def _softmax(x, axis=-1):
    return torch.softmax(x, dim=axis)
def _gelu(x):
    return torch.nn.functional.gelu(x, approximate="tanh")
def _silu(x):
    return torch.nn.functional.silu(x)
def _sigmoid(x):
    return torch.sigmoid(x)
def _layernorm(x, axis=-1, eps=1e-5):
    m = x.mean(dim=axis, keepdim=True)
    v = x.var(dim=axis, keepdim=True, unbiased=False)
    return (x - m) / torch.sqrt(v + eps)
def _scatter_add(tgt, idx, src, axis=0):
    return tgt.clone().index_add_(axis, idx, src)
def _segment_sum(src, seg, n):
    out = torch.zeros((n,) + src.shape[1:], dtype=src.dtype)
    return out.index_add_(0, seg, src)
def _pad(x, pw):
    flat = tuple(v for pair in reversed(pw) for v in pair)
    return torch.nn.functional.pad(x, flat)

kernel_name = 'recurrent_scan__spectral_gfnet__glu_gated_geglu__prompt'

def setup_inputs():

    _w = (lambda a: (lambda t: t.to(torch.bfloat16) if t.is_floating_point() else t)(torch.as_tensor(a)))
    def _A_setup():
        B, S, D = 1, 2048, 640
        Df = D // 2 + 1
        return {
            "x": _w((lambda *s: torch.randn(*s, dtype=torch.bfloat16) * 0.1)(B, S, D)),
            "w_r": _w((lambda *s: torch.randn(*s, dtype=torch.bfloat16) * 3.2)(S, Df) * 0.02),
            "w_i": _w((lambda *s: torch.randn(*s, dtype=torch.bfloat16) * 3.2)(S, Df) * 0.02),
        }
    _A_in = _A_setup()

    def _B_setup():
        B, S, Dm, Df = 1, 2048, 640, 1536
        return {
            "x": _w((lambda *s: torch.randn(*s, dtype=torch.bfloat16) * 0.1)(B, S, Dm)),
            "w_gate": _w((lambda *s: torch.randn(*s, dtype=torch.bfloat16) * 0.8)(Dm, Df) * (Dm ** -0.5)),
            "w_up": _w((lambda *s: torch.randn(*s, dtype=torch.bfloat16) * 0.8)(Dm, Df) * (Dm ** -0.5)),
            "w_down": _w((lambda *s: torch.randn(*s, dtype=torch.bfloat16) * 0.8)(Df, Dm) * (Df ** -0.5)),
        }
    _B_in = _B_setup()

    return {
        "A_x": _A_in["x"],
        "A_w_r": _A_in["w_r"],
        "A_w_i": _A_in["w_i"],
        "B_x": _B_in["x"],
        "B_w_gate": _B_in["w_gate"],
        "B_w_up": _B_in["w_up"],
        "B_w_down": _B_in["w_down"],
    }

def reference(A_x, A_w_r, A_w_i, B_x, B_w_gate, B_w_up, B_w_down):
    def _A_ref(x, w_r, w_i):
        B, S, D = x.shape
        X = (lambda x, axes=(-2,-1): torch.fft.rfft2(x.float(), dim=axes))(x, axes=(-2, -1))
        W = w_r + 1j * w_i
        X = X * W
        y = (lambda x, s, axes=(-2,-1): torch.fft.irfft2(x, s=s, dim=axes).to(torch.bfloat16))(X, (S, D), axes=(-2, -1))
        return y

    def _B_ref(x, w_gate, w_up, w_down):
        g = torch.einsum("bsd,df->bsf", x, w_gate)
        u = torch.einsum("bsd,df->bsf", x, w_up)
        h = _gelu(g) * u
        return torch.einsum("bsf,fd->bsd", h, w_down)

    x = A_x
    xn = _layernorm(x, axis=-1)
    s = _A_ref(xn, A_w_r, A_w_i)
    g = _silu(_B_ref(xn, B_w_gate, B_w_up, B_w_down))
    return x + s * g
```

```asm
; @launch grid=(256,1,1) block=(512,1,1) lds=163840
.amdgcn_target "amdgcn-amd-amdhsa--gfx950"
.text
.globl recurrent_scan__spectral_gfnet__glu_gated_geglu__prompt_kernel
.p2align 8
.type recurrent_scan__spectral_gfnet__glu_gated_geglu__prompt_kernel,@function
recurrent_scan__spectral_gfnet__glu_gated_geglu__prompt_kernel:
    s_load_dwordx16 s[40:55], s[0:1], 0
    s_load_dwordx4 s[56:59], s[0:1], 64
    v_lshrrev_b32 v1, 6, v0
    v_and_b32 v0, 63, v0
    v_readfirstlane_b32 s16, v1
    s_or_b32 s97, s2, 0x8000
    s_cmp_ge_u32 s2, 256
    s_cbranch_scc1 k_done
    v_lshlrev_b32 v1, 2, v0
    v_add_u32 v1, 163584, v1
    v_mov_b32 v2, 0
    ds_write_b32 v1, v2
    s_cmp_lt_u32 s2, 64
    s_cbranch_scc1 k_f
    s_sub_u32 s34, s2, 64
    s_and_b32 s28, s2, 7
    s_lshr_b32 s29, s34, 3
    s_mul_i32 s30, s29, 43
    s_lshr_b32 s30, s30, 7
    s_mul_i32 s31, s30, 3
    s_sub_u32 s31, s29, s31
    s_lshr_b32 s17, s28, 2
    s_lshl_b32 s17, s17, 3
    s_add_u32 s17, s17, s30
    s_and_b32 s18, s28, 3
    s_mul_i32 s18, s18, 3
    s_add_u32 s18, s18, s31
    s_and_b32 s19, s16, 3
    s_cmp_lt_u32 s16, 4
    s_cbranch_scc1 k_gc
k_gl:
    v_lshrrev_b32 v30, 3, v0
    v_and_b32 v31, 3, v30
    v_lshrrev_b32 v32, 2, v30
    v_lshl_add_u32 v31, v32, 3, v31
    s_and_b32 s28, s19, 1
    s_lshl_b32 s28, s28, 4
    v_add_u32 v31, s28, v31
    s_lshr_b32 s29, s19, 1
    s_lshl_b32 s30, s17, 1
    s_add_u32 s29, s29, s30
    s_lshl_b32 s29, s29, 1
    v_lshl_add_u32 v31, v31, 6, s29
    v_mul_u32_u24 v31, 1280, v31
    v_and_b32 v32, 7, v0
    v_lshrrev_b32 v33, 4, v0
    v_xor_b32 v34, v32, v33
    v_lshl_add_u32 v10, v34, 4, v31
    v_xor_b32 v34, 4, v34
    v_lshl_add_u32 v11, v34, 4, v31
    v_add_u32 v11, 327680, v11
    v_add_u32 v12, 1280, v10
    v_add_u32 v13, 1280, v11
    v_lshrrev_b32 v30, 4, v0
    s_lshr_b32 s28, s19, 1
    s_lshl_b32 s28, s28, 2
    v_or_b32 v31, s28, v30
    v_bfe_u32 v32, v0, 1, 3
    v_xor_b32 v31, v31, v32
    v_lshlrev_b32 v31, 5, v31
    v_and_b32 v32, 1, v0
    v_lshl_add_u32 v31, v32, 4, v31
    v_mul_u32_u24 v30, 3072, v30
    v_add_u32 v20, v30, v31
    v_add_u32 v21, 24576, v20
    v_add_u32 v22, 49152, v20
    v_add_u32 v23, 73728, v20
    v_add_u32 v24, 98304, v20
    v_add_u32 v25, 122880, v20
    v_add_u32 v26, 147456, v20
    v_add_u32 v27, 172032, v20
    s_and_b32 s28, s19, 1
    s_mul_i32 s21, s28, 12288
    s_lshl_b32 s29, s18, 8
    s_add_u32 s21, s21, s29
    s_lshl_b32 s22, s19, 12
    s_lshr_b32 s23, s19, 1
    s_lshl_b32 s23, s23, 14
    s_lshl_b32 s28, s28, 10
    s_add_u32 s23, s23, s28
    s_add_u32 s23, s23, 16384
    s_mov_b32 s20, 0
    s_and_b32 s28, s17, 7
    s_mul_i32 s28, s28, 1
    s_mul_i32 s29, s18, 86
    s_lshr_b32 s29, s29, 8
    s_mul_i32 s29, s29, 3
    s_sub_u32 s29, s18, s29
    s_mul_i32 s29, s29, 0
    s_add_u32 s28, s28, s29
    s_mul_i32 s29, s28, 6554
    s_lshr_b32 s29, s29, 16
    s_mul_i32 s29, s29, 10
    s_sub_u32 s28, s28, s29
    s_mul_i32 s28, s28, 1
    s_lshl_b32 s20, s28, 7
    s_mul_i32 s28, s28, 196608
    s_add_u32 s21, s21, s28
    s_waitcnt lgkmcnt(0)
    s_mov_b32 s12, s58
    s_mov_b32 s13, s59
    s_mov_b32 s14, 268435456
    s_mov_b32 s15, 0x20000
    s_mov_b32 s4, s40
    s_mov_b32 s5, s41
    s_mov_b32 s6, 2621440
    s_mov_b32 s7, 0x20000
    s_cmp_lt_u32 s19, 2
    s_cselect_b32 s8, s48, s50
    s_cselect_b32 s9, s49, s51
    s_mov_b32 s10, 1966080
    s_mov_b32 s11, 0x20000
    s_add_u32 m0, s22, 0
    s_nop 0
    buffer_load_dwordx4 v10, s[4:7], s20 offen lds
    s_add_u32 m0, s22, 1024
    s_nop 0
    buffer_load_dwordx4 v11, s[4:7], s20 offen lds
    s_add_u32 m0, s22, 2048
    s_nop 0
    buffer_load_dwordx4 v12, s[4:7], s20 offen lds
    s_add_u32 m0, s22, 3072
    s_nop 0
    buffer_load_dwordx4 v13, s[4:7], s20 offen lds
    s_add_u32 m0, s23, 0
    s_nop 0
    buffer_load_dwordx4 v20, s[8:11], s21 offen lds
    s_add_u32 m0, s23, 2048
    s_nop 0
    buffer_load_dwordx4 v21, s[8:11], s21 offen lds
    s_add_u32 m0, s23, 4096
    s_nop 0
    buffer_load_dwordx4 v22, s[8:11], s21 offen lds
    s_add_u32 m0, s23, 6144
    s_nop 0
    buffer_load_dwordx4 v23, s[8:11], s21 offen lds
    s_add_u32 m0, s23, 8192
    s_nop 0
    buffer_load_dwordx4 v24, s[8:11], s21 offen lds
    s_add_u32 m0, s23, 10240
    s_nop 0
    buffer_load_dwordx4 v25, s[8:11], s21 offen lds
    s_waitcnt vmcnt(4)
    s_barrier
    s_add_u32 m0, s23, 12288
    s_nop 0
    buffer_load_dwordx4 v26, s[8:11], s21 offen lds
    s_add_u32 m0, s23, 14336
    s_nop 0
    buffer_load_dwordx4 v27, s[8:11], s21 offen lds
    s_add_u32 s20, s20, 128
    s_add_u32 s21, s21, 196608
    s_cmp_eq_u32 s20, 1280
    s_cselect_b32 s20, 0, s20
    s_cselect_b32 s28, 1966080, 0
    s_sub_u32 s21, s21, s28
    s_waitcnt vmcnt(4)
    s_barrier
    s_add_u32 m0, s22, 49152
    s_nop 0
    buffer_load_dwordx4 v10, s[4:7], s20 offen lds
    s_add_u32 m0, s22, 50176
    s_nop 0
    buffer_load_dwordx4 v11, s[4:7], s20 offen lds
    s_add_u32 m0, s22, 51200
    s_nop 0
    buffer_load_dwordx4 v12, s[4:7], s20 offen lds
    s_add_u32 m0, s22, 52224
    s_nop 0
    buffer_load_dwordx4 v13, s[4:7], s20 offen lds
    s_waitcnt vmcnt(6)
    s_barrier
    s_add_u32 m0, s23, 49152
    s_nop 0
    buffer_load_dwordx4 v20, s[8:11], s21 offen lds
    s_add_u32 m0, s23, 51200
    s_nop 0
    buffer_load_dwordx4 v21, s[8:11], s21 offen lds
    s_add_u32 m0, s23, 53248
    s_nop 0
    buffer_load_dwordx4 v22, s[8:11], s21 offen lds
    s_waitcnt vmcnt(7)
    s_barrier
    s_add_u32 m0, s23, 55296
    s_nop 0
    buffer_load_dwordx4 v23, s[8:11], s21 offen lds
    s_add_u32 m0, s23, 57344
    s_nop 0
    buffer_load_dwordx4 v24, s[8:11], s21 offen lds
    s_add_u32 m0, s23, 59392
    s_nop 0
    buffer_load_dwordx4 v25, s[8:11], s21 offen lds
    s_add_u32 m0, s23, 61440
    s_nop 0
    buffer_load_dwordx4 v26, s[8:11], s21 offen lds
    s_add_u32 m0, s23, 63488
    s_nop 0
    buffer_load_dwordx4 v27, s[8:11], s21 offen lds
    s_add_u32 s20, s20, 128
    s_add_u32 s21, s21, 196608
    s_cmp_eq_u32 s20, 1280
    s_cselect_b32 s20, 0, s20
    s_cselect_b32 s28, 1966080, 0
    s_sub_u32 s21, s21, s28
    s_mov_b32 s36, s52
    s_mov_b32 s37, s53
    s_mov_b32 s38, 1966080
    s_mov_b32 s39, 0x20000
    s_lshr_b32 s35, s34, 3
    s_lshl_b32 s35, s35, 2
    s_add_u32 s35, s35, s19
    s_mul_i32 s35, s35, 5120
    s_and_b32 s28, s2, 1
    s_mul_i32 s28, s28, 983040
    s_add_u32 s35, s35, s28
    v_lshlrev_b32 v44, 7, v0
    v_mov_b32 v45, 0x40000000
    v_cmp_gt_u32 vcc, 40, v0
    s_nop 1
    v_cndmask_b32 v44, v45, v44, vcc
    s_add_u32 m0, s22, 98304
    s_nop 0
    buffer_load_dwordx4 v10, s[4:7], s20 offen lds
    s_add_u32 m0, s22, 99328
    s_nop 0
    buffer_load_dwordx4 v11, s[4:7], s20 offen lds
    s_add_u32 m0, s22, 100352
    s_nop 0
    buffer_load_dwordx4 v12, s[4:7], s20 offen lds
    s_add_u32 m0, s22, 101376
    s_nop 0
    buffer_load_dwordx4 v13, s[4:7], s20 offen lds
    v_lshrrev_b32 v56, 4, v0
    v_mul_u32_u24 v56, 3072, v56
    v_and_b32 v57, 15, v0
    v_lshl_add_u32 v56, v57, 4, v56
    s_lshl_b32 s28, s17, 1
    s_and_b32 s29, s19, 1
    s_add_u32 s28, s28, s29
    s_mul_i32 s28, s28, 61440
    s_lshl_b32 s29, s18, 8
    s_add_u32 s28, s28, s29
    buffer_load_dwordx4 v[64:67], v56, s[8:11], s28 offen
    s_add_u32 s28, s28, 12288
    buffer_load_dwordx4 v[68:71], v56, s[8:11], s28 offen
    s_add_u32 s28, s28, 12288
    buffer_load_dwordx4 v[72:75], v56, s[8:11], s28 offen
    s_add_u32 s28, s28, 12288
    buffer_load_dwordx4 v[76:79], v56, s[8:11], s28 offen
    s_add_u32 s28, s28, 12288
    buffer_load_dwordx4 v[80:83], v56, s[8:11], s28 offen
    s_add_u32 s28, s28, 12288
    v_and_b32 v58, 1, v0
    v_lshlrev_b32 v58, 4, v58
    v_mov_b32 v59, 0x3f80
    v_lshlrev_b32 v58, v58, v59
    v_lshrrev_b32 v59, 1, v57
    v_cmp_eq_u32 vcc, 0, v59
    s_nop 1
    v_cndmask_b32 v60, 0, v58, vcc
    v_cmp_eq_u32 vcc, 1, v59
    s_nop 1
    v_cndmask_b32 v61, 0, v58, vcc
    v_cmp_eq_u32 vcc, 2, v59
    s_nop 1
    v_cndmask_b32 v62, 0, v58, vcc
    v_cmp_eq_u32 vcc, 3, v59
    s_nop 1
    v_cndmask_b32 v63, 0, v58, vcc
    s_waitcnt vmcnt(9)
    s_barrier
    s_add_u32 m0, s23, 98304
    s_nop 0
    buffer_load_dwordx4 v20, s[8:11], s21 offen lds
    s_add_u32 m0, s23, 100352
    s_nop 0
    buffer_load_dwordx4 v21, s[8:11], s21 offen lds
    s_add_u32 m0, s23, 102400
    s_nop 0
    buffer_load_dwordx4 v22, s[8:11], s21 offen lds
    s_add_u32 m0, s23, 104448
    s_nop 0
    buffer_load_dwordx4 v23, s[8:11], s21 offen lds
    s_add_u32 m0, s23, 106496
    s_nop 0
    buffer_load_dwordx4 v24, s[8:11], s21 offen lds
    s_add_u32 m0, s23, 108544
    s_nop 0
    buffer_load_dwordx4 v25, s[8:11], s21 offen lds
    s_add_u32 m0, s23, 110592
    s_nop 0
    buffer_load_dwordx4 v26, s[8:11], s21 offen lds
    s_add_u32 m0, s23, 112640
    s_nop 0
    buffer_load_dwordx4 v27, s[8:11], s21 offen lds
    s_add_u32 s20, s20, 128
    s_add_u32 s21, s21, 196608
    s_cmp_eq_u32 s20, 1280
    s_cselect_b32 s20, 0, s20
    s_cselect_b32 s28, 1966080, 0
    s_sub_u32 s21, s21, s28
    s_add_u32 m0, s22, 0
    s_nop 0
    buffer_load_dwordx4 v10, s[4:7], s20 offen lds
    s_add_u32 m0, s22, 1024
    s_nop 0
    buffer_load_dwordx4 v11, s[4:7], s20 offen lds
    s_add_u32 m0, s22, 2048
    s_nop 0
    buffer_load_dwordx4 v12, s[4:7], s20 offen lds
    s_add_u32 m0, s22, 3072
    s_nop 0
    buffer_load_dwordx4 v13, s[4:7], s20 offen lds
    s_add_u32 m0, s23, 0
    s_nop 0
    buffer_load_dwordx4 v20, s[8:11], s21 offen lds
    s_add_u32 m0, s23, 2048
    s_nop 0
    buffer_load_dwordx4 v21, s[8:11], s21 offen lds
    s_lshl_b32 s28, s19, 10
    s_add_u32 s28, s28, 155648
    v_lshl_add_u32 v57, v0, 4, s28
    s_waitcnt vmcnt(14)
    v_mfma_f32_16x16x32_bf16 v[84:87], v[60:63], v[64:67], 0
    v_mfma_f32_16x16x32_bf16 v[84:87], v[60:63], v[68:71], v[84:87]
    v_mfma_f32_16x16x32_bf16 v[84:87], v[60:63], v[72:75], v[84:87]
    v_mfma_f32_16x16x32_bf16 v[84:87], v[60:63], v[76:79], v[84:87]
    v_mfma_f32_16x16x32_bf16 v[84:87], v[60:63], v[80:83], v[84:87]
    s_nop 7
    ds_write_b128 v57, v[84:87]
    s_waitcnt lgkmcnt(0)
    v_mov_b32 v41, 0
    global_load_dword v42, v41, s[56:57] offset:128 sc1
    s_waitcnt vmcnt(7)
    s_barrier
    ds_read_b128 v[64:67], v57 offset:1024
    s_lshl_b32 s28, s18, 1
    s_lshr_b32 s29, s19, 1
    s_add_u32 s28, s28, s29
    s_lshl_b32 s26, s28, 12
    s_add_u32 s26, s26, 29392896
    s_lshl_b32 s28, s17, 8
    s_add_u32 s28, s28, s26
    s_bitcmp1_b32 s19, 0
    s_cselect_b32 s28, 0x40000000, s28
    v_and_b32 v56, 15, v0
    v_lshlrev_b32 v56, 4, v56
    v_lshrrev_b32 v58, 4, v0
    v_lshl_add_u32 v56, v58, 3, v56
    v_lshrrev_b32 v58, 5, v0
    v_lshl_or_b32 v56, v58, 29, v56
    s_waitcnt lgkmcnt(0)
    v_add_f32 v84, v84, v64
    v_add_f32 v85, v85, v65
    v_add_f32 v86, v86, v66
    v_add_f32 v87, v87, v67
    v_cvt_pk_bf16_f32 v84, v84, v85
    v_cvt_pk_bf16_f32 v85, v86, v87
    buffer_store_dwordx2 v[84:85], v56, s[12:15], s28 offen sc0 sc1
    s_add_u32 m0, s23, 4096
    s_nop 0
    buffer_load_dwordx4 v22, s[8:11], s21 offen lds
    s_add_u32 m0, s23, 6144
    s_nop 0
    buffer_load_dwordx4 v23, s[8:11], s21 offen lds
    s_add_u32 m0, s23, 8192
    s_nop 0
    buffer_load_dwordx4 v24, s[8:11], s21 offen lds
    s_add_u32 m0, s23, 10240
    s_nop 0
    buffer_load_dwordx4 v25, s[8:11], s21 offen lds
    s_add_u32 m0, s23, 12288
    s_nop 0
    buffer_load_dwordx4 v26, s[8:11], s21 offen lds
    s_add_u32 m0, s23, 14336
    s_nop 0
    buffer_load_dwordx4 v27, s[8:11], s21 offen lds
    s_add_u32 s20, s20, 128
    s_add_u32 s21, s21, 196608
    s_cmp_eq_u32 s20, 1280
    s_cselect_b32 s20, 0, s20
    s_cselect_b32 s28, 1966080, 0
    s_sub_u32 s21, s21, s28
    s_add_u32 m0, s22, 49152
    s_nop 0
    buffer_load_dwordx4 v10, s[4:7], s20 offen lds
    s_add_u32 m0, s22, 50176
    s_nop 0
    buffer_load_dwordx4 v11, s[4:7], s20 offen lds
    s_add_u32 m0, s22, 51200
    s_nop 0
    buffer_load_dwordx4 v12, s[4:7], s20 offen lds
    s_add_u32 m0, s22, 52224
    s_nop 0
    buffer_load_dwordx4 v13, s[4:7], s20 offen lds
    s_add_u32 m0, s23, 49152
    s_nop 0
    buffer_load_dwordx4 v20, s[8:11], s21 offen lds
    s_add_u32 m0, s23, 51200
    s_nop 0
    buffer_load_dwordx4 v21, s[8:11], s21 offen lds
    s_add_u32 m0, s23, 53248
    s_nop 0
    buffer_load_dwordx4 v22, s[8:11], s21 offen lds
    s_add_u32 m0, s23, 55296
    s_nop 0
    buffer_load_dwordx4 v23, s[8:11], s21 offen lds
    s_add_u32 m0, s23, 57344
    s_nop 0
    buffer_load_dwordx4 v24, s[8:11], s21 offen lds
    s_add_u32 m0, s23, 59392
    s_nop 0
    buffer_load_dwordx4 v25, s[8:11], s21 offen lds
    s_add_u32 m0, s23, 61440
    s_nop 0
    buffer_load_dwordx4 v26, s[8:11], s21 offen lds
    s_add_u32 m0, s23, 63488
    s_nop 0
    buffer_load_dwordx4 v27, s[8:11], s21 offen lds
    s_add_u32 s20, s20, 128
    s_add_u32 s21, s21, 196608
    s_cmp_eq_u32 s20, 1280
    s_cselect_b32 s20, 0, s20
    s_cselect_b32 s28, 1966080, 0
    s_sub_u32 s21, s21, s28
    s_waitcnt vmcnt(12)
    s_barrier
    s_add_u32 m0, s22, 98304
    s_nop 0
    buffer_load_dwordx4 v10, s[4:7], s20 offen lds
    s_add_u32 m0, s22, 99328
    s_nop 0
    buffer_load_dwordx4 v11, s[4:7], s20 offen lds
    s_add_u32 m0, s22, 100352
    s_nop 0
    buffer_load_dwordx4 v12, s[4:7], s20 offen lds
    s_add_u32 m0, s22, 101376
    s_nop 0
    buffer_load_dwordx4 v13, s[4:7], s20 offen lds
    s_add_u32 m0, s23, 98304
    s_nop 0
    buffer_load_dwordx4 v20, s[8:11], s21 offen lds
    s_add_u32 m0, s23, 100352
    s_nop 0
    buffer_load_dwordx4 v21, s[8:11], s21 offen lds
    s_add_u32 m0, s23, 102400
    s_nop 0
    buffer_load_dwordx4 v22, s[8:11], s21 offen lds
    s_add_u32 m0, s23, 104448
    s_nop 0
    buffer_load_dwordx4 v23, s[8:11], s21 offen lds
    s_add_u32 m0, s23, 106496
    s_nop 0
    buffer_load_dwordx4 v24, s[8:11], s21 offen lds
    s_add_u32 m0, s23, 108544
    s_nop 0
    buffer_load_dwordx4 v25, s[8:11], s21 offen lds
    s_add_u32 m0, s23, 110592
    s_nop 0
    buffer_load_dwordx4 v26, s[8:11], s21 offen lds
    s_add_u32 m0, s23, 112640
    s_nop 0
    buffer_load_dwordx4 v27, s[8:11], s21 offen lds
    s_add_u32 s20, s20, 128
    s_add_u32 s21, s21, 196608
    s_cmp_eq_u32 s20, 1280
    s_cselect_b32 s20, 0, s20
    s_cselect_b32 s28, 1966080, 0
    s_sub_u32 s21, s21, s28
    s_waitcnt vmcnt(12)
    s_waitcnt vmcnt(12)
    v_cmp_eq_u32 vcc, 0, v42
    s_cbranch_vccnz k_clr1
k_clr1_back:
    s_lshl_b32 s27, s18, 7
    s_add_u32 s27, s27, 29551616
    s_mov_b32 s28, 1
    s_bitcmp1_b32 s19, 0
    s_cbranch_scc1 k_nocss
    s_atomic_add s28, s[58:59], s27
k_nocss:
    s_barrier
    s_add_u32 m0, s22, 0
    s_nop 0
    buffer_load_dwordx4 v10, s[4:7], s20 offen lds
    s_add_u32 m0, s22, 1024
    s_nop 0
    buffer_load_dwordx4 v11, s[4:7], s20 offen lds
    s_add_u32 m0, s22, 2048
    s_nop 0
    buffer_load_dwordx4 v12, s[4:7], s20 offen lds
    s_add_u32 m0, s22, 3072
    s_nop 0
    buffer_load_dwordx4 v13, s[4:7], s20 offen lds
    s_add_u32 m0, s23, 0
    s_nop 0
    buffer_load_dwordx4 v20, s[8:11], s21 offen lds
    s_add_u32 m0, s23, 2048
    s_nop 0
    buffer_load_dwordx4 v21, s[8:11], s21 offen lds
    s_add_u32 m0, s23, 4096
    s_nop 0
    buffer_load_dwordx4 v22, s[8:11], s21 offen lds
    s_add_u32 m0, s23, 6144
    s_nop 0
    buffer_load_dwordx4 v23, s[8:11], s21 offen lds
    s_add_u32 m0, s23, 8192
    s_nop 0
    buffer_load_dwordx4 v24, s[8:11], s21 offen lds
    s_add_u32 m0, s23, 10240
    s_nop 0
    buffer_load_dwordx4 v25, s[8:11], s21 offen lds
    s_add_u32 m0, s23, 12288
    s_nop 0
    buffer_load_dwordx4 v26, s[8:11], s21 offen lds
    s_add_u32 m0, s23, 14336
    s_nop 0
    buffer_load_dwordx4 v27, s[8:11], s21 offen lds
    s_add_u32 s20, s20, 128
    s_add_u32 s21, s21, 196608
    s_cmp_eq_u32 s20, 1280
    s_cselect_b32 s20, 0, s20
    s_cselect_b32 s28, 1966080, 0
    s_sub_u32 s21, s21, s28
    s_waitcnt vmcnt(12)
    s_barrier
    s_add_u32 m0, s22, 49152
    s_nop 0
    buffer_load_dwordx4 v10, s[4:7], s20 offen lds
    s_add_u32 m0, s22, 50176
    s_nop 0
    buffer_load_dwordx4 v11, s[4:7], s20 offen lds
    s_add_u32 m0, s22, 51200
    s_nop 0
    buffer_load_dwordx4 v12, s[4:7], s20 offen lds
    s_add_u32 m0, s22, 52224
    s_nop 0
    buffer_load_dwordx4 v13, s[4:7], s20 offen lds
    s_add_u32 m0, s23, 49152
    s_nop 0
    buffer_load_dwordx4 v20, s[8:11], s21 offen lds
    s_add_u32 m0, s23, 51200
    s_nop 0
    buffer_load_dwordx4 v21, s[8:11], s21 offen lds
    s_add_u32 m0, s23, 53248
    s_nop 0
    buffer_load_dwordx4 v22, s[8:11], s21 offen lds
    s_add_u32 m0, s23, 55296
    s_nop 0
    buffer_load_dwordx4 v23, s[8:11], s21 offen lds
    s_add_u32 m0, s23, 57344
    s_nop 0
    buffer_load_dwordx4 v24, s[8:11], s21 offen lds
    s_add_u32 m0, s23, 59392
    s_nop 0
    buffer_load_dwordx4 v25, s[8:11], s21 offen lds
    s_add_u32 m0, s23, 61440
    s_nop 0
    buffer_load_dwordx4 v26, s[8:11], s21 offen lds
    s_add_u32 m0, s23, 63488
    s_nop 0
    buffer_load_dwordx4 v27, s[8:11], s21 offen lds
    s_add_u32 s20, s20, 128
    s_add_u32 s21, s21, 196608
    s_cmp_eq_u32 s20, 1280
    s_cselect_b32 s20, 0, s20
    s_cselect_b32 s28, 1966080, 0
    s_sub_u32 s21, s21, s28
    s_waitcnt vmcnt(12)
    s_barrier
    s_add_u32 m0, s22, 98304
    s_nop 0
    buffer_load_dwordx4 v10, s[4:7], s20 offen lds
    s_add_u32 m0, s22, 99328
    s_nop 0
    buffer_load_dwordx4 v11, s[4:7], s20 offen lds
    s_add_u32 m0, s22, 100352
    s_nop 0
    buffer_load_dwordx4 v12, s[4:7], s20 offen lds
    s_add_u32 m0, s22, 101376
    s_nop 0
    buffer_load_dwordx4 v13, s[4:7], s20 offen lds
    s_add_u32 m0, s23, 98304
    s_nop 0
    buffer_load_dwordx4 v20, s[8:11], s21 offen lds
    s_add_u32 m0, s23, 100352
    s_nop 0
    buffer_load_dwordx4 v21, s[8:11], s21 offen lds
    s_add_u32 m0, s23, 102400
    s_nop 0
    buffer_load_dwordx4 v22, s[8:11], s21 offen lds
    s_add_u32 m0, s23, 104448
    s_nop 0
    buffer_load_dwordx4 v23, s[8:11], s21 offen lds
    s_add_u32 m0, s23, 106496
    s_nop 0
    buffer_load_dwordx4 v24, s[8:11], s21 offen lds
    s_add_u32 m0, s23, 108544
    s_nop 0
    buffer_load_dwordx4 v25, s[8:11], s21 offen lds
    s_add_u32 m0, s23, 110592
    s_nop 0
    buffer_load_dwordx4 v26, s[8:11], s21 offen lds
    s_add_u32 m0, s23, 112640
    s_nop 0
    buffer_load_dwordx4 v27, s[8:11], s21 offen lds
    s_add_u32 s20, s20, 128
    s_add_u32 s21, s21, 196608
    s_cmp_eq_u32 s20, 1280
    s_cselect_b32 s20, 0, s20
    s_cselect_b32 s28, 1966080, 0
    s_sub_u32 s21, s21, s28
    v_mov_b32 v43, 32
    buffer_load_dword v42, v41, s[12:15], s27 offen sc1
    s_waitcnt vmcnt(13)
    s_barrier
    s_add_u32 m0, s22, 0
    s_nop 0
    buffer_load_dwordx4 v10, s[4:7], s20 offen lds
    s_add_u32 m0, s22, 1024
    s_nop 0
    buffer_load_dwordx4 v11, s[4:7], s20 offen lds
    s_add_u32 m0, s22, 2048
    s_nop 0
    buffer_load_dwordx4 v12, s[4:7], s20 offen lds
    s_add_u32 m0, s22, 3072
    s_nop 0
    buffer_load_dwordx4 v13, s[4:7], s20 offen lds
    s_add_u32 m0, s23, 0
    s_nop 0
    buffer_load_dwordx4 v20, s[8:11], s21 offen lds
    s_add_u32 m0, s23, 2048
    s_nop 0
    buffer_load_dwordx4 v21, s[8:11], s21 offen lds
    s_add_u32 m0, s23, 4096
    s_nop 0
    buffer_load_dwordx4 v22, s[8:11], s21 offen lds
    s_add_u32 m0, s23, 6144
    s_nop 0
    buffer_load_dwordx4 v23, s[8:11], s21 offen lds
    s_add_u32 m0, s23, 8192
    s_nop 0
    buffer_load_dwordx4 v24, s[8:11], s21 offen lds
    s_add_u32 m0, s23, 10240
    s_nop 0
    buffer_load_dwordx4 v25, s[8:11], s21 offen lds
    s_add_u32 m0, s23, 12288
    s_nop 0
    buffer_load_dwordx4 v26, s[8:11], s21 offen lds
    s_add_u32 m0, s23, 14336
    s_nop 0
    buffer_load_dwordx4 v27, s[8:11], s21 offen lds
    s_add_u32 s20, s20, 128
    s_add_u32 s21, s21, 196608
    s_cmp_eq_u32 s20, 1280
    s_cselect_b32 s20, 0, s20
    s_cselect_b32 s28, 1966080, 0
    s_sub_u32 s21, s21, s28
    s_waitcnt vmcnt(13)
    s_waitcnt vmcnt(12)
    v_cmp_ne_u32 vcc, v43, v42
    s_cbranch_vccnz k_csq
k_csq_back:
    v_lshrrev_b32 v56, 4, v0
    v_mul_u32_u24 v57, 2816, v56
    v_sub_u32 v56, v20, v57
    s_and_b32 s28, s19, 1
    s_lshl_b32 s28, s28, 11
    s_add_u32 s26, s26, s28
    s_lshl_b32 s28, s19, 11
    s_add_u32 s28, s28, 147456
    s_add_u32 m0, s28, 0
    s_nop 0
    buffer_load_dwordx4 v56, s[12:15], s26 offen lds
    s_add_u32 s26, s26, 1024
    s_add_u32 m0, s28, 1024
    s_nop 0
    buffer_load_dwordx4 v56, s[12:15], s26 offen lds
    s_add_u32 s26, s26, 1024
    s_barrier
    s_and_b32 s29, s2, 7
    s_lshl_b32 s29, s29, 7
    s_add_u32 s29, s29, 29509632
    v_mov_b32 v43, 64
    buffer_load_dword v42, v41, s[12:15], s29 offen sc1
    buffer_load_dword v40, v44, s[36:39], s35 offen
    s_add_u32 s35, s35, 491520
    s_waitcnt vmcnt(4)
    s_waitcnt vmcnt(1)
    v_cmp_ne_u32 vcc, v43, v42
    s_cbranch_vccnz k_aux
k_aux_back:
    s_barrier
    buffer_load_dword v40, v44, s[36:39], s35 offen
    s_add_u32 s35, s35, 491520
    s_branch k_p2f
k_gc:
    s_getpc_b64 s[30:31]
k_pf1:
    s_sub_u32 s30, s30, k_pf1-recurrent_scan__spectral_gfnet__glu_gated_geglu__prompt_kernel
    s_subb_u32 s31, s31, 0
    s_lshr_b32 s28, s34, 3
    s_lshl_b32 s28, s28, 2
    s_add_u32 s28, s28, s19
    s_mul_i32 s28, s28, 1152
    v_min_u32 v20, 8, v0
    v_lshl_add_u32 v20, v20, 7, s28
    v_min_u32 v20, k_end-recurrent_scan__spectral_gfnet__glu_gated_geglu__prompt_kernel-4, v20
    global_load_dword v21, v20, s[30:31]
    v_and_b32 v30, 31, v0
    s_lshr_b32 s28, s19, 1
    s_lshl_b32 s28, s28, 13
    v_lshl_add_u32 v31, v30, 7, s28
    v_bfe_u32 v32, v0, 1, 3
    v_lshrrev_b32 v33, 5, v0
    v_xor_b32 v32, v32, v33
    v_xor_b32 v33, 0, v32
    v_lshl_add_u32 v2, v33, 4, v31
    v_xor_b32 v33, 2, v32
    v_lshl_add_u32 v3, v33, 4, v31
    v_xor_b32 v33, 4, v32
    v_lshl_add_u32 v4, v33, 4, v31
    v_xor_b32 v33, 6, v32
    v_lshl_add_u32 v5, v33, 4, v31
    v_bfe_u32 v30, v0, 4, 1
    v_bfe_u32 v31, v0, 2, 2
    v_lshrrev_b32 v32, 5, v0
    v_lshl_add_u32 v33, v32, 3, v31
    v_lshlrev_b32 v33, 8, v33
    v_lshl_add_u32 v33, v30, 14, v33
    v_and_b32 v34, 3, v0
    v_lshl_add_u32 v33, v34, 3, v33
    v_add_u32 v33, 16384, v33
    v_lshl_add_u32 v31, v30, 2, v31
    s_and_b32 s28, s19, 1
    s_lshl_b32 s28, s28, 2
    v_xor_b32 v31, s28, v31
    v_xor_b32 v34, 0, v31
    v_lshl_add_u32 v6, v34, 5, v33
    v_xor_b32 v34, 1, v31
    v_lshl_add_u32 v7, v34, 5, v33
    v_xor_b32 v34, 2, v31
    v_lshl_add_u32 v8, v34, 5, v33
    v_xor_b32 v34, 3, v31
    v_lshl_add_u32 v9, v34, 5, v33
    s_lshl_b32 s28, s19, 2
    s_add_u32 s28, s28, 163728
    v_mov_b32 v11, s28
    v_and_b32 v10, 3, v0
    v_lshlrev_b32 v10, 2, v10
    v_add_u32 v10, 163712, v10
    v_bfe_u32 v30, v0, 4, 1
    v_mul_u32_u24 v30, 50176, v30
    v_lshrrev_b32 v31, 5, v0
    v_lshl_add_u32 v30, v31, 8, v30
    v_and_b32 v31, 15, v0
    v_lshl_add_u32 v13, v31, 4, v30
    v_and_b32 v30, 31, v0
    v_lshlrev_b32 v15, 3, v30
    v_lshlrev_b32 v14, 2, v30
    s_lshl_b32 s26, s18, 1
    s_and_b32 s29, s19, 1
    s_add_u32 s26, s26, s29
    s_lshl_b32 s26, s26, 9
    s_add_u32 s26, s26, 29392896
    s_lshl_b32 s27, s17, 1
    s_lshr_b32 s30, s19, 1
    s_add_u32 s27, s27, s30
    s_lshl_b32 s27, s27, 9
    s_add_u32 s27, s27, 29360128
    s_mov_b32 s32, 49152
    s_mov_b32 s33, -98304
    s_mov_b32 s24, 0
    s_mov_b32 s29, 0
    s_waitcnt lgkmcnt(0)
    s_mov_b32 s12, s58
    s_mov_b32 s13, s59
    s_mov_b32 s14, 268435456
    s_mov_b32 s15, 0x20000
    s_setprio 2
    s_barrier
    ds_read_b128 v[64:67], v2 offset:0
    ds_read_b64_tr_b16 v[72:73], v6 offset:0
    ds_read_b64_tr_b16 v[74:75], v6 offset:1024
    ds_read_b128 v[68:71], v2 offset:4096
    ds_read_b64_tr_b16 v[76:77], v7 offset:0
    ds_read_b64_tr_b16 v[78:79], v7 offset:1024
    ds_read_b64_tr_b16 v[80:81], v8 offset:0
    ds_read_b64_tr_b16 v[82:83], v8 offset:1024
    ds_read_b64_tr_b16 v[84:85], v9 offset:0
    ds_read_b64_tr_b16 v[86:87], v9 offset:1024
    s_waitcnt lgkmcnt(0)
    s_barrier
    v_mfma_f32_32x32x16_bf16 v[128:143], v[72:75], v[64:67], 0
    ds_read_b128 v[88:91], v3 offset:0
    ds_read_b64_tr_b16 v[96:97], v6 offset:4096
    v_mfma_f32_32x32x16_bf16 v[192:207], v[72:75], v[68:71], 0
    ds_read_b64_tr_b16 v[98:99], v6 offset:5120
    ds_read_b128 v[92:95], v3 offset:4096
    v_mfma_f32_32x32x16_bf16 v[144:159], v[76:79], v[64:67], 0
    ds_read_b64_tr_b16 v[100:101], v7 offset:4096
    ds_read_b64_tr_b16 v[102:103], v7 offset:5120
    v_mfma_f32_32x32x16_bf16 v[208:223], v[76:79], v[68:71], 0
    ds_read_b64_tr_b16 v[104:105], v8 offset:4096
    ds_read_b64_tr_b16 v[106:107], v8 offset:5120
    v_mfma_f32_32x32x16_bf16 v[160:175], v[80:83], v[64:67], 0
    ds_read_b64_tr_b16 v[108:109], v9 offset:4096
    ds_read_b64_tr_b16 v[110:111], v9 offset:5120
    v_mfma_f32_32x32x16_bf16 v[224:239], v[80:83], v[68:71], 0
    v_mfma_f32_32x32x16_bf16 v[176:191], v[84:87], v[64:67], 0
    v_mfma_f32_32x32x16_bf16 v[240:255], v[84:87], v[68:71], 0
    s_waitcnt lgkmcnt(0)
    s_barrier
    v_mfma_f32_32x32x16_bf16 v[128:143], v[96:99], v[88:91], v[128:143]
    ds_read_b128 v[64:67], v4 offset:0
    ds_read_b64_tr_b16 v[72:73], v6 offset:8192
    v_mfma_f32_32x32x16_bf16 v[192:207], v[96:99], v[92:95], v[192:207]
    ds_read_b64_tr_b16 v[74:75], v6 offset:9216
    ds_read_b128 v[68:71], v4 offset:4096
    v_mfma_f32_32x32x16_bf16 v[144:159], v[100:103], v[88:91], v[144:159]
    ds_read_b64_tr_b16 v[76:77], v7 offset:8192
    ds_read_b64_tr_b16 v[78:79], v7 offset:9216
    v_mfma_f32_32x32x16_bf16 v[208:223], v[100:103], v[92:95], v[208:223]
    ds_read_b64_tr_b16 v[80:81], v8 offset:8192
    ds_read_b64_tr_b16 v[82:83], v8 offset:9216
    v_mfma_f32_32x32x16_bf16 v[160:175], v[104:107], v[88:91], v[160:175]
    ds_read_b64_tr_b16 v[84:85], v9 offset:8192
    ds_read_b64_tr_b16 v[86:87], v9 offset:9216
    v_mfma_f32_32x32x16_bf16 v[224:239], v[104:107], v[92:95], v[224:239]
    v_mfma_f32_32x32x16_bf16 v[176:191], v[108:111], v[88:91], v[176:191]
    v_mfma_f32_32x32x16_bf16 v[240:255], v[108:111], v[92:95], v[240:255]
    s_waitcnt lgkmcnt(0)
    s_barrier
    v_mfma_f32_32x32x16_bf16 v[128:143], v[72:75], v[64:67], v[128:143]
    ds_read_b128 v[88:91], v5 offset:0
    ds_read_b64_tr_b16 v[96:97], v6 offset:12288
    v_mfma_f32_32x32x16_bf16 v[192:207], v[72:75], v[68:71], v[192:207]
    ds_read_b64_tr_b16 v[98:99], v6 offset:13312
    ds_read_b128 v[92:95], v5 offset:4096
    v_mfma_f32_32x32x16_bf16 v[144:159], v[76:79], v[64:67], v[144:159]
    ds_read_b64_tr_b16 v[100:101], v7 offset:12288
    ds_read_b64_tr_b16 v[102:103], v7 offset:13312
    v_mfma_f32_32x32x16_bf16 v[208:223], v[76:79], v[68:71], v[208:223]
    ds_read_b64_tr_b16 v[104:105], v8 offset:12288
    ds_read_b64_tr_b16 v[106:107], v8 offset:13312
    v_mfma_f32_32x32x16_bf16 v[160:175], v[80:83], v[64:67], v[160:175]
    ds_read_b64_tr_b16 v[108:109], v9 offset:12288
    ds_read_b64_tr_b16 v[110:111], v9 offset:13312
    s_add_u32 s29, s29, 1
    s_cmp_eq_u32 s29, 3
    s_cselect_b32 s25, s33, s32
    s_cselect_b32 s29, 0, s29
    v_mfma_f32_32x32x16_bf16 v[224:239], v[80:83], v[68:71], v[224:239]
    v_add_u32 v2, s25, v2
    v_add_u32 v3, s25, v3
    v_add_u32 v4, s25, v4
    v_add_u32 v5, s25, v5
    v_mfma_f32_32x32x16_bf16 v[176:191], v[84:87], v[64:67], v[176:191]
    v_add_u32 v6, s25, v6
    v_add_u32 v7, s25, v7
    v_add_u32 v8, s25, v8
    v_add_u32 v9, s25, v9
    v_mfma_f32_32x32x16_bf16 v[240:255], v[84:87], v[68:71], v[240:255]
    s_waitcnt lgkmcnt(0)
    s_barrier
    v_mfma_f32_32x32x16_bf16 v[128:143], v[96:99], v[88:91], v[128:143]
    ds_read_b128 v[64:67], v2 offset:0
    ds_read_b64_tr_b16 v[72:73], v6 offset:0
    v_mfma_f32_32x32x16_bf16 v[192:207], v[96:99], v[92:95], v[192:207]
    ds_read_b64_tr_b16 v[74:75], v6 offset:1024
    ds_read_b128 v[68:71], v2 offset:4096
    v_mfma_f32_32x32x16_bf16 v[144:159], v[100:103], v[88:91], v[144:159]
    ds_read_b64_tr_b16 v[76:77], v7 offset:0
    ds_read_b64_tr_b16 v[78:79], v7 offset:1024
    v_mfma_f32_32x32x16_bf16 v[208:223], v[100:103], v[92:95], v[208:223]
    ds_read_b64_tr_b16 v[80:81], v8 offset:0
    ds_read_b64_tr_b16 v[82:83], v8 offset:1024
    v_mfma_f32_32x32x16_bf16 v[160:175], v[104:107], v[88:91], v[160:175]
    ds_read_b64_tr_b16 v[84:85], v9 offset:0
    ds_read_b64_tr_b16 v[86:87], v9 offset:1024
    v_mfma_f32_32x32x16_bf16 v[224:239], v[104:107], v[92:95], v[224:239]
    s_add_u32 s24, s24, 1
    s_cmp_lt_u32 s24, 9
    v_mfma_f32_32x32x16_bf16 v[176:191], v[108:111], v[88:91], v[176:191]
    v_mfma_f32_32x32x16_bf16 v[240:255], v[108:111], v[92:95], v[240:255]
g1_loop:
    s_waitcnt lgkmcnt(0)
    v_mfma_f32_32x32x16_bf16 v[128:143], v[72:75], v[64:67], v[128:143]
    ds_read_b128 v[88:91], v3 offset:0
    ds_read_b64_tr_b16 v[96:97], v6 offset:4096
    v_mfma_f32_32x32x16_bf16 v[192:207], v[72:75], v[68:71], v[192:207]
    ds_read_b64_tr_b16 v[98:99], v6 offset:5120
    ds_read_b128 v[92:95], v3 offset:4096
    v_mfma_f32_32x32x16_bf16 v[144:159], v[76:79], v[64:67], v[144:159]
    ds_read_b64_tr_b16 v[100:101], v7 offset:4096
    ds_read_b64_tr_b16 v[102:103], v7 offset:5120
    v_mfma_f32_32x32x16_bf16 v[208:223], v[76:79], v[68:71], v[208:223]
    ds_read_b64_tr_b16 v[104:105], v8 offset:4096
    ds_read_b64_tr_b16 v[106:107], v8 offset:5120
    v_mfma_f32_32x32x16_bf16 v[160:175], v[80:83], v[64:67], v[160:175]
    ds_read_b64_tr_b16 v[108:109], v9 offset:4096
    ds_read_b64_tr_b16 v[110:111], v9 offset:5120
    v_mfma_f32_32x32x16_bf16 v[224:239], v[80:83], v[68:71], v[224:239]
    v_mfma_f32_32x32x16_bf16 v[176:191], v[84:87], v[64:67], v[176:191]
    v_mfma_f32_32x32x16_bf16 v[240:255], v[84:87], v[68:71], v[240:255]
    s_waitcnt lgkmcnt(0)
    v_mfma_f32_32x32x16_bf16 v[128:143], v[96:99], v[88:91], v[128:143]
    ds_read_b128 v[64:67], v4 offset:0
    ds_read_b64_tr_b16 v[72:73], v6 offset:8192
    v_mfma_f32_32x32x16_bf16 v[192:207], v[96:99], v[92:95], v[192:207]
    ds_read_b64_tr_b16 v[74:75], v6 offset:9216
    ds_read_b128 v[68:71], v4 offset:4096
    v_mfma_f32_32x32x16_bf16 v[144:159], v[100:103], v[88:91], v[144:159]
    ds_read_b64_tr_b16 v[76:77], v7 offset:8192
    ds_read_b64_tr_b16 v[78:79], v7 offset:9216
    v_mfma_f32_32x32x16_bf16 v[208:223], v[100:103], v[92:95], v[208:223]
    ds_read_b64_tr_b16 v[80:81], v8 offset:8192
    ds_read_b64_tr_b16 v[82:83], v8 offset:9216
    v_mfma_f32_32x32x16_bf16 v[160:175], v[104:107], v[88:91], v[160:175]
    ds_read_b64_tr_b16 v[84:85], v9 offset:8192
    ds_read_b64_tr_b16 v[86:87], v9 offset:9216
    v_mfma_f32_32x32x16_bf16 v[224:239], v[104:107], v[92:95], v[224:239]
    v_mfma_f32_32x32x16_bf16 v[176:191], v[108:111], v[88:91], v[176:191]
    v_mfma_f32_32x32x16_bf16 v[240:255], v[108:111], v[92:95], v[240:255]
    s_waitcnt lgkmcnt(0)
    v_mfma_f32_32x32x16_bf16 v[128:143], v[72:75], v[64:67], v[128:143]
    ds_read_b128 v[88:91], v5 offset:0
    ds_read_b64_tr_b16 v[96:97], v6 offset:12288
    v_mfma_f32_32x32x16_bf16 v[192:207], v[72:75], v[68:71], v[192:207]
    ds_read_b64_tr_b16 v[98:99], v6 offset:13312
    ds_read_b128 v[92:95], v5 offset:4096
    v_mfma_f32_32x32x16_bf16 v[144:159], v[76:79], v[64:67], v[144:159]
    ds_read_b64_tr_b16 v[100:101], v7 offset:12288
    ds_read_b64_tr_b16 v[102:103], v7 offset:13312
    v_mfma_f32_32x32x16_bf16 v[208:223], v[76:79], v[68:71], v[208:223]
    ds_read_b64_tr_b16 v[104:105], v8 offset:12288
    ds_read_b64_tr_b16 v[106:107], v8 offset:13312
    v_mfma_f32_32x32x16_bf16 v[160:175], v[80:83], v[64:67], v[160:175]
    ds_read_b64_tr_b16 v[108:109], v9 offset:12288
    ds_read_b64_tr_b16 v[110:111], v9 offset:13312
    s_add_u32 s29, s29, 1
    s_cmp_eq_u32 s29, 3
    s_cselect_b32 s25, s33, s32
    s_cselect_b32 s29, 0, s29
    v_mfma_f32_32x32x16_bf16 v[224:239], v[80:83], v[68:71], v[224:239]
    v_add_u32 v2, s25, v2
    v_add_u32 v3, s25, v3
    v_add_u32 v4, s25, v4
    v_add_u32 v5, s25, v5
    v_mfma_f32_32x32x16_bf16 v[176:191], v[84:87], v[64:67], v[176:191]
    v_add_u32 v6, s25, v6
    v_add_u32 v7, s25, v7
    v_add_u32 v8, s25, v8
    v_add_u32 v9, s25, v9
    v_mfma_f32_32x32x16_bf16 v[240:255], v[84:87], v[68:71], v[240:255]
    s_waitcnt lgkmcnt(0)
    s_barrier
    v_mfma_f32_32x32x16_bf16 v[128:143], v[96:99], v[88:91], v[128:143]
    ds_read_b128 v[64:67], v2 offset:0
    ds_read_b64_tr_b16 v[72:73], v6 offset:0
    v_mfma_f32_32x32x16_bf16 v[192:207], v[96:99], v[92:95], v[192:207]
    ds_read_b64_tr_b16 v[74:75], v6 offset:1024
    ds_read_b128 v[68:71], v2 offset:4096
    v_mfma_f32_32x32x16_bf16 v[144:159], v[100:103], v[88:91], v[144:159]
    ds_read_b64_tr_b16 v[76:77], v7 offset:0
    ds_read_b64_tr_b16 v[78:79], v7 offset:1024
    v_mfma_f32_32x32x16_bf16 v[208:223], v[100:103], v[92:95], v[208:223]
    ds_read_b64_tr_b16 v[80:81], v8 offset:0
    ds_read_b64_tr_b16 v[82:83], v8 offset:1024
    v_mfma_f32_32x32x16_bf16 v[160:175], v[104:107], v[88:91], v[160:175]
    ds_read_b64_tr_b16 v[84:85], v9 offset:0
    ds_read_b64_tr_b16 v[86:87], v9 offset:1024
    v_mfma_f32_32x32x16_bf16 v[224:239], v[104:107], v[92:95], v[224:239]
    s_add_u32 s24, s24, 1
    s_cmp_lt_u32 s24, 9
    v_mfma_f32_32x32x16_bf16 v[176:191], v[108:111], v[88:91], v[176:191]
    v_mfma_f32_32x32x16_bf16 v[240:255], v[108:111], v[92:95], v[240:255]
    s_cbranch_scc1 g1_loop
g1_epi:
    s_waitcnt lgkmcnt(0)
    v_mfma_f32_32x32x16_bf16 v[128:143], v[72:75], v[64:67], v[128:143]
    ds_read_b128 v[88:91], v3 offset:0
    ds_read_b64_tr_b16 v[96:97], v6 offset:4096
    v_mfma_f32_32x32x16_bf16 v[192:207], v[72:75], v[68:71], v[192:207]
    ds_read_b64_tr_b16 v[98:99], v6 offset:5120
    ds_read_b128 v[92:95], v3 offset:4096
    v_mfma_f32_32x32x16_bf16 v[144:159], v[76:79], v[64:67], v[144:159]
    ds_read_b64_tr_b16 v[100:101], v7 offset:4096
    ds_read_b64_tr_b16 v[102:103], v7 offset:5120
    buffer_load_dwordx2 v[116:117], v15, s[12:15], s27 offen offset:0
    v_mfma_f32_32x32x16_bf16 v[208:223], v[76:79], v[68:71], v[208:223]
    ds_read_b64_tr_b16 v[104:105], v8 offset:4096
    ds_read_b64_tr_b16 v[106:107], v8 offset:5120
    buffer_load_dwordx2 v[118:119], v15, s[12:15], s27 offen offset:256
    v_mfma_f32_32x32x16_bf16 v[160:175], v[80:83], v[64:67], v[160:175]
    ds_read_b64_tr_b16 v[108:109], v9 offset:4096
    ds_read_b64_tr_b16 v[110:111], v9 offset:5120
    v_mfma_f32_32x32x16_bf16 v[224:239], v[80:83], v[68:71], v[224:239]
    v_mfma_f32_32x32x16_bf16 v[176:191], v[84:87], v[64:67], v[176:191]
    v_mfma_f32_32x32x16_bf16 v[240:255], v[84:87], v[68:71], v[240:255]
    s_waitcnt lgkmcnt(0)
    v_mfma_f32_32x32x16_bf16 v[128:143], v[96:99], v[88:91], v[128:143]
    ds_read_b128 v[64:67], v4 offset:0
    ds_read_b64_tr_b16 v[72:73], v6 offset:8192
    v_mfma_f32_32x32x16_bf16 v[192:207], v[96:99], v[92:95], v[192:207]
    ds_read_b64_tr_b16 v[74:75], v6 offset:9216
    ds_read_b128 v[68:71], v4 offset:4096
    v_mfma_f32_32x32x16_bf16 v[144:159], v[100:103], v[88:91], v[144:159]
    ds_read_b64_tr_b16 v[76:77], v7 offset:8192
    ds_read_b64_tr_b16 v[78:79], v7 offset:9216
    v_mfma_f32_32x32x16_bf16 v[208:223], v[100:103], v[92:95], v[208:223]
    ds_read_b64_tr_b16 v[80:81], v8 offset:8192
    ds_read_b64_tr_b16 v[82:83], v8 offset:9216
    v_mfma_f32_32x32x16_bf16 v[160:175], v[104:107], v[88:91], v[160:175]
    ds_read_b64_tr_b16 v[84:85], v9 offset:8192
    ds_read_b64_tr_b16 v[86:87], v9 offset:9216
    v_mfma_f32_32x32x16_bf16 v[224:239], v[104:107], v[92:95], v[224:239]
    v_mfma_f32_32x32x16_bf16 v[176:191], v[108:111], v[88:91], v[176:191]
    v_mfma_f32_32x32x16_bf16 v[240:255], v[108:111], v[92:95], v[240:255]
    s_waitcnt lgkmcnt(0)
    v_mfma_f32_32x32x16_bf16 v[128:143], v[72:75], v[64:67], v[128:143]
    ds_read_b128 v[88:91], v5 offset:0
    ds_read_b64_tr_b16 v[96:97], v6 offset:12288
    v_mfma_f32_32x32x16_bf16 v[192:207], v[72:75], v[68:71], v[192:207]
    ds_read_b64_tr_b16 v[98:99], v6 offset:13312
    ds_read_b128 v[92:95], v5 offset:4096
    v_mfma_f32_32x32x16_bf16 v[144:159], v[76:79], v[64:67], v[144:159]
    ds_read_b64_tr_b16 v[100:101], v7 offset:12288
    ds_read_b64_tr_b16 v[102:103], v7 offset:13312
    v_mfma_f32_32x32x16_bf16 v[208:223], v[76:79], v[68:71], v[208:223]
    ds_read_b64_tr_b16 v[104:105], v8 offset:12288
    ds_read_b64_tr_b16 v[106:107], v8 offset:13312
    v_mfma_f32_32x32x16_bf16 v[160:175], v[80:83], v[64:67], v[160:175]
    ds_read_b64_tr_b16 v[108:109], v9 offset:12288
    ds_read_b64_tr_b16 v[110:111], v9 offset:13312
    v_mfma_f32_32x32x16_bf16 v[224:239], v[80:83], v[68:71], v[224:239]
    v_mfma_f32_32x32x16_bf16 v[176:191], v[84:87], v[64:67], v[176:191]
    v_mfma_f32_32x32x16_bf16 v[240:255], v[84:87], v[68:71], v[240:255]
    s_waitcnt lgkmcnt(0)
    v_mfma_f32_32x32x16_bf16 v[128:143], v[96:99], v[88:91], v[128:143]
    v_bfe_u32 v30, v0, 4, 1
    v_mul_u32_u24 v30, 12288, v30
    v_mfma_f32_32x32x16_bf16 v[192:207], v[96:99], v[92:95], v[192:207]
    v_subrev_u32 v30, 131072, v30
    v_sub_u32 v6, v6, v30
    v_mfma_f32_32x32x16_bf16 v[144:159], v[100:103], v[88:91], v[144:159]
    v_sub_u32 v7, v7, v30
    v_sub_u32 v8, v8, v30
    v_mfma_f32_32x32x16_bf16 v[208:223], v[100:103], v[92:95], v[208:223]
    v_sub_u32 v9, v9, v30
    ds_read_b64_tr_b16 v[72:73], v6 offset:0
    v_mfma_f32_32x32x16_bf16 v[160:175], v[104:107], v[88:91], v[160:175]
    ds_read_b64_tr_b16 v[74:75], v6 offset:1024
    ds_read_b64_tr_b16 v[76:77], v7 offset:0
    v_mfma_f32_32x32x16_bf16 v[224:239], v[104:107], v[92:95], v[224:239]
    ds_read_b64_tr_b16 v[78:79], v7 offset:1024
    ds_read_b64_tr_b16 v[80:81], v8 offset:0
    v_mfma_f32_32x32x16_bf16 v[176:191], v[108:111], v[88:91], v[176:191]
    ds_read_b64_tr_b16 v[82:83], v8 offset:1024
    ds_read_b64_tr_b16 v[84:85], v9 offset:0
    v_mfma_f32_32x32x16_bf16 v[240:255], v[108:111], v[92:95], v[240:255]
    ds_read_b64_tr_b16 v[86:87], v9 offset:1024
    s_waitcnt vmcnt(0)
    v_mov_b32 v64, v116
    v_mov_b32 v65, v116
    v_mov_b32 v66, v116
    v_mov_b32 v67, v116
    v_mov_b32 v68, v118
    v_mov_b32 v69, v118
    v_mov_b32 v70, v118
    v_mov_b32 v71, v118
    s_nop 0
    s_waitcnt lgkmcnt(0)
    v_mfma_f32_32x32x16_bf16 v[128:143], v[72:75], v[64:67], v[128:143]
    v_mul_f32 v52, v117, v117
    v_mul_f32 v48, 0xc0135761, v117
    v_mul_f32 v50, v52, v117
    v_mfma_f32_32x32x16_bf16 v[192:207], v[72:75], v[68:71], v[192:207]
    v_rcp_f32 v52, v52
    v_mul_f32 v50, 0xbdd2d3e8, v50
    v_mul_f32 v58, v119, v119
    v_mfma_f32_32x32x16_bf16 v[144:159], v[76:79], v[64:67], v[144:159]
    v_mul_f32 v54, 0xc0135761, v119
    v_mul_f32 v56, v58, v119
    v_rcp_f32 v58, v58
    v_mfma_f32_32x32x16_bf16 v[208:223], v[76:79], v[68:71], v[208:223]
    v_mul_f32 v56, 0xbdd2d3e8, v56
    s_lshl_b32 s28, s17, 3
    s_lshr_b32 s29, s19, 1
    v_mfma_f32_32x32x16_bf16 v[160:175], v[80:83], v[64:67], v[160:175]
    s_lshl_b32 s29, s29, 2
    s_add_u32 s28, s28, s29
    s_mul_i32 s28, s28, 50176
    v_mfma_f32_32x32x16_bf16 v[224:239], v[80:83], v[68:71], v[224:239]
    s_lshl_b32 s29, s18, 2
    s_and_b32 s30, s19, 1
    s_lshl_b32 s30, s30, 1
    v_mfma_f32_32x32x16_bf16 v[176:191], v[84:87], v[64:67], v[176:191]
    s_add_u32 s29, s29, s30
    s_lshl_b32 s29, s29, 10
    s_add_u32 s28, s28, s29
    v_mfma_f32_32x32x16_bf16 v[240:255], v[84:87], v[68:71], v[240:255]
    s_add_u32 s62, s28, 0
    s_add_u32 s63, s62, 100352
    s_lshl_b32 s60, s17, 1
    s_cmp_ge_u32 s18, 6
    s_addc_u32 s60, s60, 0
    s_lshl_b32 s60, s60, 7
    s_add_u32 s60, s60, 29510656
    s_lshl_b32 s28, s19, 2
    s_add_u32 s28, s28, 163584
    v_mov_b32 v16, s28
    v_mov_b32 v19, 1
    v_pk_mul_f32 v[32:33], v[128:129], v[128:129]
    v_pk_mul_f32 v[34:35], v[130:131], v[130:131]
    v_pk_mul_f32 v[36:37], v[132:133], v[132:133]
    v_pk_mul_f32 v[38:39], v[134:135], v[134:135]
    v_pk_fma_f32 v[32:33], v[32:33], v[50:51], v[48:49] op_sel_hi:[1,0,0]
    v_pk_fma_f32 v[34:35], v[34:35], v[50:51], v[48:49] op_sel_hi:[1,0,0]
    v_pk_fma_f32 v[36:37], v[36:37], v[50:51], v[48:49] op_sel_hi:[1,0,0]
    v_pk_fma_f32 v[38:39], v[38:39], v[50:51], v[48:49] op_sel_hi:[1,0,0]
    v_pk_mul_f32 v[32:33], v[32:33], v[128:129]
    v_pk_mul_f32 v[34:35], v[34:35], v[130:131]
    v_pk_mul_f32 v[36:37], v[36:37], v[132:133]
    v_pk_mul_f32 v[38:39], v[38:39], v[134:135]
    v_exp_f32 v32, v32
    v_exp_f32 v33, v33
    v_exp_f32 v34, v34
    v_exp_f32 v35, v35
    v_exp_f32 v36, v36
    v_exp_f32 v37, v37
    v_exp_f32 v38, v38
    v_exp_f32 v39, v39
    v_pk_mul_f32 v[40:41], v[128:129], v[136:137]
    v_pk_mul_f32 v[42:43], v[130:131], v[138:139]
    v_pk_mul_f32 v[44:45], v[132:133], v[140:141]
    v_pk_mul_f32 v[46:47], v[134:135], v[142:143]
    v_pk_fma_f32 v[32:33], v[32:33], v[52:53], v[52:53] op_sel_hi:[1,0,0]
    v_pk_fma_f32 v[34:35], v[34:35], v[52:53], v[52:53] op_sel_hi:[1,0,0]
    v_pk_fma_f32 v[36:37], v[36:37], v[52:53], v[52:53] op_sel_hi:[1,0,0]
    v_pk_fma_f32 v[38:39], v[38:39], v[52:53], v[52:53] op_sel_hi:[1,0,0]
    v_rcp_f32 v32, v32
    v_rcp_f32 v33, v33
    v_rcp_f32 v34, v34
    v_rcp_f32 v35, v35
    v_rcp_f32 v36, v36
    v_rcp_f32 v37, v37
    v_rcp_f32 v38, v38
    v_rcp_f32 v39, v39
    s_nop 0
    v_pk_mul_f32 v[32:33], v[32:33], v[40:41]
    v_pk_mul_f32 v[34:35], v[34:35], v[42:43]
    v_pk_mul_f32 v[36:37], v[36:37], v[44:45]
    v_pk_mul_f32 v[38:39], v[38:39], v[46:47]
    v_cvt_pk_bf16_f32 v96, v32, v33
    v_cvt_pk_bf16_f32 v97, v34, v35
    v_cvt_pk_bf16_f32 v98, v36, v37
    v_cvt_pk_bf16_f32 v99, v38, v39
    buffer_store_dwordx4 v[96:99], v13, s[12:15], s62 offen offset:0 sc0 sc1
    v_pk_mul_f32 v[32:33], v[192:193], v[192:193]
    v_pk_mul_f32 v[34:35], v[194:195], v[194:195]
    v_pk_mul_f32 v[36:37], v[196:197], v[196:197]
    v_pk_mul_f32 v[38:39], v[198:199], v[198:199]
    v_pk_fma_f32 v[32:33], v[32:33], v[56:57], v[54:55] op_sel_hi:[1,0,0]
    v_pk_fma_f32 v[34:35], v[34:35], v[56:57], v[54:55] op_sel_hi:[1,0,0]
    v_pk_fma_f32 v[36:37], v[36:37], v[56:57], v[54:55] op_sel_hi:[1,0,0]
    v_pk_fma_f32 v[38:39], v[38:39], v[56:57], v[54:55] op_sel_hi:[1,0,0]
    v_pk_mul_f32 v[32:33], v[32:33], v[192:193]
    v_pk_mul_f32 v[34:35], v[34:35], v[194:195]
    v_pk_mul_f32 v[36:37], v[36:37], v[196:197]
    v_pk_mul_f32 v[38:39], v[38:39], v[198:199]
    v_exp_f32 v32, v32
    v_exp_f32 v33, v33
    v_exp_f32 v34, v34
    v_exp_f32 v35, v35
    v_exp_f32 v36, v36
    v_exp_f32 v37, v37
    v_exp_f32 v38, v38
    v_exp_f32 v39, v39
    v_pk_mul_f32 v[40:41], v[192:193], v[200:201]
    v_pk_mul_f32 v[42:43], v[194:195], v[202:203]
    v_pk_mul_f32 v[44:45], v[196:197], v[204:205]
    v_pk_mul_f32 v[46:47], v[198:199], v[206:207]
    v_pk_fma_f32 v[32:33], v[32:33], v[58:59], v[58:59] op_sel_hi:[1,0,0]
    v_pk_fma_f32 v[34:35], v[34:35], v[58:59], v[58:59] op_sel_hi:[1,0,0]
    v_pk_fma_f32 v[36:37], v[36:37], v[58:59], v[58:59] op_sel_hi:[1,0,0]
    v_pk_fma_f32 v[38:39], v[38:39], v[58:59], v[58:59] op_sel_hi:[1,0,0]
    v_rcp_f32 v32, v32
    v_rcp_f32 v33, v33
    v_rcp_f32 v34, v34
    v_rcp_f32 v35, v35
    v_rcp_f32 v36, v36
    v_rcp_f32 v37, v37
    v_rcp_f32 v38, v38
    v_rcp_f32 v39, v39
    s_nop 0
    v_pk_mul_f32 v[32:33], v[32:33], v[40:41]
    v_pk_mul_f32 v[34:35], v[34:35], v[42:43]
    v_pk_mul_f32 v[36:37], v[36:37], v[44:45]
    v_pk_mul_f32 v[38:39], v[38:39], v[46:47]
    v_cvt_pk_bf16_f32 v100, v32, v33
    v_cvt_pk_bf16_f32 v101, v34, v35
    v_cvt_pk_bf16_f32 v102, v36, v37
    v_cvt_pk_bf16_f32 v103, v38, v39
    buffer_store_dwordx4 v[100:103], v13, s[12:15], s63 offen offset:0 sc0 sc1
    v_pk_mul_f32 v[32:33], v[144:145], v[144:145]
    v_pk_mul_f32 v[34:35], v[146:147], v[146:147]
    v_pk_mul_f32 v[36:37], v[148:149], v[148:149]
    v_pk_mul_f32 v[38:39], v[150:151], v[150:151]
    v_pk_fma_f32 v[32:33], v[32:33], v[50:51], v[48:49] op_sel_hi:[1,0,0]
    v_pk_fma_f32 v[34:35], v[34:35], v[50:51], v[48:49] op_sel_hi:[1,0,0]
    v_pk_fma_f32 v[36:37], v[36:37], v[50:51], v[48:49] op_sel_hi:[1,0,0]
    v_pk_fma_f32 v[38:39], v[38:39], v[50:51], v[48:49] op_sel_hi:[1,0,0]
    v_pk_mul_f32 v[32:33], v[32:33], v[144:145]
    v_pk_mul_f32 v[34:35], v[34:35], v[146:147]
    v_pk_mul_f32 v[36:37], v[36:37], v[148:149]
    v_pk_mul_f32 v[38:39], v[38:39], v[150:151]
    v_exp_f32 v32, v32
    v_exp_f32 v33, v33
    v_exp_f32 v34, v34
    v_exp_f32 v35, v35
    v_exp_f32 v36, v36
    v_exp_f32 v37, v37
    v_exp_f32 v38, v38
    v_exp_f32 v39, v39
    v_pk_mul_f32 v[40:41], v[144:145], v[152:153]
    v_pk_mul_f32 v[42:43], v[146:147], v[154:155]
    v_pk_mul_f32 v[44:45], v[148:149], v[156:157]
    v_pk_mul_f32 v[46:47], v[150:151], v[158:159]
    v_pk_fma_f32 v[32:33], v[32:33], v[52:53], v[52:53] op_sel_hi:[1,0,0]
    v_pk_fma_f32 v[34:35], v[34:35], v[52:53], v[52:53] op_sel_hi:[1,0,0]
    v_pk_fma_f32 v[36:37], v[36:37], v[52:53], v[52:53] op_sel_hi:[1,0,0]
    v_pk_fma_f32 v[38:39], v[38:39], v[52:53], v[52:53] op_sel_hi:[1,0,0]
    v_rcp_f32 v32, v32
    v_rcp_f32 v33, v33
    v_rcp_f32 v34, v34
    v_rcp_f32 v35, v35
    v_rcp_f32 v36, v36
    v_rcp_f32 v37, v37
    v_rcp_f32 v38, v38
    v_rcp_f32 v39, v39
    s_nop 0
    v_pk_mul_f32 v[32:33], v[32:33], v[40:41]
    v_pk_mul_f32 v[34:35], v[34:35], v[42:43]
    v_pk_mul_f32 v[36:37], v[36:37], v[44:45]
    v_pk_mul_f32 v[38:39], v[38:39], v[46:47]
    v_cvt_pk_bf16_f32 v104, v32, v33
    v_cvt_pk_bf16_f32 v105, v34, v35
    v_cvt_pk_bf16_f32 v106, v36, v37
    v_cvt_pk_bf16_f32 v107, v38, v39
    buffer_store_dwordx4 v[104:107], v13, s[12:15], s62 offen offset:512 sc0 sc1
    v_pk_mul_f32 v[32:33], v[208:209], v[208:209]
    v_pk_mul_f32 v[34:35], v[210:211], v[210:211]
    v_pk_mul_f32 v[36:37], v[212:213], v[212:213]
    v_pk_mul_f32 v[38:39], v[214:215], v[214:215]
    v_pk_fma_f32 v[32:33], v[32:33], v[56:57], v[54:55] op_sel_hi:[1,0,0]
    v_pk_fma_f32 v[34:35], v[34:35], v[56:57], v[54:55] op_sel_hi:[1,0,0]
    v_pk_fma_f32 v[36:37], v[36:37], v[56:57], v[54:55] op_sel_hi:[1,0,0]
    v_pk_fma_f32 v[38:39], v[38:39], v[56:57], v[54:55] op_sel_hi:[1,0,0]
    v_pk_mul_f32 v[32:33], v[32:33], v[208:209]
    v_pk_mul_f32 v[34:35], v[34:35], v[210:211]
    v_pk_mul_f32 v[36:37], v[36:37], v[212:213]
    v_pk_mul_f32 v[38:39], v[38:39], v[214:215]
    v_exp_f32 v32, v32
    v_exp_f32 v33, v33
    v_exp_f32 v34, v34
    v_exp_f32 v35, v35
    v_exp_f32 v36, v36
    v_exp_f32 v37, v37
    v_exp_f32 v38, v38
    v_exp_f32 v39, v39
    v_pk_mul_f32 v[40:41], v[208:209], v[216:217]
    v_pk_mul_f32 v[42:43], v[210:211], v[218:219]
    v_pk_mul_f32 v[44:45], v[212:213], v[220:221]
    v_pk_mul_f32 v[46:47], v[214:215], v[222:223]
    v_pk_fma_f32 v[32:33], v[32:33], v[58:59], v[58:59] op_sel_hi:[1,0,0]
    v_pk_fma_f32 v[34:35], v[34:35], v[58:59], v[58:59] op_sel_hi:[1,0,0]
    v_pk_fma_f32 v[36:37], v[36:37], v[58:59], v[58:59] op_sel_hi:[1,0,0]
    v_pk_fma_f32 v[38:39], v[38:39], v[58:59], v[58:59] op_sel_hi:[1,0,0]
    v_rcp_f32 v32, v32
    v_rcp_f32 v33, v33
    v_rcp_f32 v34, v34
    v_rcp_f32 v35, v35
    v_rcp_f32 v36, v36
    v_rcp_f32 v37, v37
    v_rcp_f32 v38, v38
    v_rcp_f32 v39, v39
    s_nop 0
    v_pk_mul_f32 v[32:33], v[32:33], v[40:41]
    v_pk_mul_f32 v[34:35], v[34:35], v[42:43]
    v_pk_mul_f32 v[36:37], v[36:37], v[44:45]
    v_pk_mul_f32 v[38:39], v[38:39], v[46:47]
    v_cvt_pk_bf16_f32 v108, v32, v33
    v_cvt_pk_bf16_f32 v109, v34, v35
    v_cvt_pk_bf16_f32 v110, v36, v37
    v_cvt_pk_bf16_f32 v111, v38, v39
    buffer_store_dwordx4 v[108:111], v13, s[12:15], s63 offen offset:512 sc0 sc1
    ds_write_b32 v16, v19 offset:64
    v_pk_mul_f32 v[32:33], v[160:161], v[160:161]
    v_pk_mul_f32 v[34:35], v[162:163], v[162:163]
    v_pk_mul_f32 v[36:37], v[164:165], v[164:165]
    v_pk_mul_f32 v[38:39], v[166:167], v[166:167]
    v_pk_fma_f32 v[32:33], v[32:33], v[50:51], v[48:49] op_sel_hi:[1,0,0]
    v_pk_fma_f32 v[34:35], v[34:35], v[50:51], v[48:49] op_sel_hi:[1,0,0]
    v_pk_fma_f32 v[36:37], v[36:37], v[50:51], v[48:49] op_sel_hi:[1,0,0]
    v_pk_fma_f32 v[38:39], v[38:39], v[50:51], v[48:49] op_sel_hi:[1,0,0]
    v_pk_mul_f32 v[32:33], v[32:33], v[160:161]
    v_pk_mul_f32 v[34:35], v[34:35], v[162:163]
    v_pk_mul_f32 v[36:37], v[36:37], v[164:165]
    v_pk_mul_f32 v[38:39], v[38:39], v[166:167]
    v_exp_f32 v32, v32
    v_exp_f32 v33, v33
    v_exp_f32 v34, v34
    v_exp_f32 v35, v35
    v_exp_f32 v36, v36
    v_exp_f32 v37, v37
    v_exp_f32 v38, v38
    v_exp_f32 v39, v39
    v_pk_mul_f32 v[40:41], v[160:161], v[168:169]
    v_pk_mul_f32 v[42:43], v[162:163], v[170:171]
    v_pk_mul_f32 v[44:45], v[164:165], v[172:173]
    v_pk_mul_f32 v[46:47], v[166:167], v[174:175]
    v_pk_fma_f32 v[32:33], v[32:33], v[52:53], v[52:53] op_sel_hi:[1,0,0]
    v_pk_fma_f32 v[34:35], v[34:35], v[52:53], v[52:53] op_sel_hi:[1,0,0]
    v_pk_fma_f32 v[36:37], v[36:37], v[52:53], v[52:53] op_sel_hi:[1,0,0]
    v_pk_fma_f32 v[38:39], v[38:39], v[52:53], v[52:53] op_sel_hi:[1,0,0]
    v_rcp_f32 v32, v32
    v_rcp_f32 v33, v33
    v_rcp_f32 v34, v34
    v_rcp_f32 v35, v35
    v_rcp_f32 v36, v36
    v_rcp_f32 v37, v37
    v_rcp_f32 v38, v38
    v_rcp_f32 v39, v39
    s_nop 0
    v_pk_mul_f32 v[32:33], v[32:33], v[40:41]
    v_pk_mul_f32 v[34:35], v[34:35], v[42:43]
    v_pk_mul_f32 v[36:37], v[36:37], v[44:45]
    v_pk_mul_f32 v[38:39], v[38:39], v[46:47]
    v_cvt_pk_bf16_f32 v96, v32, v33
    v_cvt_pk_bf16_f32 v97, v34, v35
    v_cvt_pk_bf16_f32 v98, v36, v37
    v_cvt_pk_bf16_f32 v99, v38, v39
    buffer_store_dwordx4 v[96:99], v13, s[12:15], s62 offen offset:1024 sc0 sc1
    v_pk_mul_f32 v[32:33], v[224:225], v[224:225]
    v_pk_mul_f32 v[34:35], v[226:227], v[226:227]
    v_pk_mul_f32 v[36:37], v[228:229], v[228:229]
    v_pk_mul_f32 v[38:39], v[230:231], v[230:231]
    v_pk_fma_f32 v[32:33], v[32:33], v[56:57], v[54:55] op_sel_hi:[1,0,0]
    v_pk_fma_f32 v[34:35], v[34:35], v[56:57], v[54:55] op_sel_hi:[1,0,0]
    v_pk_fma_f32 v[36:37], v[36:37], v[56:57], v[54:55] op_sel_hi:[1,0,0]
    v_pk_fma_f32 v[38:39], v[38:39], v[56:57], v[54:55] op_sel_hi:[1,0,0]
    v_pk_mul_f32 v[32:33], v[32:33], v[224:225]
    v_pk_mul_f32 v[34:35], v[34:35], v[226:227]
    v_pk_mul_f32 v[36:37], v[36:37], v[228:229]
    v_pk_mul_f32 v[38:39], v[38:39], v[230:231]
    v_exp_f32 v32, v32
    v_exp_f32 v33, v33
    v_exp_f32 v34, v34
    v_exp_f32 v35, v35
    v_exp_f32 v36, v36
    v_exp_f32 v37, v37
    v_exp_f32 v38, v38
    v_exp_f32 v39, v39
    v_pk_mul_f32 v[40:41], v[224:225], v[232:233]
    v_pk_mul_f32 v[42:43], v[226:227], v[234:235]
    v_pk_mul_f32 v[44:45], v[228:229], v[236:237]
    v_pk_mul_f32 v[46:47], v[230:231], v[238:239]
    v_pk_fma_f32 v[32:33], v[32:33], v[58:59], v[58:59] op_sel_hi:[1,0,0]
    v_pk_fma_f32 v[34:35], v[34:35], v[58:59], v[58:59] op_sel_hi:[1,0,0]
    v_pk_fma_f32 v[36:37], v[36:37], v[58:59], v[58:59] op_sel_hi:[1,0,0]
    v_pk_fma_f32 v[38:39], v[38:39], v[58:59], v[58:59] op_sel_hi:[1,0,0]
    v_rcp_f32 v32, v32
    v_rcp_f32 v33, v33
    v_rcp_f32 v34, v34
    v_rcp_f32 v35, v35
    v_rcp_f32 v36, v36
    v_rcp_f32 v37, v37
    v_rcp_f32 v38, v38
    v_rcp_f32 v39, v39
    s_nop 0
    v_pk_mul_f32 v[32:33], v[32:33], v[40:41]
    v_pk_mul_f32 v[34:35], v[34:35], v[42:43]
    v_pk_mul_f32 v[36:37], v[36:37], v[44:45]
    v_pk_mul_f32 v[38:39], v[38:39], v[46:47]
    v_cvt_pk_bf16_f32 v100, v32, v33
    v_cvt_pk_bf16_f32 v101, v34, v35
    v_cvt_pk_bf16_f32 v102, v36, v37
    v_cvt_pk_bf16_f32 v103, v38, v39
    buffer_store_dwordx4 v[100:103], v13, s[12:15], s63 offen offset:1024 sc0 sc1
    s_mov_b32 s28, 1
    s_waitcnt vmcnt(2)
    s_atomic_add s28, s[58:59], s60
    s_add_u32 s60, s60, 4096
    ds_write_b32 v16, v19 offset:192
    v_pk_mul_f32 v[32:33], v[176:177], v[176:177]
    v_pk_mul_f32 v[34:35], v[178:179], v[178:179]
    v_pk_mul_f32 v[36:37], v[180:181], v[180:181]
    v_pk_mul_f32 v[38:39], v[182:183], v[182:183]
    v_pk_fma_f32 v[32:33], v[32:33], v[50:51], v[48:49] op_sel_hi:[1,0,0]
    v_pk_fma_f32 v[34:35], v[34:35], v[50:51], v[48:49] op_sel_hi:[1,0,0]
    v_pk_fma_f32 v[36:37], v[36:37], v[50:51], v[48:49] op_sel_hi:[1,0,0]
    v_pk_fma_f32 v[38:39], v[38:39], v[50:51], v[48:49] op_sel_hi:[1,0,0]
    v_pk_mul_f32 v[32:33], v[32:33], v[176:177]
    v_pk_mul_f32 v[34:35], v[34:35], v[178:179]
    v_pk_mul_f32 v[36:37], v[36:37], v[180:181]
    v_pk_mul_f32 v[38:39], v[38:39], v[182:183]
    v_exp_f32 v32, v32
    v_exp_f32 v33, v33
    v_exp_f32 v34, v34
    v_exp_f32 v35, v35
    v_exp_f32 v36, v36
    v_exp_f32 v37, v37
    v_exp_f32 v38, v38
    v_exp_f32 v39, v39
    v_pk_mul_f32 v[40:41], v[176:177], v[184:185]
    v_pk_mul_f32 v[42:43], v[178:179], v[186:187]
    v_pk_mul_f32 v[44:45], v[180:181], v[188:189]
    v_pk_mul_f32 v[46:47], v[182:183], v[190:191]
    v_pk_fma_f32 v[32:33], v[32:33], v[52:53], v[52:53] op_sel_hi:[1,0,0]
    v_pk_fma_f32 v[34:35], v[34:35], v[52:53], v[52:53] op_sel_hi:[1,0,0]
    v_pk_fma_f32 v[36:37], v[36:37], v[52:53], v[52:53] op_sel_hi:[1,0,0]
    v_pk_fma_f32 v[38:39], v[38:39], v[52:53], v[52:53] op_sel_hi:[1,0,0]
    v_rcp_f32 v32, v32
    v_rcp_f32 v33, v33
    v_rcp_f32 v34, v34
    v_rcp_f32 v35, v35
    v_rcp_f32 v36, v36
    v_rcp_f32 v37, v37
    v_rcp_f32 v38, v38
    v_rcp_f32 v39, v39
    s_nop 0
    v_pk_mul_f32 v[32:33], v[32:33], v[40:41]
    v_pk_mul_f32 v[34:35], v[34:35], v[42:43]
    v_pk_mul_f32 v[36:37], v[36:37], v[44:45]
    v_pk_mul_f32 v[38:39], v[38:39], v[46:47]
    v_cvt_pk_bf16_f32 v104, v32, v33
    v_cvt_pk_bf16_f32 v105, v34, v35
    v_cvt_pk_bf16_f32 v106, v36, v37
    v_cvt_pk_bf16_f32 v107, v38, v39
    buffer_store_dwordx4 v[104:107], v13, s[12:15], s62 offen offset:1536 sc0 sc1
    v_pk_mul_f32 v[32:33], v[240:241], v[240:241]
    v_pk_mul_f32 v[34:35], v[242:243], v[242:243]
    v_pk_mul_f32 v[36:37], v[244:245], v[244:245]
    v_pk_mul_f32 v[38:39], v[246:247], v[246:247]
    v_pk_fma_f32 v[32:33], v[32:33], v[56:57], v[54:55] op_sel_hi:[1,0,0]
    v_pk_fma_f32 v[34:35], v[34:35], v[56:57], v[54:55] op_sel_hi:[1,0,0]
    v_pk_fma_f32 v[36:37], v[36:37], v[56:57], v[54:55] op_sel_hi:[1,0,0]
    v_pk_fma_f32 v[38:39], v[38:39], v[56:57], v[54:55] op_sel_hi:[1,0,0]
    v_pk_mul_f32 v[32:33], v[32:33], v[240:241]
    v_pk_mul_f32 v[34:35], v[34:35], v[242:243]
    v_pk_mul_f32 v[36:37], v[36:37], v[244:245]
    v_pk_mul_f32 v[38:39], v[38:39], v[246:247]
    v_exp_f32 v32, v32
    v_exp_f32 v33, v33
    v_exp_f32 v34, v34
    v_exp_f32 v35, v35
    v_exp_f32 v36, v36
    v_exp_f32 v37, v37
    v_exp_f32 v38, v38
    v_exp_f32 v39, v39
    v_pk_mul_f32 v[40:41], v[240:241], v[248:249]
    v_pk_mul_f32 v[42:43], v[242:243], v[250:251]
    v_pk_mul_f32 v[44:45], v[244:245], v[252:253]
    v_pk_mul_f32 v[46:47], v[246:247], v[254:255]
    v_pk_fma_f32 v[32:33], v[32:33], v[58:59], v[58:59] op_sel_hi:[1,0,0]
    v_pk_fma_f32 v[34:35], v[34:35], v[58:59], v[58:59] op_sel_hi:[1,0,0]
    v_pk_fma_f32 v[36:37], v[36:37], v[58:59], v[58:59] op_sel_hi:[1,0,0]
    v_pk_fma_f32 v[38:39], v[38:39], v[58:59], v[58:59] op_sel_hi:[1,0,0]
    v_rcp_f32 v32, v32
    v_rcp_f32 v33, v33
    v_rcp_f32 v34, v34
    v_rcp_f32 v35, v35
    v_rcp_f32 v36, v36
    v_rcp_f32 v37, v37
    v_rcp_f32 v38, v38
    v_rcp_f32 v39, v39
    s_nop 0
    v_pk_mul_f32 v[32:33], v[32:33], v[40:41]
    v_pk_mul_f32 v[34:35], v[34:35], v[42:43]
    v_pk_mul_f32 v[36:37], v[36:37], v[44:45]
    v_pk_mul_f32 v[38:39], v[38:39], v[46:47]
    v_cvt_pk_bf16_f32 v108, v32, v33
    v_cvt_pk_bf16_f32 v109, v34, v35
    v_cvt_pk_bf16_f32 v110, v36, v37
    v_cvt_pk_bf16_f32 v111, v38, v39
    buffer_store_dwordx4 v[108:111], v13, s[12:15], s63 offen offset:1536 sc0 sc1
    s_and_b32 s28, s2, 7
    s_lshr_b32 s29, s2, 3
    s_and_b32 s18, s29, 7
    s_lshr_b32 s29, s29, 3
    s_and_b32 s3, s28, 1
    s_lshr_b32 s28, s28, 1
    s_lshl_b32 s28, s28, 2
    s_add_u32 s17, s28, s29
    s_lshl_b32 s17, s17, 1
    s_add_u32 s17, s17, s3
    s_and_b32 s19, s16, 3
    v_lshlrev_b32 v2, 4, v0
    s_lshl_b32 s28, s17, 2
    s_add_u32 s28, s28, s19
    s_mul_i32 s29, s3, 24576
    s_add_u32 s29, s29, 0
    s_mul_i32 s20, s28, 50176
    s_add_u32 s20, s20, s29
    s_xor_b32 s28, s28, 4
    s_mul_i32 s21, s28, 50176
    s_add_u32 s21, s21, s29
    s_lshl_b32 s28, s19, 2
    s_add_u32 s28, s28, 163584
    v_mov_b32 v5, s28
    v_lshrrev_b32 v88, 5, v0
    v_lshlrev_b32 v88, 4, v88
    v_bfe_u32 v89, v0, 4, 1
    v_lshl_add_u32 v88, v89, 2, v88
    v_bfe_u32 v89, v0, 2, 2
    v_add_u32 v88, v88, v89
    v_mul_u32_u24 v88, 160, v88
    v_and_b32 v89, 3, v0
    v_lshl_add_u32 v3, v89, 3, v88
    v_add_u32 v4, 0x10000, v3
    s_min_u32 s29, s20, s21
    s_add_u32 s42, s29, 0
    s_add_u32 s43, s29, 4096
    s_add_u32 s44, s29, 8192
    s_add_u32 s45, s29, 12288
    s_add_u32 s46, s29, 16384
    s_add_u32 s47, s29, 20480
    s_sub_u32 s21, s21, s29
    v_add_u32 v93, s21, v2
    s_sub_u32 s20, s20, s29
    v_add_u32 v92, s20, v2
    s_mov_b32 s28, 1
    s_waitcnt vmcnt(0)
    s_atomic_add s28, s[58:59], s60
    s_branch k_p2g
k_f:
    s_and_b32 s28, s2, 7
    s_lshl_b32 s17, s28, 3
    s_lshr_b32 s29, s2, 3
    s_add_u32 s17, s17, s29
    s_mul_i32 s38, s16, 327680
    s_mul_i32 s29, s17, 1280
    s_add_u32 s38, s38, s29
    s_mul_i32 s39, s16, 5120
    s_mov_b32 s30, 80640
    v_add_u32 v1, 0, v0
    v_mul_u32_u24 v2, 205, v1
    v_lshrrev_b32 v2, 14, v2
    v_lshlrev_b32 v1, 4, v1
    v_mad_u32_u24 v24, v2, s30, v1
    v_add_u32 v1, 64, v0
    v_mul_u32_u24 v2, 205, v1
    v_lshrrev_b32 v2, 14, v2
    v_lshlrev_b32 v1, 4, v1
    v_mad_u32_u24 v25, v2, s30, v1
    v_add_u32 v1, 128, v0
    v_mul_u32_u24 v2, 205, v1
    v_lshrrev_b32 v2, 14, v2
    v_lshlrev_b32 v1, 4, v1
    v_mad_u32_u24 v26, v2, s30, v1
    v_add_u32 v1, 192, v0
    v_mul_u32_u24 v2, 205, v1
    v_lshrrev_b32 v2, 14, v2
    v_lshlrev_b32 v1, 4, v1
    v_mad_u32_u24 v27, v2, s30, v1
    v_add_u32 v1, 256, v0
    v_mul_u32_u24 v2, 205, v1
    v_lshrrev_b32 v2, 14, v2
    v_lshlrev_b32 v1, 4, v1
    v_mad_u32_u24 v28, v2, s30, v1
    v_lshlrev_b32 v1, 2, v0
    v_add_u32 v1, 127232, v1
    v_mov_b32 v2, 0
    ds_write_b32 v1, v2
    s_waitcnt lgkmcnt(0)
    s_mov_b32 s12, s58
    s_mov_b32 s13, s59
    s_mov_b32 s14, 268435456
    s_mov_b32 s15, 0x20000
    s_lshl_b32 s61, s2, 3
    s_add_u32 s61, s61, s16
    s_cmp_lg_u32 s61, 508
    s_cbranch_scc1 k_noclr
    v_lshlrev_b32 v30, 7, v0
    v_mov_b32 v32, 0
    v_mov_b32 v33, 0
    v_mov_b32 v34, 0
    v_mov_b32 v35, 0
    s_mov_b32 s28, 29491200
    buffer_store_dwordx4 v[32:35], v30, s[12:15], s28 offen sc0 sc1
    s_add_u32 s28, s28, 8192
    buffer_store_dwordx4 v[32:35], v30, s[12:15], s28 offen sc0 sc1
    s_add_u32 s28, s28, 8192
    buffer_store_dwordx4 v[32:35], v30, s[12:15], s28 offen sc0 sc1
    s_add_u32 s28, s28, 8192
    buffer_store_dwordx4 v[32:35], v30, s[12:15], s28 offen sc0 sc1
    s_add_u32 s28, s28, 8192
    buffer_store_dwordx4 v[32:35], v30, s[12:15], s28 offen sc0 sc1
    s_add_u32 s28, s28, 8192
    buffer_store_dwordx4 v[32:35], v30, s[12:15], s28 offen sc0 sc1
    s_add_u32 s28, s28, 8192
    buffer_store_dwordx4 v[32:35], v30, s[12:15], s28 offen sc0 sc1
    s_add_u32 s28, s28, 8192
    buffer_store_dwordx4 v[32:35], v30, s[12:15], s28 offen sc0 sc1
    s_add_u32 s28, s28, 8192
k_noclr:
    s_mov_b32 s4, s40
    s_mov_b32 s5, s41
    s_mov_b32 s6, 2621440
    s_mov_b32 s7, 0x20000
    s_add_u32 m0, s39, 0
    s_nop 0
    buffer_load_dwordx4 v24, s[4:7], s38 offen lds
    s_add_u32 m0, s39, 1024
    s_nop 0
    buffer_load_dwordx4 v25, s[4:7], s38 offen lds
    s_add_u32 m0, s39, 2048
    s_nop 0
    buffer_load_dwordx4 v26, s[4:7], s38 offen lds
    s_add_u32 m0, s39, 3072
    s_nop 0
    buffer_load_dwordx4 v27, s[4:7], s38 offen lds
    s_add_u32 m0, s39, 4096
    s_nop 0
    buffer_load_dwordx4 v28, s[4:7], s38 offen lds
    v_lshrrev_b32 v1, 4, v0
    v_mul_u32_u24 v1, 1280, v1
    v_and_b32 v2, 15, v0
    v_mul_u32_u24 v3, 80, v2
    v_add3_u32 v1, v1, v3, s39
    v_lshrrev_b32 v3, 3, v2
    v_mul_u32_u24 v3, 20480, v3
    v_bfe_u32 v8, v0, 2, 1
    v_lshl_add_u32 v3, v8, 9, v3
    v_lshrrev_b32 v8, 4, v0
    s_lshl_b32 s29, s16, 2
    v_add_u32 v8, s29, v8
    v_lshl_add_u32 v3, v8, 4, v3
    v_and_b32 v9, 3, v0
    v_lshl_add_u32 v3, v9, 2, v3
    v_add_u32 v3, 40960, v3
    v_lshlrev_b32 v9, 3, v8
    v_add_u32 v9, 127488, v9
    s_mov_b32 s28, 0x3f803f80
    v_mov_b32 v4, 0
    v_mov_b32 v5, 0
    v_mov_b32 v6, 0
    v_mov_b32 v7, 0
    s_waitcnt vmcnt(0)
    s_cmp_lg_u32 s61, 508
    s_cbranch_scc1 k_noclr2
    v_mov_b32 v30, 1
    v_mov_b32 v31, 0
    global_store_dword v31, v30, s[56:57] offset:128 sc0 sc1
k_noclr2:
    ds_read_b128 v[64:67], v1 offset:0
    ds_read_b128 v[68:71], v1 offset:16
    ds_read_b128 v[72:75], v1 offset:32
    ds_read_b128 v[76:79], v1 offset:48
    ds_read_b128 v[80:83], v1 offset:64
    s_waitcnt lgkmcnt(4)
    v_dot2_f32_bf16 v4, v64, s28, v4
    v_dot2_f32_bf16 v6, v64, v64, v6
    v_dot2_f32_bf16 v5, v65, s28, v5
    v_dot2_f32_bf16 v7, v65, v65, v7
    v_dot2_f32_bf16 v4, v66, s28, v4
    v_dot2_f32_bf16 v6, v66, v66, v6
    v_dot2_f32_bf16 v5, v67, s28, v5
    v_dot2_f32_bf16 v7, v67, v67, v7
    s_waitcnt lgkmcnt(3)
    v_dot2_f32_bf16 v4, v68, s28, v4
    v_dot2_f32_bf16 v6, v68, v68, v6
    v_dot2_f32_bf16 v5, v69, s28, v5
    v_dot2_f32_bf16 v7, v69, v69, v7
    v_dot2_f32_bf16 v4, v70, s28, v4
    v_dot2_f32_bf16 v6, v70, v70, v6
    v_dot2_f32_bf16 v5, v71, s28, v5
    v_dot2_f32_bf16 v7, v71, v71, v7
    s_waitcnt lgkmcnt(2)
    v_dot2_f32_bf16 v4, v72, s28, v4
    v_dot2_f32_bf16 v6, v72, v72, v6
    v_dot2_f32_bf16 v5, v73, s28, v5
    v_dot2_f32_bf16 v7, v73, v73, v7
    v_dot2_f32_bf16 v4, v74, s28, v4
    v_dot2_f32_bf16 v6, v74, v74, v6
    v_dot2_f32_bf16 v5, v75, s28, v5
    v_dot2_f32_bf16 v7, v75, v75, v7
    s_waitcnt lgkmcnt(1)
    v_dot2_f32_bf16 v4, v76, s28, v4
    v_dot2_f32_bf16 v6, v76, v76, v6
    v_dot2_f32_bf16 v5, v77, s28, v5
    v_dot2_f32_bf16 v7, v77, v77, v7
    v_dot2_f32_bf16 v4, v78, s28, v4
    v_dot2_f32_bf16 v6, v78, v78, v6
    v_dot2_f32_bf16 v5, v79, s28, v5
    v_dot2_f32_bf16 v7, v79, v79, v7
    s_waitcnt lgkmcnt(0)
    v_dot2_f32_bf16 v4, v80, s28, v4
    v_dot2_f32_bf16 v6, v80, v80, v6
    v_dot2_f32_bf16 v5, v81, s28, v5
    v_dot2_f32_bf16 v7, v81, v81, v7
    v_dot2_f32_bf16 v4, v82, s28, v4
    v_dot2_f32_bf16 v6, v82, v82, v6
    v_dot2_f32_bf16 v5, v83, s28, v5
    v_dot2_f32_bf16 v7, v83, v83, v7
    v_lshlrev_b32 v88, 16, v64
    v_and_b32 v89, 0xffff0000, v64
    v_lshlrev_b32 v90, 16, v65
    v_and_b32 v91, 0xffff0000, v65
    v_lshlrev_b32 v92, 16, v66
    v_and_b32 v93, 0xffff0000, v66
    v_lshlrev_b32 v94, 16, v67
    v_and_b32 v95, 0xffff0000, v67
    v_lshlrev_b32 v96, 16, v68
    v_and_b32 v97, 0xffff0000, v68
    v_lshlrev_b32 v98, 16, v69
    v_and_b32 v99, 0xffff0000, v69
    v_lshlrev_b32 v100, 16, v70
    v_and_b32 v101, 0xffff0000, v70
    v_lshlrev_b32 v102, 16, v71
    v_and_b32 v103, 0xffff0000, v71
    v_lshlrev_b32 v104, 16, v72
    v_and_b32 v105, 0xffff0000, v72
    v_lshlrev_b32 v106, 16, v73
    v_and_b32 v107, 0xffff0000, v73
    v_lshlrev_b32 v108, 16, v74
    v_and_b32 v109, 0xffff0000, v74
    v_lshlrev_b32 v110, 16, v75
    v_and_b32 v111, 0xffff0000, v75
    v_lshlrev_b32 v112, 16, v76
    v_and_b32 v113, 0xffff0000, v76
    v_lshlrev_b32 v114, 16, v77
    v_and_b32 v115, 0xffff0000, v77
    v_lshlrev_b32 v116, 16, v78
    v_and_b32 v117, 0xffff0000, v78
    v_lshlrev_b32 v118, 16, v79
    v_and_b32 v119, 0xffff0000, v79
    v_lshlrev_b32 v120, 16, v80
    v_and_b32 v121, 0xffff0000, v80
    v_lshlrev_b32 v122, 16, v81
    v_and_b32 v123, 0xffff0000, v81
    v_lshlrev_b32 v124, 16, v82
    v_and_b32 v125, 0xffff0000, v82
    v_lshlrev_b32 v126, 16, v83
    v_and_b32 v127, 0xffff0000, v83
    v_add_f32 v4, v4, v5
    v_add_f32 v6, v6, v7
    s_nop 0
    v_add_f32_dpp v4, v4, v4 row_ror:8 row_mask:0xf bank_mask:0xf
    v_add_f32_dpp v6, v6, v6 row_ror:8 row_mask:0xf bank_mask:0xf
    s_nop 0
    v_add_f32_dpp v4, v4, v4 row_ror:4 row_mask:0xf bank_mask:0xf
    v_add_f32_dpp v6, v6, v6 row_ror:4 row_mask:0xf bank_mask:0xf
    s_nop 0
    v_add_f32_dpp v4, v4, v4 row_ror:2 row_mask:0xf bank_mask:0xf
    v_add_f32_dpp v6, v6, v6 row_ror:2 row_mask:0xf bank_mask:0xf
    s_nop 0
    v_add_f32_dpp v4, v4, v4 row_ror:1 row_mask:0xf bank_mask:0xf
    v_add_f32_dpp v6, v6, v6 row_ror:1 row_mask:0xf bank_mask:0xf
    s_nop 0
    s_mov_b32 s28, 0x3acccccd
    v_mul_f32 v4, s28, v4
    v_mul_f32 v6, s28, v6
    v_fma_f32 v6, -v4, v4, v6
    v_max_f32 v6, 0, v6
    v_cvt_pk_bf16_f32 v5, v4, v6
    v_and_b32 v6, 0xffff0000, v5
    v_add_f32 v6, 0x3727c5ac, v6
    v_cvt_pk_bf16_f32 v6, v6, v6
    v_lshlrev_b32 v6, 16, v6
    v_sqrt_f32 v6, v6
    v_lshlrev_b32 v4, 16, v5
    v_cvt_pk_bf16_f32 v6, v6, v6
    v_lshlrev_b32 v6, 16, v6
    v_rcp_f32 v11, v6
    v_cvt_pk_bf16_f32 v10, -v4, -v4
    v_mul_f32 v6, v4, v11
    v_mov_b32 v4, v11
    ds_write_b64 v9, v[10:11] offset:0
    v_pk_fma_f32 v[88:89], v[88:89], v[4:5], v[6:7] op_sel_hi:[1,0,0] neg_lo:[0,0,1] neg_hi:[0,0,1]
    v_pk_fma_f32 v[90:91], v[90:91], v[4:5], v[6:7] op_sel_hi:[1,0,0] neg_lo:[0,0,1] neg_hi:[0,0,1]
    v_pk_fma_f32 v[92:93], v[92:93], v[4:5], v[6:7] op_sel_hi:[1,0,0] neg_lo:[0,0,1] neg_hi:[0,0,1]
    v_pk_fma_f32 v[94:95], v[94:95], v[4:5], v[6:7] op_sel_hi:[1,0,0] neg_lo:[0,0,1] neg_hi:[0,0,1]
    v_pk_fma_f32 v[96:97], v[96:97], v[4:5], v[6:7] op_sel_hi:[1,0,0] neg_lo:[0,0,1] neg_hi:[0,0,1]
    v_pk_fma_f32 v[98:99], v[98:99], v[4:5], v[6:7] op_sel_hi:[1,0,0] neg_lo:[0,0,1] neg_hi:[0,0,1]
    v_pk_fma_f32 v[100:101], v[100:101], v[4:5], v[6:7] op_sel_hi:[1,0,0] neg_lo:[0,0,1] neg_hi:[0,0,1]
    v_pk_fma_f32 v[102:103], v[102:103], v[4:5], v[6:7] op_sel_hi:[1,0,0] neg_lo:[0,0,1] neg_hi:[0,0,1]
    v_pk_fma_f32 v[104:105], v[104:105], v[4:5], v[6:7] op_sel_hi:[1,0,0] neg_lo:[0,0,1] neg_hi:[0,0,1]
    v_pk_fma_f32 v[106:107], v[106:107], v[4:5], v[6:7] op_sel_hi:[1,0,0] neg_lo:[0,0,1] neg_hi:[0,0,1]
    v_pk_fma_f32 v[108:109], v[108:109], v[4:5], v[6:7] op_sel_hi:[1,0,0] neg_lo:[0,0,1] neg_hi:[0,0,1]
    v_pk_fma_f32 v[110:111], v[110:111], v[4:5], v[6:7] op_sel_hi:[1,0,0] neg_lo:[0,0,1] neg_hi:[0,0,1]
    v_pk_fma_f32 v[112:113], v[112:113], v[4:5], v[6:7] op_sel_hi:[1,0,0] neg_lo:[0,0,1] neg_hi:[0,0,1]
    v_pk_fma_f32 v[114:115], v[114:115], v[4:5], v[6:7] op_sel_hi:[1,0,0] neg_lo:[0,0,1] neg_hi:[0,0,1]
    v_pk_fma_f32 v[116:117], v[116:117], v[4:5], v[6:7] op_sel_hi:[1,0,0] neg_lo:[0,0,1] neg_hi:[0,0,1]
    v_pk_fma_f32 v[118:119], v[118:119], v[4:5], v[6:7] op_sel_hi:[1,0,0] neg_lo:[0,0,1] neg_hi:[0,0,1]
    v_pk_fma_f32 v[120:121], v[120:121], v[4:5], v[6:7] op_sel_hi:[1,0,0] neg_lo:[0,0,1] neg_hi:[0,0,1]
    v_pk_fma_f32 v[122:123], v[122:123], v[4:5], v[6:7] op_sel_hi:[1,0,0] neg_lo:[0,0,1] neg_hi:[0,0,1]
    v_pk_fma_f32 v[124:125], v[124:125], v[4:5], v[6:7] op_sel_hi:[1,0,0] neg_lo:[0,0,1] neg_hi:[0,0,1]
    v_pk_fma_f32 v[126:127], v[126:127], v[4:5], v[6:7] op_sel_hi:[1,0,0] neg_lo:[0,0,1] neg_hi:[0,0,1]
    v_cvt_pk_bf16_f32 v64, v88, v108
    ds_write_b32 v3, v64 offset:0
    v_cvt_pk_bf16_f32 v65, v89, v109
    ds_write_b32 v3, v65 offset:1024
    v_cvt_pk_bf16_f32 v66, -v90, -v110
    ds_write_b32 v3, v66 offset:2048
    v_cvt_pk_bf16_f32 v67, -v91, -v111
    ds_write_b32 v3, v67 offset:3072
    v_cvt_pk_bf16_f32 v68, v92, v112
    ds_write_b32 v3, v68 offset:4096
    v_cvt_pk_bf16_f32 v69, v93, v113
    ds_write_b32 v3, v69 offset:5120
    v_cvt_pk_bf16_f32 v70, -v94, -v114
    ds_write_b32 v3, v70 offset:6144
    v_cvt_pk_bf16_f32 v71, -v95, -v115
    ds_write_b32 v3, v71 offset:7168
    v_cvt_pk_bf16_f32 v72, v96, v116
    ds_write_b32 v3, v72 offset:8192
    v_cvt_pk_bf16_f32 v73, v97, v117
    ds_write_b32 v3, v73 offset:9216
    v_cvt_pk_bf16_f32 v74, -v98, -v118
    ds_write_b32 v3, v74 offset:10240
    v_cvt_pk_bf16_f32 v75, -v99, -v119
    ds_write_b32 v3, v75 offset:11264
    v_cvt_pk_bf16_f32 v76, v100, v120
    ds_write_b32 v3, v76 offset:12288
    v_cvt_pk_bf16_f32 v77, v101, v121
    ds_write_b32 v3, v77 offset:13312
    v_cvt_pk_bf16_f32 v78, -v102, -v122
    ds_write_b32 v3, v78 offset:14336
    v_cvt_pk_bf16_f32 v79, -v103, -v123
    ds_write_b32 v3, v79 offset:15360
    v_cvt_pk_bf16_f32 v80, v104, v124
    ds_write_b32 v3, v80 offset:16384
    v_cvt_pk_bf16_f32 v81, v105, v125
    ds_write_b32 v3, v81 offset:17408
    v_cvt_pk_bf16_f32 v82, -v106, -v126
    ds_write_b32 v3, v82 offset:18432
    v_cvt_pk_bf16_f32 v83, -v107, -v127
    ds_write_b32 v3, v83 offset:19456
    s_add_u32 s28, s16, 2
    s_cmp_lt_u32 s16, 4
    s_cselect_b32 s36, s16, s28
    s_waitcnt lgkmcnt(0)
    s_barrier
    s_lshr_b32 s28, s16, 1
    s_cmp_eq_u32 s28, 2
    s_cbranch_scc1 k_fs
f1_dft:
    v_lshlrev_b32 v12, 4, v0
    v_add_u32 v12, 40960, v12
    s_mov_b32 s37, 0x3acccccd
    v_lshrrev_b32 v1, 3, v0
    v_xor_b32 v1, v1, v0
    v_and_b32 v1, 3, v1
    v_lshlrev_b32 v17, 4, v1
    s_lshl_b32 s28, s16, 11
    s_add_u32 s28, s28, 128000
    v_lshl_add_u32 v3, v0, 4, s28
    v_bfe_u32 v1, v0, 1, 2
    v_lshrrev_b32 v2, 5, v0
    v_xor_b32 v1, v1, v2
    v_lshlrev_b32 v1, 4, v1
    v_and_b32 v2, 31, v0
    v_lshl_add_u32 v1, v2, 6, v1
    v_add_u32 v22, s28, v1
    v_xor_b32 v23, 32, v22
    v_lshlrev_b32 v16, 31, v0
    v_xor_b32 v16, 1.0, v16
    v_lshrrev_b32 v11, 5, v0
    v_mul_u32_u24 v11, 160, v11
    v_cvt_f32_u32 v11, v11
f1_unit:
    ds_read_b128 v[40:43], v12 offset:0
    ds_read_b128 v[44:47], v12 offset:20480
    ds_read_b128 v[48:51], v12 offset:1024
    ds_read_b128 v[52:55], v12 offset:21504
    s_lshr_b32 s28, s36, 1
    s_lshl_b32 s28, s28, 5
    s_and_b32 s29, s36, 1
    s_mul_i32 s30, s29, 0x3e800000
    v_and_b32 v9, 31, v0
    v_add_u32 v9, s28, v9
    v_cvt_f32_u32 v4, v9
    s_mul_i32 s31, s29, 0x80008000
    v_cmp_gt_u32 vcc, s29, v9
    v_mov_b32 v5, s30
    v_mov_b32 v6, 1.0
    v_mov_b32 v10, 0x43200000
    v_cndmask_b32 v4, v4, v10, vcc
    v_mov_b32 v10, 0x3e000000
    v_cndmask_b32 v5, v5, v10, vcc
    v_mov_b32 v10, 0x3fb504f3
    v_cndmask_b32 v6, v6, v10, vcc
    v_mul_f32 v128, v11, v4
    v_mul_f32 v8, 0x3d000000, v4
    v_mul_f32 v10, s37, v128
    v_mul_f32 v7, s37, v4
    v_floor_f32 v10, v10
    v_fract_f32 v8, v8
    v_fmac_f32 v128, 0xc4200000, v10
    v_fma_f32 v128, v128, s37, v5
    v_add_f32 v136, v128, v7
    v_add_f32 v129, v128, v8
    v_add_f32 v137, v136, v8
    v_cos_f32 v8, v8
    v_cos_f32 v128, v128
    v_cos_f32 v129, v129
    v_cos_f32 v136, v136
    v_cos_f32 v137, v137
    v_cos_f32 v7, v7
    v_add_f32 v8, v8, v8
    v_mul_f32 v128, v6, v128
    v_mul_f32 v129, v6, v129
    v_mul_f32 v136, v6, v136
    v_mul_f32 v137, v6, v137
    v_mul_f32 v13, -2.0, v7
    v_add_f32 v7, v7, v7
    v_fma_f32 v130, v8, v129, -v128
    v_fma_f32 v138, v8, v137, -v136
    v_fma_f32 v131, v8, v130, -v129
    v_fma_f32 v139, v8, v138, -v137
    v_fma_f32 v132, v8, v131, -v130
    v_fma_f32 v140, v8, v139, -v138
    v_fma_f32 v133, v8, v132, -v131
    v_fma_f32 v141, v8, v140, -v139
    v_fma_f32 v134, v8, v133, -v132
    v_fma_f32 v142, v8, v141, -v140
    v_fma_f32 v135, v8, v134, -v133
    v_fma_f32 v143, v8, v142, -v141
    v_cvt_pk_bf16_f32 v144, v128, v129
    v_cvt_pk_bf16_f32 v145, v130, v131
    v_cvt_pk_bf16_f32 v146, v132, v133
    v_cvt_pk_bf16_f32 v147, v134, v135
    v_lshrrev_b32 v9, 2, v0
    v_add_u32 v9, s28, v9
    v_cmp_eq_u32 vcc, 0, v9
    v_mul_u32_u24 v9, 8320, v9
    s_lshl_b32 s30, s29, 6
    v_add_u32 v18, s30, v9
    v_add_u32 v19, 133120, v18
    s_add_u32 s30, s30, 2662400
    v_sub_u32 v20, s30, v9
    v_subrev_u32 v21, 133120, v20
    s_mul_i32 s30, s29, 1331200
    v_mov_b32 v9, s30
    v_cndmask_b32 v18, v18, v9, vcc
    v_add_u32 v9, 64, v9
    v_cndmask_b32 v20, v20, v9, vcc
    v_add_u32 v18, v18, v17
    v_add_u32 v19, v19, v17
    v_add_u32 v20, v20, v17
    v_add_u32 v21, v21, v17
    s_lshl_b32 s30, s17, 7
    s_add_u32 s30, s30, 12582912
    s_waitcnt lgkmcnt(2)
    v_mfma_f32_32x32x16_bf16 v[64:79], v[40:43], v[144:147], 0
    v_cvt_pk_bf16_f32 v148, v136, v137
    v_cvt_pk_bf16_f32 v149, v138, v139
    v_mfma_f32_32x32x16_bf16 v[96:111], v[44:47], v[144:147], 0
    v_cvt_pk_bf16_f32 v150, v140, v141
    v_cvt_pk_bf16_f32 v151, v142, v143
    ds_read_b128 v[56:59], v12 offset:2048
    ds_read_b128 v[60:63], v12 offset:22528
    s_waitcnt lgkmcnt(2)
    v_mfma_f32_32x32x16_bf16 v[80:95], v[48:51], v[148:151], 0
    v_fmac_f32 v128, v13, v136
    v_fmac_f32 v129, v13, v137
    v_fmac_f32 v130, v13, v138
    v_fmac_f32 v131, v13, v139
    v_fmac_f32 v132, v13, v140
    v_fmac_f32 v133, v13, v141
    v_mfma_f32_32x32x16_bf16 v[112:127], v[52:55], v[148:151], 0
    v_fmac_f32 v134, v13, v142
    v_fmac_f32 v135, v13, v143
    v_cvt_pk_bf16_f32 v144, v128, v129
    v_cvt_pk_bf16_f32 v145, v130, v131
    v_cvt_pk_bf16_f32 v146, v132, v133
    v_cvt_pk_bf16_f32 v147, v134, v135
    ds_read_b128 v[40:43], v12 offset:3072
    ds_read_b128 v[44:47], v12 offset:23552
    s_waitcnt lgkmcnt(2)
    v_mfma_f32_32x32x16_bf16 v[64:79], v[56:59], v[144:147], v[64:79]
    v_fmac_f32 v136, v7, v128
    v_fmac_f32 v137, v7, v129
    v_fmac_f32 v138, v7, v130
    v_fmac_f32 v139, v7, v131
    v_fmac_f32 v140, v7, v132
    v_fmac_f32 v141, v7, v133
    v_mfma_f32_32x32x16_bf16 v[96:111], v[60:63], v[144:147], v[96:111]
    v_fmac_f32 v142, v7, v134
    v_fmac_f32 v143, v7, v135
    v_cvt_pk_bf16_f32 v148, v136, v137
    v_cvt_pk_bf16_f32 v149, v138, v139
    v_cvt_pk_bf16_f32 v150, v140, v141
    v_cvt_pk_bf16_f32 v151, v142, v143
    ds_read_b128 v[48:51], v12 offset:4096
    ds_read_b128 v[52:55], v12 offset:24576
    s_waitcnt lgkmcnt(2)
    v_mfma_f32_32x32x16_bf16 v[80:95], v[40:43], v[148:151], v[80:95]
    v_fmac_f32 v128, v13, v136
    v_fmac_f32 v129, v13, v137
    v_fmac_f32 v130, v13, v138
    v_fmac_f32 v131, v13, v139
    v_fmac_f32 v132, v13, v140
    v_fmac_f32 v133, v13, v141
    v_mfma_f32_32x32x16_bf16 v[112:127], v[44:47], v[148:151], v[112:127]
    v_fmac_f32 v134, v13, v142
    v_fmac_f32 v135, v13, v143
    v_cvt_pk_bf16_f32 v144, v128, v129
    v_cvt_pk_bf16_f32 v145, v130, v131
    v_cvt_pk_bf16_f32 v146, v132, v133
    v_cvt_pk_bf16_f32 v147, v134, v135
    ds_read_b128 v[56:59], v12 offset:5120
    ds_read_b128 v[60:63], v12 offset:25600
    s_waitcnt lgkmcnt(2)
    v_mfma_f32_32x32x16_bf16 v[64:79], v[48:51], v[144:147], v[64:79]
    v_fmac_f32 v136, v7, v128
    v_fmac_f32 v137, v7, v129
    v_fmac_f32 v138, v7, v130
    v_fmac_f32 v139, v7, v131
    v_fmac_f32 v140, v7, v132
    v_fmac_f32 v141, v7, v133
    v_mfma_f32_32x32x16_bf16 v[96:111], v[52:55], v[144:147], v[96:111]
    v_fmac_f32 v142, v7, v134
    v_fmac_f32 v143, v7, v135
    v_cvt_pk_bf16_f32 v148, v136, v137
    v_cvt_pk_bf16_f32 v149, v138, v139
    v_cvt_pk_bf16_f32 v150, v140, v141
    v_cvt_pk_bf16_f32 v151, v142, v143
    ds_read_b128 v[40:43], v12 offset:6144
    ds_read_b128 v[44:47], v12 offset:26624
    s_waitcnt lgkmcnt(2)
    v_mfma_f32_32x32x16_bf16 v[80:95], v[56:59], v[148:151], v[80:95]
    v_fmac_f32 v128, v13, v136
    v_fmac_f32 v129, v13, v137
    v_fmac_f32 v130, v13, v138
    v_fmac_f32 v131, v13, v139
    v_fmac_f32 v132, v13, v140
    v_fmac_f32 v133, v13, v141
    v_mfma_f32_32x32x16_bf16 v[112:127], v[60:63], v[148:151], v[112:127]
    v_fmac_f32 v134, v13, v142
    v_fmac_f32 v135, v13, v143
    v_cvt_pk_bf16_f32 v144, v128, v129
    v_cvt_pk_bf16_f32 v145, v130, v131
    v_cvt_pk_bf16_f32 v146, v132, v133
    v_cvt_pk_bf16_f32 v147, v134, v135
    ds_read_b128 v[48:51], v12 offset:7168
    ds_read_b128 v[52:55], v12 offset:27648
    s_waitcnt lgkmcnt(2)
    v_mfma_f32_32x32x16_bf16 v[64:79], v[40:43], v[144:147], v[64:79]
    v_fmac_f32 v136, v7, v128
    v_fmac_f32 v137, v7, v129
    v_fmac_f32 v138, v7, v130
    v_fmac_f32 v139, v7, v131
    v_fmac_f32 v140, v7, v132
    v_fmac_f32 v141, v7, v133
    v_mfma_f32_32x32x16_bf16 v[96:111], v[44:47], v[144:147], v[96:111]
    v_fmac_f32 v142, v7, v134
    v_fmac_f32 v143, v7, v135
    v_cvt_pk_bf16_f32 v148, v136, v137
    v_cvt_pk_bf16_f32 v149, v138, v139
    v_cvt_pk_bf16_f32 v150, v140, v141
    v_cvt_pk_bf16_f32 v151, v142, v143
    ds_read_b128 v[56:59], v12 offset:8192
    ds_read_b128 v[60:63], v12 offset:28672
    s_waitcnt lgkmcnt(2)
    v_mfma_f32_32x32x16_bf16 v[80:95], v[48:51], v[148:151], v[80:95]
    v_fmac_f32 v128, v13, v136
    v_fmac_f32 v129, v13, v137
    v_fmac_f32 v130, v13, v138
    v_fmac_f32 v131, v13, v139
    v_fmac_f32 v132, v13, v140
    v_fmac_f32 v133, v13, v141
    v_mfma_f32_32x32x16_bf16 v[112:127], v[52:55], v[148:151], v[112:127]
    v_fmac_f32 v134, v13, v142
    v_fmac_f32 v135, v13, v143
    v_cvt_pk_bf16_f32 v144, v128, v129
    v_cvt_pk_bf16_f32 v145, v130, v131
    v_cvt_pk_bf16_f32 v146, v132, v133
    v_cvt_pk_bf16_f32 v147, v134, v135
    ds_read_b128 v[40:43], v12 offset:9216
    ds_read_b128 v[44:47], v12 offset:29696
    s_waitcnt lgkmcnt(2)
    v_mfma_f32_32x32x16_bf16 v[64:79], v[56:59], v[144:147], v[64:79]
    v_fmac_f32 v136, v7, v128
    v_fmac_f32 v137, v7, v129
    v_fmac_f32 v138, v7, v130
    v_fmac_f32 v139, v7, v131
    v_fmac_f32 v140, v7, v132
    v_fmac_f32 v141, v7, v133
    v_mfma_f32_32x32x16_bf16 v[96:111], v[60:63], v[144:147], v[96:111]
    v_fmac_f32 v142, v7, v134
    v_fmac_f32 v143, v7, v135
    v_cvt_pk_bf16_f32 v148, v136, v137
    v_cvt_pk_bf16_f32 v149, v138, v139
    v_cvt_pk_bf16_f32 v150, v140, v141
    v_cvt_pk_bf16_f32 v151, v142, v143
    ds_read_b128 v[48:51], v12 offset:10240
    ds_read_b128 v[52:55], v12 offset:30720
    s_waitcnt lgkmcnt(2)
    v_mfma_f32_32x32x16_bf16 v[80:95], v[40:43], v[148:151], v[80:95]
    v_fmac_f32 v128, v13, v136
    v_fmac_f32 v129, v13, v137
    v_fmac_f32 v130, v13, v138
    v_fmac_f32 v131, v13, v139
    v_fmac_f32 v132, v13, v140
    v_fmac_f32 v133, v13, v141
    v_mfma_f32_32x32x16_bf16 v[112:127], v[44:47], v[148:151], v[112:127]
    v_fmac_f32 v134, v13, v142
    v_fmac_f32 v135, v13, v143
    v_cvt_pk_bf16_f32 v144, v128, v129
    v_cvt_pk_bf16_f32 v145, v130, v131
    v_cvt_pk_bf16_f32 v146, v132, v133
    v_cvt_pk_bf16_f32 v147, v134, v135
    ds_read_b128 v[56:59], v12 offset:11264
    ds_read_b128 v[60:63], v12 offset:31744
    s_waitcnt lgkmcnt(2)
    v_mfma_f32_32x32x16_bf16 v[64:79], v[48:51], v[144:147], v[64:79]
    v_fmac_f32 v136, v7, v128
    v_fmac_f32 v137, v7, v129
    v_fmac_f32 v138, v7, v130
    v_fmac_f32 v139, v7, v131
    v_fmac_f32 v140, v7, v132
    v_fmac_f32 v141, v7, v133
    v_mfma_f32_32x32x16_bf16 v[96:111], v[52:55], v[144:147], v[96:111]
    v_fmac_f32 v142, v7, v134
    v_fmac_f32 v143, v7, v135
    v_cvt_pk_bf16_f32 v148, v136, v137
    v_cvt_pk_bf16_f32 v149, v138, v139
    v_cvt_pk_bf16_f32 v150, v140, v141
    v_cvt_pk_bf16_f32 v151, v142, v143
    ds_read_b128 v[40:43], v12 offset:12288
    ds_read_b128 v[44:47], v12 offset:32768
    s_waitcnt lgkmcnt(2)
    v_mfma_f32_32x32x16_bf16 v[80:95], v[56:59], v[148:151], v[80:95]
    v_fmac_f32 v128, v13, v136
    v_fmac_f32 v129, v13, v137
    v_fmac_f32 v130, v13, v138
    v_fmac_f32 v131, v13, v139
    v_fmac_f32 v132, v13, v140
    v_fmac_f32 v133, v13, v141
    v_mfma_f32_32x32x16_bf16 v[112:127], v[60:63], v[148:151], v[112:127]
    v_fmac_f32 v134, v13, v142
    v_fmac_f32 v135, v13, v143
    v_cvt_pk_bf16_f32 v144, v128, v129
    v_cvt_pk_bf16_f32 v145, v130, v131
    v_cvt_pk_bf16_f32 v146, v132, v133
    v_cvt_pk_bf16_f32 v147, v134, v135
    ds_read_b128 v[48:51], v12 offset:13312
    ds_read_b128 v[52:55], v12 offset:33792
    s_waitcnt lgkmcnt(2)
    v_mfma_f32_32x32x16_bf16 v[64:79], v[40:43], v[144:147], v[64:79]
    v_fmac_f32 v136, v7, v128
    v_fmac_f32 v137, v7, v129
    v_fmac_f32 v138, v7, v130
    v_fmac_f32 v139, v7, v131
    v_fmac_f32 v140, v7, v132
    v_fmac_f32 v141, v7, v133
    v_mfma_f32_32x32x16_bf16 v[96:111], v[44:47], v[144:147], v[96:111]
    v_fmac_f32 v142, v7, v134
    v_fmac_f32 v143, v7, v135
    v_cvt_pk_bf16_f32 v148, v136, v137
    v_cvt_pk_bf16_f32 v149, v138, v139
    v_cvt_pk_bf16_f32 v150, v140, v141
    v_cvt_pk_bf16_f32 v151, v142, v143
    ds_read_b128 v[56:59], v12 offset:14336
    ds_read_b128 v[60:63], v12 offset:34816
    s_waitcnt lgkmcnt(2)
    v_mfma_f32_32x32x16_bf16 v[80:95], v[48:51], v[148:151], v[80:95]
    v_fmac_f32 v128, v13, v136
    v_fmac_f32 v129, v13, v137
    v_fmac_f32 v130, v13, v138
    v_fmac_f32 v131, v13, v139
    v_fmac_f32 v132, v13, v140
    v_fmac_f32 v133, v13, v141
    v_mfma_f32_32x32x16_bf16 v[112:127], v[52:55], v[148:151], v[112:127]
    v_fmac_f32 v134, v13, v142
    v_fmac_f32 v135, v13, v143
    v_cvt_pk_bf16_f32 v144, v128, v129
    v_cvt_pk_bf16_f32 v145, v130, v131
    v_cvt_pk_bf16_f32 v146, v132, v133
    v_cvt_pk_bf16_f32 v147, v134, v135
    ds_read_b128 v[40:43], v12 offset:15360
    ds_read_b128 v[44:47], v12 offset:35840
    s_waitcnt lgkmcnt(2)
    v_mfma_f32_32x32x16_bf16 v[64:79], v[56:59], v[144:147], v[64:79]
    v_fmac_f32 v136, v7, v128
    v_fmac_f32 v137, v7, v129
    v_fmac_f32 v138, v7, v130
    v_fmac_f32 v139, v7, v131
    v_fmac_f32 v140, v7, v132
    v_fmac_f32 v141, v7, v133
    v_mfma_f32_32x32x16_bf16 v[96:111], v[60:63], v[144:147], v[96:111]
    v_fmac_f32 v142, v7, v134
    v_fmac_f32 v143, v7, v135
    v_cvt_pk_bf16_f32 v148, v136, v137
    v_cvt_pk_bf16_f32 v149, v138, v139
    v_cvt_pk_bf16_f32 v150, v140, v141
    v_cvt_pk_bf16_f32 v151, v142, v143
    ds_read_b128 v[48:51], v12 offset:16384
    ds_read_b128 v[52:55], v12 offset:36864
    s_waitcnt lgkmcnt(2)
    v_mfma_f32_32x32x16_bf16 v[80:95], v[40:43], v[148:151], v[80:95]
    v_fmac_f32 v128, v13, v136
    v_fmac_f32 v129, v13, v137
    v_fmac_f32 v130, v13, v138
    v_fmac_f32 v131, v13, v139
    v_fmac_f32 v132, v13, v140
    v_fmac_f32 v133, v13, v141
    v_mfma_f32_32x32x16_bf16 v[112:127], v[44:47], v[148:151], v[112:127]
    v_fmac_f32 v134, v13, v142
    v_fmac_f32 v135, v13, v143
    v_cvt_pk_bf16_f32 v144, v128, v129
    v_cvt_pk_bf16_f32 v145, v130, v131
    v_cvt_pk_bf16_f32 v146, v132, v133
    v_cvt_pk_bf16_f32 v147, v134, v135
    ds_read_b128 v[56:59], v12 offset:17408
    ds_read_b128 v[60:63], v12 offset:37888
    s_waitcnt lgkmcnt(2)
    v_mfma_f32_32x32x16_bf16 v[64:79], v[48:51], v[144:147], v[64:79]
    v_fmac_f32 v136, v7, v128
    v_fmac_f32 v137, v7, v129
    v_fmac_f32 v138, v7, v130
    v_fmac_f32 v139, v7, v131
    v_fmac_f32 v140, v7, v132
    v_fmac_f32 v141, v7, v133
    v_mfma_f32_32x32x16_bf16 v[96:111], v[52:55], v[144:147], v[96:111]
    v_fmac_f32 v142, v7, v134
    v_fmac_f32 v143, v7, v135
    v_cvt_pk_bf16_f32 v148, v136, v137
    v_cvt_pk_bf16_f32 v149, v138, v139
    v_cvt_pk_bf16_f32 v150, v140, v141
    v_cvt_pk_bf16_f32 v151, v142, v143
    ds_read_b128 v[40:43], v12 offset:18432
    ds_read_b128 v[44:47], v12 offset:38912
    s_waitcnt lgkmcnt(2)
    v_mfma_f32_32x32x16_bf16 v[80:95], v[56:59], v[148:151], v[80:95]
    v_fmac_f32 v128, v13, v136
    v_fmac_f32 v129, v13, v137
    v_fmac_f32 v130, v13, v138
    v_fmac_f32 v131, v13, v139
    v_fmac_f32 v132, v13, v140
    v_fmac_f32 v133, v13, v141
    v_mfma_f32_32x32x16_bf16 v[112:127], v[60:63], v[148:151], v[112:127]
    v_fmac_f32 v134, v13, v142
    v_fmac_f32 v135, v13, v143
    v_cvt_pk_bf16_f32 v144, v128, v129
    v_cvt_pk_bf16_f32 v145, v130, v131
    v_cvt_pk_bf16_f32 v146, v132, v133
    v_cvt_pk_bf16_f32 v147, v134, v135
    ds_read_b128 v[48:51], v12 offset:19456
    ds_read_b128 v[52:55], v12 offset:39936
    s_waitcnt lgkmcnt(2)
    v_mfma_f32_32x32x16_bf16 v[64:79], v[40:43], v[144:147], v[64:79]
    v_fmac_f32 v136, v7, v128
    v_fmac_f32 v137, v7, v129
    v_fmac_f32 v138, v7, v130
    v_fmac_f32 v139, v7, v131
    v_fmac_f32 v140, v7, v132
    v_fmac_f32 v141, v7, v133
    v_mfma_f32_32x32x16_bf16 v[96:111], v[44:47], v[144:147], v[96:111]
    v_fmac_f32 v142, v7, v134
    v_fmac_f32 v143, v7, v135
    v_cvt_pk_bf16_f32 v148, v136, v137
    v_cvt_pk_bf16_f32 v149, v138, v139
    v_cvt_pk_bf16_f32 v150, v140, v141
    v_cvt_pk_bf16_f32 v151, v142, v143
    s_nop 0
    s_waitcnt lgkmcnt(0)
    v_mfma_f32_32x32x16_bf16 v[80:95], v[48:51], v[148:151], v[80:95]
    v_mfma_f32_32x32x16_bf16 v[112:127], v[52:55], v[148:151], v[112:127]
    s_nop 0
    s_nop 5
    v_fmac_f32 v64, v16, v96
    v_fmac_f32 v65, v16, v97
    v_fmac_f32 v66, v16, v98
    v_fmac_f32 v67, v16, v99
    v_fmac_f32 v68, v16, v100
    v_fmac_f32 v69, v16, v101
    v_fmac_f32 v70, v16, v102
    v_fmac_f32 v71, v16, v103
    v_fmac_f32 v72, v16, v104
    v_fmac_f32 v73, v16, v105
    v_fmac_f32 v74, v16, v106
    v_fmac_f32 v75, v16, v107
    v_fmac_f32 v76, v16, v108
    v_fmac_f32 v77, v16, v109
    v_fmac_f32 v78, v16, v110
    v_fmac_f32 v79, v16, v111
    v_fmac_f32 v80, v16, v112
    v_fmac_f32 v81, v16, v113
    v_fmac_f32 v82, v16, v114
    v_fmac_f32 v83, v16, v115
    v_fmac_f32 v84, v16, v116
    v_fmac_f32 v85, v16, v117
    v_fmac_f32 v86, v16, v118
    v_fmac_f32 v87, v16, v119
    v_fmac_f32 v88, v16, v120
    v_fmac_f32 v89, v16, v121
    v_fmac_f32 v90, v16, v122
    v_fmac_f32 v91, v16, v123
    v_fmac_f32 v92, v16, v124
    v_fmac_f32 v93, v16, v125
    v_fmac_f32 v94, v16, v126
    v_fmac_f32 v95, v16, v127
    s_cmp_lg_u32 s36, 1
    s_cbranch_scc1 f1_plain
    s_mov_b32 exec_lo, 1
    s_mov_b32 exec_hi, 1
    v_sub_f32 v96, v64, v80
    v_add_f32 v80, v64, v80
    v_mul_f32 v64, 0.5, v96
    v_mul_f32 v80, 0.5, v80
    v_sub_f32 v97, v65, v81
    v_add_f32 v81, v65, v81
    v_mul_f32 v65, 0.5, v97
    v_mul_f32 v81, 0.5, v81
    v_sub_f32 v98, v66, v82
    v_add_f32 v82, v66, v82
    v_mul_f32 v66, 0.5, v98
    v_mul_f32 v82, 0.5, v82
    v_sub_f32 v99, v67, v83
    v_add_f32 v83, v67, v83
    v_mul_f32 v67, 0.5, v99
    v_mul_f32 v83, 0.5, v83
    v_sub_f32 v100, v68, v84
    v_add_f32 v84, v68, v84
    v_mul_f32 v68, 0.5, v100
    v_mul_f32 v84, 0.5, v84
    v_sub_f32 v101, v69, v85
    v_add_f32 v85, v69, v85
    v_mul_f32 v69, 0.5, v101
    v_mul_f32 v85, 0.5, v85
    v_sub_f32 v102, v70, v86
    v_add_f32 v86, v70, v86
    v_mul_f32 v70, 0.5, v102
    v_mul_f32 v86, 0.5, v86
    v_sub_f32 v103, v71, v87
    v_add_f32 v87, v71, v87
    v_mul_f32 v71, 0.5, v103
    v_mul_f32 v87, 0.5, v87
    v_sub_f32 v104, v72, v88
    v_add_f32 v88, v72, v88
    v_mul_f32 v72, 0.5, v104
    v_mul_f32 v88, 0.5, v88
    v_sub_f32 v105, v73, v89
    v_add_f32 v89, v73, v89
    v_mul_f32 v73, 0.5, v105
    v_mul_f32 v89, 0.5, v89
    v_sub_f32 v106, v74, v90
    v_add_f32 v90, v74, v90
    v_mul_f32 v74, 0.5, v106
    v_mul_f32 v90, 0.5, v90
    v_sub_f32 v107, v75, v91
    v_add_f32 v91, v75, v91
    v_mul_f32 v75, 0.5, v107
    v_mul_f32 v91, 0.5, v91
    v_sub_f32 v108, v76, v92
    v_add_f32 v92, v76, v92
    v_mul_f32 v76, 0.5, v108
    v_mul_f32 v92, 0.5, v92
    v_sub_f32 v109, v77, v93
    v_add_f32 v93, v77, v93
    v_mul_f32 v77, 0.5, v109
    v_mul_f32 v93, 0.5, v93
    v_sub_f32 v110, v78, v94
    v_add_f32 v94, v78, v94
    v_mul_f32 v78, 0.5, v110
    v_mul_f32 v94, 0.5, v94
    v_sub_f32 v111, v79, v95
    v_add_f32 v95, v79, v95
    v_mul_f32 v79, 0.5, v111
    v_mul_f32 v95, 0.5, v95
    s_mov_b64 exec, -1
f1_plain:
    v_sub_f32 v96, v64, v80
    v_sub_f32 v97, v65, v81
    v_sub_f32 v98, v66, v82
    v_sub_f32 v99, v67, v83
    v_sub_f32 v100, v68, v84
    v_sub_f32 v101, v69, v85
    v_sub_f32 v102, v70, v86
    v_sub_f32 v103, v71, v87
    v_sub_f32 v104, v72, v88
    v_sub_f32 v105, v73, v89
    v_sub_f32 v106, v74, v90
    v_sub_f32 v107, v75, v91
    v_sub_f32 v108, v76, v92
    v_sub_f32 v109, v77, v93
    v_sub_f32 v110, v78, v94
    v_sub_f32 v111, v79, v95
    v_add_f32 v64, v64, v80
    v_add_f32 v65, v65, v81
    v_add_f32 v66, v66, v82
    v_add_f32 v67, v67, v83
    v_add_f32 v68, v68, v84
    v_add_f32 v69, v69, v85
    v_add_f32 v70, v70, v86
    v_add_f32 v71, v71, v87
    v_add_f32 v72, v72, v88
    v_add_f32 v73, v73, v89
    v_add_f32 v74, v74, v90
    v_add_f32 v75, v75, v91
    v_add_f32 v76, v76, v92
    v_add_f32 v77, v77, v93
    v_add_f32 v78, v78, v94
    v_add_f32 v79, v79, v95
    v_cvt_pk_bf16_f32 v24, v64, v65
    v_cvt_pk_bf16_f32 v25, v66, v67
    v_cvt_pk_bf16_f32 v26, v68, v69
    v_cvt_pk_bf16_f32 v27, v70, v71
    v_cvt_pk_bf16_f32 v28, v72, v73
    v_cvt_pk_bf16_f32 v29, v74, v75
    v_cvt_pk_bf16_f32 v30, v76, v77
    v_cvt_pk_bf16_f32 v31, v78, v79
    ds_write_b128 v22, v[24:27]
    ds_write_b128 v23, v[28:31]
    ds_read_b128 v[152:155], v3
    ds_read_b128 v[156:159], v3 offset:1024
    v_cvt_pk_bf16_f32 v32, v96, v97
    v_cvt_pk_bf16_f32 v33, v98, v99
    v_cvt_pk_bf16_f32 v34, v100, v101
    v_cvt_pk_bf16_f32 v35, v102, v103
    v_cvt_pk_bf16_f32 v36, v104, v105
    v_cvt_pk_bf16_f32 v37, v106, v107
    v_cvt_pk_bf16_f32 v38, v108, v109
    v_cvt_pk_bf16_f32 v39, v110, v111
    v_xor_b32 v32, s31, v32
    v_xor_b32 v33, s31, v33
    v_xor_b32 v34, s31, v34
    v_xor_b32 v35, s31, v35
    v_xor_b32 v36, s31, v36
    v_xor_b32 v37, s31, v37
    v_xor_b32 v38, s31, v38
    v_xor_b32 v39, s31, v39
    s_waitcnt lgkmcnt(0)
    buffer_store_dwordx4 v[152:155], v18, s[12:15], s30 offen sc0 sc1
    buffer_store_dwordx4 v[156:159], v19, s[12:15], s30 offen sc0 sc1
    ds_write_b128 v22, v[32:35]
    ds_write_b128 v23, v[36:39]
    ds_read_b128 v[160:163], v3
    ds_read_b128 v[164:167], v3 offset:1024
    s_waitcnt lgkmcnt(0)
    buffer_store_dwordx4 v[160:163], v20, s[12:15], s30 offen sc0 sc1
    buffer_store_dwordx4 v[164:167], v21, s[12:15], s30 offen sc0 sc1
    s_add_u32 s36, s36, 4
    s_cmp_lt_u32 s36, 8
    s_cbranch_scc1 f1_unit
f1_unit_end:
    s_waitcnt vmcnt(0)
    s_barrier
    s_cmp_ge_u32 s16, 4
    s_cbranch_scc1 k_p2f
    s_cmp_lg_u32 s16, 0
    s_cbranch_scc1 k_ysig
    s_mov_b32 s28, 1
    s_mov_b32 s29, 29508864
    s_atomic_add s28, s[58:59], s29 glc
    s_waitcnt lgkmcnt(0)
    s_cmp_lg_u32 s28, 63
    s_cbranch_scc1 k_ysig
    s_mov_b32 s28, 1
    s_mov_b32 s29, 29507592
    s_atomic_add s28, s[58:59], s29
    s_mov_b32 s29, 29507720
    s_atomic_add s28, s[58:59], s29
    s_mov_b32 s29, 29507848
    s_atomic_add s28, s[58:59], s29
    s_mov_b32 s29, 29507976
    s_atomic_add s28, s[58:59], s29
    s_mov_b32 s29, 29508104
    s_atomic_add s28, s[58:59], s29
    s_mov_b32 s29, 29508232
    s_atomic_add s28, s[58:59], s29
    s_mov_b32 s29, 29508360
    s_atomic_add s28, s[58:59], s29
    s_mov_b32 s29, 29508488
    s_atomic_add s28, s[58:59], s29
k_ysig:
    s_and_b32 s28, s2, 7
    s_lshr_b32 s29, s2, 3
    s_and_b32 s18, s29, 7
    s_lshr_b32 s29, s29, 3
    s_and_b32 s3, s28, 1
    s_lshr_b32 s28, s28, 1
    s_lshl_b32 s28, s28, 2
    s_add_u32 s17, s28, s29
    s_lshl_b32 s17, s17, 1
    s_add_u32 s17, s17, s3
    s_and_b32 s19, s16, 3
    s_cmp_lg_u32 s2, 0
    s_cbranch_scc1 k_fg1
    s_cmp_lt_u32 s16, 2
    s_cbranch_scc1 k_fg0
    s_and_b32 s21, s19, 1
    s_lshl_b32 s22, s19, 13
    s_add_u32 s22, s22, 134912
    v_lshlrev_b32 v2, 4, v0
    v_add_u32 v3, s22, v2
    s_xor_b32 s28, s19, 1
    s_lshl_b32 s28, s28, 13
    s_add_u32 s28, s28, 134912
    v_add_u32 v4, s28, v2
    s_lshl_b32 s28, s19, 2
    s_add_u32 s28, s28, 163688
    v_mov_b32 v6, s28
    s_and_b32 s28, s28, -8
    v_and_b32 v5, 1, v0
    v_lshl_add_u32 v5, v5, 2, s28
    s_mov_b32 s4, s40
    s_mov_b32 s5, s41
    s_mov_b32 s6, 2621440
    s_mov_b32 s7, 0x20000
    s_mov_b32 s8, s54
    s_mov_b32 s9, s55
    s_mov_b32 s10, 2621440
    s_mov_b32 s11, 0x20000
    s_mov_b32 s12, s58
    s_mov_b32 s13, s59
    s_mov_b32 s14, 268435456
    s_mov_b32 s15, 0x20000
    s_movk_i32 s20, 320
    s_mov_b32 s60, 2
    s_branch k_p2e
k_fg0:
    s_add_u32 s27, s19, 2
    s_mov_b32 s36, s52
    s_mov_b32 s37, s53
    s_mov_b32 s38, 1966080
    s_mov_b32 s39, 0x20000
    s_mul_i32 s25, s18, 160
    s_mul_i32 s28, s3, 983040
    s_add_u32 s25, s25, s28
    s_lshl_b32 s21, s27, 10
    s_lshl_b32 s28, s27, 6
    v_add_u32 v16, s28, v0
    s_movk_i32 s29, 1120
    s_mov_b32 s30, 40960
    v_add_u32 v17, 0, v16
    v_mul_u32_u24 v18, 6554, v17
    v_lshrrev_b32 v18, 16, v18
    v_lshlrev_b32 v17, 4, v17
    v_mad_u32_u24 v17, v18, s29, v17
    v_lshrrev_b32 v18, 5, v18
    v_mad_u32_u24 v61, v18, s30, v17
    v_add_u32 v17, 256, v16
    v_mul_u32_u24 v18, 6554, v17
    v_lshrrev_b32 v18, 16, v18
    v_lshlrev_b32 v17, 4, v17
    v_mad_u32_u24 v17, v18, s29, v17
    v_lshrrev_b32 v18, 5, v18
    v_mad_u32_u24 v62, v18, s30, v17
    v_add_u32 v17, 512, v16
    v_mul_u32_u24 v18, 6554, v17
    v_lshrrev_b32 v18, 16, v18
    v_lshlrev_b32 v17, 4, v17
    v_mad_u32_u24 v17, v18, s29, v17
    v_lshrrev_b32 v18, 5, v18
    v_mad_u32_u24 v63, v18, s30, v17
    v_add_u32 v17, 768, v16
    v_mul_u32_u24 v18, 6554, v17
    v_lshrrev_b32 v18, 16, v18
    v_lshlrev_b32 v17, 4, v17
    v_mad_u32_u24 v17, v18, s29, v17
    v_lshrrev_b32 v18, 5, v18
    v_mad_u32_u24 v64, v18, s30, v17
    v_add_u32 v17, 1024, v16
    v_mul_u32_u24 v18, 6554, v17
    v_lshrrev_b32 v18, 16, v18
    v_lshlrev_b32 v17, 4, v17
    v_mad_u32_u24 v17, v18, s29, v17
    v_lshrrev_b32 v18, 5, v18
    v_mad_u32_u24 v65, v18, s30, v17
    v_and_b32 v16, 1, v0
    v_lshlrev_b32 v16, 2, v16
    v_add_u32 v16, 163752, v16
k_yiss00:
    ds_read_b32 v17, v16
    s_waitcnt lgkmcnt(0)
    v_cmp_gt_u32 vcc, 1, v17
    s_cbranch_vccz k_yiss00_out
    s_sleep 2
    s_sub_u32 s97, s97, 1
    s_cmp_gt_i32 s97, 0
    s_cbranch_scc1 k_yiss00
k_yiss00_out:
    v_and_b32 v16, 3, v0
    v_lshlrev_b32 v16, 2, v16
    v_add_u32 v16, 163760, v16
k_yiss0:
    ds_read_b32 v17, v16
    s_waitcnt lgkmcnt(0)
    v_cmp_gt_u32 vcc, 1, v17
    s_cbranch_vccz k_yiss0_out
    s_sleep 2
    s_sub_u32 s97, s97, 1
    s_cmp_gt_i32 s97, 0
    s_cbranch_scc1 k_yiss0
k_yiss0_out:
    s_add_u32 s24, s25, 0
    s_add_u32 m0, s21, 69376
    s_nop 0
    buffer_load_dwordx4 v61, s[36:39], s24 offen lds
    s_add_u32 m0, s21, 73472
    s_nop 0
    buffer_load_dwordx4 v62, s[36:39], s24 offen lds
    s_add_u32 m0, s21, 77568
    s_nop 0
    buffer_load_dwordx4 v63, s[36:39], s24 offen lds
    s_add_u32 m0, s21, 81664
    s_nop 0
    buffer_load_dwordx4 v64, s[36:39], s24 offen lds
    s_add_u32 m0, s21, 85760
    s_nop 0
    buffer_load_dwordx4 v65, s[36:39], s24 offen lds
    s_add_u32 s24, s25, 327680
    s_add_u32 m0, s21, 89856
    s_nop 0
    buffer_load_dwordx4 v61, s[36:39], s24 offen lds
    s_add_u32 m0, s21, 93952
    s_nop 0
    buffer_load_dwordx4 v62, s[36:39], s24 offen lds
    s_add_u32 m0, s21, 98048
    s_nop 0
    buffer_load_dwordx4 v63, s[36:39], s24 offen lds
    s_add_u32 m0, s21, 102144
    s_nop 0
    buffer_load_dwordx4 v64, s[36:39], s24 offen lds
    s_add_u32 m0, s21, 106240
    s_nop 0
    buffer_load_dwordx4 v65, s[36:39], s24 offen lds
    s_add_u32 s24, s25, 655360
    s_add_u32 m0, s21, 110336
    s_nop 0
    buffer_load_dwordx4 v61, s[36:39], s24 offen lds
    s_add_u32 m0, s21, 114432
    s_nop 0
    buffer_load_dwordx4 v62, s[36:39], s24 offen lds
    s_add_u32 m0, s21, 118528
    s_nop 0
    buffer_load_dwordx4 v63, s[36:39], s24 offen lds
    s_add_u32 m0, s21, 122624
    s_nop 0
    buffer_load_dwordx4 v64, s[36:39], s24 offen lds
    s_add_u32 m0, s21, 126720
    s_nop 0
    buffer_load_dwordx4 v65, s[36:39], s24 offen lds
    s_add_u32 s24, s25, 40960
    s_add_u32 m0, s21, 48896
    s_nop 0
    buffer_load_dwordx4 v61, s[36:39], s24 offen lds
    s_add_u32 m0, s21, 52992
    s_nop 0
    buffer_load_dwordx4 v62, s[36:39], s24 offen lds
    s_add_u32 m0, s21, 57088
    s_nop 0
    buffer_load_dwordx4 v63, s[36:39], s24 offen lds
    s_add_u32 m0, s21, 61184
    s_nop 0
    buffer_load_dwordx4 v64, s[36:39], s24 offen lds
    s_add_u32 m0, s21, 65280
    s_nop 0
    buffer_load_dwordx4 v65, s[36:39], s24 offen lds
    s_add_u32 s24, s25, 368640
    s_add_u32 m0, s21, 0
    s_nop 0
    buffer_load_dwordx4 v61, s[36:39], s24 offen lds
    s_add_u32 m0, s21, 4096
    s_nop 0
    buffer_load_dwordx4 v62, s[36:39], s24 offen lds
    s_add_u32 m0, s21, 8192
    s_nop 0
    buffer_load_dwordx4 v63, s[36:39], s24 offen lds
    s_add_u32 m0, s21, 12288
    s_nop 0
    buffer_load_dwordx4 v64, s[36:39], s24 offen lds
    s_add_u32 m0, s21, 16384
    s_nop 0
    buffer_load_dwordx4 v65, s[36:39], s24 offen lds
    s_add_u32 s24, s25, 696320
    s_add_u32 m0, s21, 20480
    s_nop 0
    buffer_load_dwordx4 v61, s[36:39], s24 offen lds
    s_add_u32 m0, s21, 24576
    s_nop 0
    buffer_load_dwordx4 v62, s[36:39], s24 offen lds
    s_add_u32 m0, s21, 28672
    s_nop 0
    buffer_load_dwordx4 v63, s[36:39], s24 offen lds
    s_add_u32 m0, s21, 32768
    s_nop 0
    buffer_load_dwordx4 v64, s[36:39], s24 offen lds
    s_add_u32 m0, s21, 36864
    s_nop 0
    buffer_load_dwordx4 v65, s[36:39], s24 offen lds
    s_waitcnt vmcnt(20)
k_fg1:
    s_mov_b32 s36, s52
    s_mov_b32 s37, s53
    s_mov_b32 s38, 1966080
    s_mov_b32 s39, 0x20000
    s_mul_i32 s25, s18, 160
    s_mul_i32 s28, s3, 983040
    s_add_u32 s25, s25, s28
    s_lshl_b32 s23, s19, 10
    s_lshl_b32 s28, s19, 6
    v_add_u32 v16, s28, v0
    s_movk_i32 s29, 1120
    s_mov_b32 s30, 40960
    v_add_u32 v17, 0, v16
    v_mul_u32_u24 v18, 6554, v17
    v_lshrrev_b32 v18, 16, v18
    v_lshlrev_b32 v17, 4, v17
    v_mad_u32_u24 v17, v18, s29, v17
    v_lshrrev_b32 v18, 5, v18
    v_mad_u32_u24 v8, v18, s30, v17
    v_add_u32 v17, 256, v16
    v_mul_u32_u24 v18, 6554, v17
    v_lshrrev_b32 v18, 16, v18
    v_lshlrev_b32 v17, 4, v17
    v_mad_u32_u24 v17, v18, s29, v17
    v_lshrrev_b32 v18, 5, v18
    v_mad_u32_u24 v9, v18, s30, v17
    v_add_u32 v17, 512, v16
    v_mul_u32_u24 v18, 6554, v17
    v_lshrrev_b32 v18, 16, v18
    v_lshlrev_b32 v17, 4, v17
    v_mad_u32_u24 v17, v18, s29, v17
    v_lshrrev_b32 v18, 5, v18
    v_mad_u32_u24 v10, v18, s30, v17
    v_add_u32 v17, 768, v16
    v_mul_u32_u24 v18, 6554, v17
    v_lshrrev_b32 v18, 16, v18
    v_lshlrev_b32 v17, 4, v17
    v_mad_u32_u24 v17, v18, s29, v17
    v_lshrrev_b32 v18, 5, v18
    v_mad_u32_u24 v11, v18, s30, v17
    v_add_u32 v17, 1024, v16
    v_mul_u32_u24 v18, 6554, v17
    v_lshrrev_b32 v18, 16, v18
    v_lshlrev_b32 v17, 4, v17
    v_mad_u32_u24 v17, v18, s29, v17
    v_lshrrev_b32 v18, 5, v18
    v_mad_u32_u24 v12, v18, s30, v17
    v_and_b32 v16, 3, v0
    v_lshlrev_b32 v16, 2, v16
    v_add_u32 v16, 163760, v16
k_yissued:
    ds_read_b32 v17, v16
    s_waitcnt lgkmcnt(0)
    v_cmp_gt_u32 vcc, 1, v17
    s_cbranch_vccz k_yissued_out
    s_sleep 2
    s_sub_u32 s97, s97, 1
    s_cmp_gt_i32 s97, 0
    s_cbranch_scc1 k_yissued
k_yissued_out:
    s_add_u32 s24, s25, 0
    s_add_u32 m0, s23, 69376
    s_nop 0
    buffer_load_dwordx4 v8, s[36:39], s24 offen lds
    s_add_u32 m0, s23, 73472
    s_nop 0
    buffer_load_dwordx4 v9, s[36:39], s24 offen lds
    s_add_u32 m0, s23, 77568
    s_nop 0
    buffer_load_dwordx4 v10, s[36:39], s24 offen lds
    s_add_u32 m0, s23, 81664
    s_nop 0
    buffer_load_dwordx4 v11, s[36:39], s24 offen lds
    s_add_u32 m0, s23, 85760
    s_nop 0
    buffer_load_dwordx4 v12, s[36:39], s24 offen lds
    s_add_u32 s24, s25, 327680
    s_add_u32 m0, s23, 89856
    s_nop 0
    buffer_load_dwordx4 v8, s[36:39], s24 offen lds
    s_add_u32 m0, s23, 93952
    s_nop 0
    buffer_load_dwordx4 v9, s[36:39], s24 offen lds
    s_add_u32 m0, s23, 98048
    s_nop 0
    buffer_load_dwordx4 v10, s[36:39], s24 offen lds
    s_add_u32 m0, s23, 102144
    s_nop 0
    buffer_load_dwordx4 v11, s[36:39], s24 offen lds
    s_add_u32 m0, s23, 106240
    s_nop 0
    buffer_load_dwordx4 v12, s[36:39], s24 offen lds
    s_add_u32 s24, s25, 655360
    s_add_u32 m0, s23, 110336
    s_nop 0
    buffer_load_dwordx4 v8, s[36:39], s24 offen lds
    s_add_u32 m0, s23, 114432
    s_nop 0
    buffer_load_dwordx4 v9, s[36:39], s24 offen lds
    s_add_u32 m0, s23, 118528
    s_nop 0
    buffer_load_dwordx4 v10, s[36:39], s24 offen lds
    s_add_u32 m0, s23, 122624
    s_nop 0
    buffer_load_dwordx4 v11, s[36:39], s24 offen lds
    s_add_u32 m0, s23, 126720
    s_nop 0
    buffer_load_dwordx4 v12, s[36:39], s24 offen lds
    s_add_u32 s24, s25, 40960
    s_add_u32 m0, s23, 48896
    s_nop 0
    buffer_load_dwordx4 v8, s[36:39], s24 offen lds
    s_add_u32 m0, s23, 52992
    s_nop 0
    buffer_load_dwordx4 v9, s[36:39], s24 offen lds
    s_add_u32 m0, s23, 57088
    s_nop 0
    buffer_load_dwordx4 v10, s[36:39], s24 offen lds
    s_add_u32 m0, s23, 61184
    s_nop 0
    buffer_load_dwordx4 v11, s[36:39], s24 offen lds
    s_add_u32 m0, s23, 65280
    s_nop 0
    buffer_load_dwordx4 v12, s[36:39], s24 offen lds
    s_add_u32 s24, s25, 368640
    s_add_u32 m0, s23, 0
    s_nop 0
    buffer_load_dwordx4 v8, s[36:39], s24 offen lds
    s_add_u32 m0, s23, 4096
    s_nop 0
    buffer_load_dwordx4 v9, s[36:39], s24 offen lds
    s_add_u32 m0, s23, 8192
    s_nop 0
    buffer_load_dwordx4 v10, s[36:39], s24 offen lds
    s_add_u32 m0, s23, 12288
    s_nop 0
    buffer_load_dwordx4 v11, s[36:39], s24 offen lds
    s_add_u32 m0, s23, 16384
    s_nop 0
    buffer_load_dwordx4 v12, s[36:39], s24 offen lds
    s_add_u32 s24, s25, 696320
    s_add_u32 m0, s23, 20480
    s_nop 0
    buffer_load_dwordx4 v8, s[36:39], s24 offen lds
    s_add_u32 m0, s23, 24576
    s_nop 0
    buffer_load_dwordx4 v9, s[36:39], s24 offen lds
    s_add_u32 m0, s23, 28672
    s_nop 0
    buffer_load_dwordx4 v10, s[36:39], s24 offen lds
    s_add_u32 m0, s23, 32768
    s_nop 0
    buffer_load_dwordx4 v11, s[36:39], s24 offen lds
    s_add_u32 m0, s23, 36864
    s_nop 0
    buffer_load_dwordx4 v12, s[36:39], s24 offen lds
k_fg3:
    v_lshlrev_b32 v2, 4, v0
    s_lshl_b32 s28, s17, 2
    s_add_u32 s28, s28, s19
    s_mul_i32 s29, s3, 24576
    s_add_u32 s29, s29, 0
    s_mul_i32 s20, s28, 50176
    s_add_u32 s20, s20, s29
    s_xor_b32 s28, s28, 4
    s_mul_i32 s21, s28, 50176
    s_add_u32 s21, s21, s29
    s_lshl_b32 s28, s19, 2
    s_add_u32 s28, s28, 163584
    v_mov_b32 v5, s28
    v_lshrrev_b32 v88, 5, v0
    v_lshlrev_b32 v88, 4, v88
    v_bfe_u32 v89, v0, 4, 1
    v_lshl_add_u32 v88, v89, 2, v88
    v_bfe_u32 v89, v0, 2, 2
    v_add_u32 v88, v88, v89
    v_mul_u32_u24 v88, 160, v88
    v_and_b32 v89, 3, v0
    v_lshl_add_u32 v3, v89, 3, v88
    v_add_u32 v4, 0x10000, v3
    s_min_u32 s29, s20, s21
    s_add_u32 s42, s29, 0
    s_add_u32 s43, s29, 4096
    s_add_u32 s44, s29, 8192
    s_add_u32 s45, s29, 12288
    s_add_u32 s46, s29, 16384
    s_add_u32 s47, s29, 20480
    s_sub_u32 s21, s21, s29
    v_add_u32 v93, s21, v2
    s_sub_u32 s20, s20, s29
    v_add_u32 v92, s20, v2
    v_mov_b32 v19, 1
    s_waitcnt vmcnt(0)
    ds_write_b32 v5, v19 offset:64
    s_cmp_gt_u32 s16, 0
    s_cbranch_scc1 k_p2g
    v_and_b32 v20, 3, v0
    v_lshlrev_b32 v20, 2, v20
    v_add_u32 v20, 163648, v20
k_fgfull:
    ds_read_b32 v24, v20
    s_waitcnt lgkmcnt(0)
    v_cmp_gt_u32 vcc, 1, v24
    s_cbranch_vccz k_fgfull_out
    s_sleep 1
    s_sub_u32 s97, s97, 1
    s_cmp_gt_i32 s97, 0
    s_cbranch_scc1 k_fgfull
k_fgfull_out:
    v_mov_b32 v16, 163640
    v_mov_b32 v17, 1
    ds_write_b32 v16, v17
    s_lshl_b32 s61, s17, 7
    s_add_u32 s61, s61, 29510656
    v_mov_b32 v16, 0
    v_mov_b32 v18, 24
k_h:
    buffer_load_dword v17, v16, s[12:15], s61 offen sc1
    s_waitcnt vmcnt(0)
    v_cmp_eq_u32 vcc, v17, v18
    s_cmp_eq_u64 vcc, -1
    s_cbranch_scc1 k_h_ok
    s_sleep 2
    s_sub_u32 s97, s97, 1
    s_cmp_gt_i32 s97, 0
    s_cbranch_scc1 k_h
k_h_ok:
    v_mov_b32 v16, 163636
    v_mov_b32 v17, 1
    ds_write_b32 v16, v17
k_p2g:
    s_setprio 2
    v_mov_b32 v20, 163636
k_hl:
    ds_read_b32 v17, v20
    s_waitcnt lgkmcnt(0)
    v_readfirstlane_b32 s28, v17
    s_cmp_lg_u32 s28, 0
    s_cbranch_scc1 k_hl_ok
    s_sleep 1
    s_sub_u32 s97, s97, 1
    s_cmp_gt_i32 s97, 0
    s_cbranch_scc1 k_hl
k_hl_ok:
    v_mov_b32 v6, 163640
    v_mov_b32 v89, 0
    s_lshl_b32 s27, s17, 7
    s_add_u32 s27, s27, 29514752
    buffer_load_dwordx4 v[96:99], v93, s[12:15], s42 offen offset:0
    buffer_load_dwordx4 v[100:103], v92, s[12:15], s42 offen offset:0
    buffer_load_dwordx4 v[104:107], v93, s[12:15], s42 offen offset:2048
    buffer_load_dwordx4 v[108:111], v92, s[12:15], s42 offen offset:2048
    buffer_load_dwordx4 v[112:115], v93, s[12:15], s43 offen offset:0
    buffer_load_dwordx4 v[116:119], v92, s[12:15], s43 offen offset:0
    buffer_load_dwordx4 v[120:123], v93, s[12:15], s43 offen offset:2048
    buffer_load_dwordx4 v[124:127], v92, s[12:15], s43 offen offset:2048
    buffer_load_dwordx4 v[128:131], v93, s[12:15], s44 offen offset:0
    buffer_load_dwordx4 v[132:135], v92, s[12:15], s44 offen offset:0
    ds_read_b64_tr_b16 v[48:49], v4 offset:3840
    ds_read_b64_tr_b16 v[50:51], v4 offset:5120
    ds_read_b64_tr_b16 v[52:53], v4 offset:3872
    ds_read_b64_tr_b16 v[54:55], v4 offset:5152
    ds_read_b64_tr_b16 v[56:57], v4 offset:3904
    ds_read_b64_tr_b16 v[58:59], v4 offset:5184
    ds_read_b64_tr_b16 v[60:61], v4 offset:3936
    ds_read_b64_tr_b16 v[62:63], v4 offset:5216
    ds_read_b64_tr_b16 v[64:65], v4 offset:3968
    ds_read_b64_tr_b16 v[66:67], v4 offset:5248
    s_xor_b32 s28, s2, 1
    s_lshl_b32 s29, s28, 2
    s_add_u32 s29, s29, s19
    s_mul_i32 s29, s29, 2560
    s_add_u32 s24, s29, 37748736
    s_add_u32 s25, s24, 4096
    s_lshl_b32 s28, s28, 7
    s_lshl_b32 s31, s19, 2
    s_add_u32 s28, s28, s31
    s_add_u32 s34, s28, 29518848
    s_lshl_b32 s29, s2, 2
    s_add_u32 s29, s29, s19
    s_mul_i32 s29, s29, 2560
    s_add_u32 s29, s29, 37748736
    s_add_u32 s30, s29, 4096
    s_lshl_b32 s35, s2, 7
    s_add_u32 s35, s35, s31
    s_add_u32 s35, s35, 29518848
    s_mul_i32 s31, s19, 5120
    s_add_u32 s31, s31, 0
    v_and_b32 v7, 15, v0
    v_mul_u32_u24 v7, 320, v7
    v_lshrrev_b32 v88, 4, v0
    v_bfe_u32 v90, v0, 1, 2
    v_xor_b32 v88, v88, v90
    v_lshl_add_u32 v7, v88, 4, v7
    v_add_u32 v7, s31, v7
    v_mov_b32 v89, 0
    v_lshlrev_b32 v94, 3, v0
    s_mov_b32 s26, 1
    s_waitcnt vmcnt(8)
    s_waitcnt lgkmcnt(6)
    v_mfma_f32_16x16x32_bf16 v[28:31], v[48:51], v[96:99], 0
    ds_read_b64_tr_b16 v[68:69], v4 offset:8960
    v_mfma_f32_16x16x32_bf16 v[8:11], v[48:51], v[100:103], 0
    ds_read_b64_tr_b16 v[70:71], v4 offset:10240
    buffer_load_dwordx4 v[136:139], v93, s[12:15], s44 offen offset:2048
    v_mfma_f32_16x16x32_bf16 v[32:35], v[52:55], v[96:99], 0
    ds_read_b64_tr_b16 v[72:73], v4 offset:8992
    v_mfma_f32_16x16x32_bf16 v[12:15], v[52:55], v[100:103], 0
    ds_read_b64_tr_b16 v[74:75], v4 offset:10272
    buffer_load_dwordx4 v[140:143], v92, s[12:15], s44 offen offset:2048
    s_waitcnt lgkmcnt(6)
    v_mfma_f32_16x16x32_bf16 v[36:39], v[56:59], v[96:99], 0
    ds_read_b64_tr_b16 v[76:77], v4 offset:9024
    v_mfma_f32_16x16x32_bf16 v[16:19], v[56:59], v[100:103], 0
    ds_read_b64_tr_b16 v[78:79], v4 offset:10304
    buffer_load_dwordx4 v[144:147], v93, s[12:15], s45 offen offset:0
    v_mfma_f32_16x16x32_bf16 v[40:43], v[60:63], v[96:99], 0
    ds_read_b64_tr_b16 v[80:81], v4 offset:9056
    v_mfma_f32_16x16x32_bf16 v[20:23], v[60:63], v[100:103], 0
    ds_read_b64_tr_b16 v[82:83], v4 offset:10336
    s_waitcnt lgkmcnt(8)
    v_mfma_f32_16x16x32_bf16 v[44:47], v[64:67], v[96:99], 0
    ds_read_b64_tr_b16 v[84:85], v4 offset:9088
    v_mfma_f32_16x16x32_bf16 v[24:27], v[64:67], v[100:103], 0
    ds_read_b64_tr_b16 v[86:87], v4 offset:10368
    s_waitcnt vmcnt(9)
    s_waitcnt lgkmcnt(6)
    v_mfma_f32_16x16x32_bf16 v[28:31], v[68:71], v[104:107], v[28:31]
    ds_read_b64_tr_b16 v[48:49], v4 offset:14080
    v_mfma_f32_16x16x32_bf16 v[8:11], v[68:71], v[108:111], v[8:11]
    ds_read_b64_tr_b16 v[50:51], v4 offset:15360
    buffer_load_dwordx4 v[148:151], v92, s[12:15], s45 offen offset:0
    v_mfma_f32_16x16x32_bf16 v[32:35], v[72:75], v[104:107], v[32:35]
    ds_read_b64_tr_b16 v[52:53], v4 offset:14112
    v_mfma_f32_16x16x32_bf16 v[12:15], v[72:75], v[108:111], v[12:15]
    ds_read_b64_tr_b16 v[54:55], v4 offset:15392
    buffer_load_dwordx4 v[152:155], v93, s[12:15], s45 offen offset:2048
    s_waitcnt lgkmcnt(6)
    v_mfma_f32_16x16x32_bf16 v[36:39], v[76:79], v[104:107], v[36:39]
    ds_read_b64_tr_b16 v[56:57], v4 offset:14144
    v_mfma_f32_16x16x32_bf16 v[16:19], v[76:79], v[108:111], v[16:19]
    ds_read_b64_tr_b16 v[58:59], v4 offset:15424
    buffer_load_dwordx4 v[156:159], v92, s[12:15], s45 offen offset:2048
    v_mfma_f32_16x16x32_bf16 v[40:43], v[80:83], v[104:107], v[40:43]
    ds_read_b64_tr_b16 v[60:61], v4 offset:14176
    v_mfma_f32_16x16x32_bf16 v[20:23], v[80:83], v[108:111], v[20:23]
    ds_read_b64_tr_b16 v[62:63], v4 offset:15456
    s_waitcnt lgkmcnt(8)
    v_mfma_f32_16x16x32_bf16 v[44:47], v[84:87], v[104:107], v[44:47]
    ds_read_b64_tr_b16 v[64:65], v4 offset:14208
    v_mfma_f32_16x16x32_bf16 v[24:27], v[84:87], v[108:111], v[24:27]
    ds_read_b64_tr_b16 v[66:67], v4 offset:15488
    s_waitcnt vmcnt(10)
    s_waitcnt lgkmcnt(6)
    v_mfma_f32_16x16x32_bf16 v[28:31], v[48:51], v[112:115], v[28:31]
    ds_read_b64_tr_b16 v[68:69], v4 offset:19200
    v_mfma_f32_16x16x32_bf16 v[8:11], v[48:51], v[116:119], v[8:11]
    ds_read_b64_tr_b16 v[70:71], v4 offset:20480
    buffer_load_dwordx4 v[160:163], v93, s[12:15], s46 offen offset:0
    v_mfma_f32_16x16x32_bf16 v[32:35], v[52:55], v[112:115], v[32:35]
    ds_read_b64_tr_b16 v[72:73], v4 offset:19232
    v_mfma_f32_16x16x32_bf16 v[12:15], v[52:55], v[116:119], v[12:15]
    ds_read_b64_tr_b16 v[74:75], v4 offset:20512
    buffer_load_dwordx4 v[164:167], v92, s[12:15], s46 offen offset:0
    s_waitcnt lgkmcnt(6)
    v_mfma_f32_16x16x32_bf16 v[36:39], v[56:59], v[112:115], v[36:39]
    ds_read_b64_tr_b16 v[76:77], v4 offset:19264
    v_mfma_f32_16x16x32_bf16 v[16:19], v[56:59], v[116:119], v[16:19]
    ds_read_b64_tr_b16 v[78:79], v4 offset:20544
    buffer_load_dwordx4 v[168:171], v93, s[12:15], s46 offen offset:2048
    v_mfma_f32_16x16x32_bf16 v[40:43], v[60:63], v[112:115], v[40:43]
    ds_read_b64_tr_b16 v[80:81], v4 offset:19296
    v_mfma_f32_16x16x32_bf16 v[20:23], v[60:63], v[116:119], v[20:23]
    ds_read_b64_tr_b16 v[82:83], v4 offset:20576
    s_waitcnt lgkmcnt(8)
    v_mfma_f32_16x16x32_bf16 v[44:47], v[64:67], v[112:115], v[44:47]
    ds_read_b64_tr_b16 v[84:85], v4 offset:19328
    v_mfma_f32_16x16x32_bf16 v[24:27], v[64:67], v[116:119], v[24:27]
    ds_read_b64_tr_b16 v[86:87], v4 offset:20608
    ds_read_b32 v91, v6
    buffer_load_dword v90, v89, s[12:15], s27 offen sc1
    s_waitcnt vmcnt(12)
    s_waitcnt lgkmcnt(7)
    v_mfma_f32_16x16x32_bf16 v[28:31], v[68:71], v[120:123], v[28:31]
    ds_read_b64_tr_b16 v[48:49], v4 offset:24320
    v_mfma_f32_16x16x32_bf16 v[8:11], v[68:71], v[124:127], v[8:11]
    ds_read_b64_tr_b16 v[50:51], v4 offset:25600
    buffer_load_dwordx4 v[172:175], v92, s[12:15], s46 offen offset:2048
    v_mfma_f32_16x16x32_bf16 v[32:35], v[72:75], v[120:123], v[32:35]
    ds_read_b64_tr_b16 v[52:53], v4 offset:24352
    v_mfma_f32_16x16x32_bf16 v[12:15], v[72:75], v[124:127], v[12:15]
    ds_read_b64_tr_b16 v[54:55], v4 offset:25632
    buffer_load_dwordx4 v[176:179], v93, s[12:15], s47 offen offset:0
    s_waitcnt lgkmcnt(7)
    v_mfma_f32_16x16x32_bf16 v[36:39], v[76:79], v[120:123], v[36:39]
    ds_read_b64_tr_b16 v[56:57], v4 offset:24384
    v_mfma_f32_16x16x32_bf16 v[16:19], v[76:79], v[124:127], v[16:19]
    ds_read_b64_tr_b16 v[58:59], v4 offset:25664
    buffer_load_dwordx4 v[180:183], v92, s[12:15], s47 offen offset:0
    v_mfma_f32_16x16x32_bf16 v[40:43], v[80:83], v[120:123], v[40:43]
    ds_read_b64_tr_b16 v[60:61], v4 offset:24416
    v_mfma_f32_16x16x32_bf16 v[20:23], v[80:83], v[124:127], v[20:23]
    ds_read_b64_tr_b16 v[62:63], v4 offset:25696
    s_waitcnt lgkmcnt(9)
    v_mfma_f32_16x16x32_bf16 v[44:47], v[84:87], v[120:123], v[44:47]
    ds_read_b64_tr_b16 v[64:65], v4 offset:24448
    v_mfma_f32_16x16x32_bf16 v[24:27], v[84:87], v[124:127], v[24:27]
    ds_read_b64_tr_b16 v[66:67], v4 offset:25728
    s_waitcnt vmcnt(13)
    s_waitcnt lgkmcnt(6)
    v_mfma_f32_16x16x32_bf16 v[28:31], v[48:51], v[128:131], v[28:31]
    ds_read_b64_tr_b16 v[68:69], v4 offset:29440
    v_mfma_f32_16x16x32_bf16 v[8:11], v[48:51], v[132:135], v[8:11]
    ds_read_b64_tr_b16 v[70:71], v4 offset:30720
    buffer_load_dwordx4 v[184:187], v93, s[12:15], s47 offen offset:2048
    v_mfma_f32_16x16x32_bf16 v[32:35], v[52:55], v[128:131], v[32:35]
    ds_read_b64_tr_b16 v[72:73], v4 offset:29472
    v_mfma_f32_16x16x32_bf16 v[12:15], v[52:55], v[132:135], v[12:15]
    ds_read_b64_tr_b16 v[74:75], v4 offset:30752
    buffer_load_dwordx4 v[188:191], v92, s[12:15], s47 offen offset:2048
    s_waitcnt lgkmcnt(6)
    v_mfma_f32_16x16x32_bf16 v[36:39], v[56:59], v[128:131], v[36:39]
    ds_read_b64_tr_b16 v[76:77], v4 offset:29504
    v_mfma_f32_16x16x32_bf16 v[16:19], v[56:59], v[132:135], v[16:19]
    ds_read_b64_tr_b16 v[78:79], v4 offset:30784
    v_mfma_f32_16x16x32_bf16 v[40:43], v[60:63], v[128:131], v[40:43]
    ds_read_b64_tr_b16 v[80:81], v4 offset:29536
    v_mfma_f32_16x16x32_bf16 v[20:23], v[60:63], v[132:135], v[20:23]
    ds_read_b64_tr_b16 v[82:83], v4 offset:30816
    s_waitcnt lgkmcnt(8)
    v_mfma_f32_16x16x32_bf16 v[44:47], v[64:67], v[128:131], v[44:47]
    ds_read_b64_tr_b16 v[84:85], v4 offset:29568
    v_mfma_f32_16x16x32_bf16 v[24:27], v[64:67], v[132:135], v[24:27]
    ds_read_b64_tr_b16 v[86:87], v4 offset:30848
    s_waitcnt vmcnt(13)
    s_waitcnt lgkmcnt(6)
    v_mfma_f32_16x16x32_bf16 v[28:31], v[68:71], v[136:139], v[28:31]
    ds_read_b64_tr_b16 v[48:49], v4 offset:34560
    v_mfma_f32_16x16x32_bf16 v[8:11], v[68:71], v[140:143], v[8:11]
    ds_read_b64_tr_b16 v[50:51], v4 offset:35840
    v_mfma_f32_16x16x32_bf16 v[32:35], v[72:75], v[136:139], v[32:35]
    ds_read_b64_tr_b16 v[52:53], v4 offset:34592
    v_mfma_f32_16x16x32_bf16 v[12:15], v[72:75], v[140:143], v[12:15]
    ds_read_b64_tr_b16 v[54:55], v4 offset:35872
    s_waitcnt lgkmcnt(6)
    v_mfma_f32_16x16x32_bf16 v[36:39], v[76:79], v[136:139], v[36:39]
    ds_read_b64_tr_b16 v[56:57], v4 offset:34624
    v_mfma_f32_16x16x32_bf16 v[16:19], v[76:79], v[140:143], v[16:19]
    ds_read_b64_tr_b16 v[58:59], v4 offset:35904
    v_mfma_f32_16x16x32_bf16 v[40:43], v[80:83], v[136:139], v[40:43]
    ds_read_b64_tr_b16 v[60:61], v4 offset:34656
    v_mfma_f32_16x16x32_bf16 v[20:23], v[80:83], v[140:143], v[20:23]
    ds_read_b64_tr_b16 v[62:63], v4 offset:35936
    s_waitcnt lgkmcnt(8)
    v_mfma_f32_16x16x32_bf16 v[44:47], v[84:87], v[136:139], v[44:47]
    ds_read_b64_tr_b16 v[64:65], v4 offset:34688
    v_mfma_f32_16x16x32_bf16 v[24:27], v[84:87], v[140:143], v[24:27]
    ds_read_b64_tr_b16 v[66:67], v4 offset:35968
    s_waitcnt vmcnt(11)
    s_waitcnt lgkmcnt(6)
    v_mfma_f32_16x16x32_bf16 v[28:31], v[48:51], v[144:147], v[28:31]
    ds_read_b64_tr_b16 v[68:69], v4 offset:39680
    v_mfma_f32_16x16x32_bf16 v[8:11], v[48:51], v[148:151], v[8:11]
    ds_read_b64_tr_b16 v[70:71], v4 offset:40960
    s_waitcnt vmcnt(5) lgkmcnt(8)
    v_mul_u32_u24 v91, v91, v90
    v_cmp_ne_u32 vcc, 24, v91
    s_cbranch_vccnz k_h2
k_h2b:
    buffer_load_dwordx4 v[192:195], v93, s[12:15], s42 offen offset:1024
    v_mfma_f32_16x16x32_bf16 v[32:35], v[52:55], v[144:147], v[32:35]
    ds_read_b64_tr_b16 v[72:73], v4 offset:39712
    v_mfma_f32_16x16x32_bf16 v[12:15], v[52:55], v[148:151], v[12:15]
    ds_read_b64_tr_b16 v[74:75], v4 offset:40992
    buffer_load_dwordx4 v[196:199], v93, s[12:15], s42 offen offset:3072
    s_waitcnt lgkmcnt(6)
    v_mfma_f32_16x16x32_bf16 v[36:39], v[56:59], v[144:147], v[36:39]
    ds_read_b64_tr_b16 v[76:77], v4 offset:39744
    v_mfma_f32_16x16x32_bf16 v[16:19], v[56:59], v[148:151], v[16:19]
    ds_read_b64_tr_b16 v[78:79], v4 offset:41024
    buffer_load_dwordx4 v[200:203], v93, s[12:15], s43 offen offset:1024
    v_mfma_f32_16x16x32_bf16 v[40:43], v[60:63], v[144:147], v[40:43]
    ds_read_b64_tr_b16 v[80:81], v4 offset:39776
    v_mfma_f32_16x16x32_bf16 v[20:23], v[60:63], v[148:151], v[20:23]
    ds_read_b64_tr_b16 v[82:83], v4 offset:41056
    s_waitcnt lgkmcnt(8)
    v_mfma_f32_16x16x32_bf16 v[44:47], v[64:67], v[144:147], v[44:47]
    ds_read_b64_tr_b16 v[84:85], v4 offset:39808
    v_mfma_f32_16x16x32_bf16 v[24:27], v[64:67], v[148:151], v[24:27]
    ds_read_b64_tr_b16 v[86:87], v4 offset:41088
    s_waitcnt lgkmcnt(6)
    v_mfma_f32_16x16x32_bf16 v[28:31], v[68:71], v[152:155], v[28:31]
    ds_read_b64_tr_b16 v[48:49], v4 offset:44800
    v_mfma_f32_16x16x32_bf16 v[8:11], v[68:71], v[156:159], v[8:11]
    ds_read_b64_tr_b16 v[50:51], v4 offset:46080
    buffer_load_dwordx4 v[204:207], v93, s[12:15], s43 offen offset:3072
    v_mfma_f32_16x16x32_bf16 v[32:35], v[72:75], v[152:155], v[32:35]
    ds_read_b64_tr_b16 v[52:53], v4 offset:44832
    v_mfma_f32_16x16x32_bf16 v[12:15], v[72:75], v[156:159], v[12:15]
    ds_read_b64_tr_b16 v[54:55], v4 offset:46112
    buffer_load_dwordx4 v[208:211], v93, s[12:15], s44 offen offset:1024
    s_waitcnt lgkmcnt(6)
    v_mfma_f32_16x16x32_bf16 v[36:39], v[76:79], v[152:155], v[36:39]
    ds_read_b64_tr_b16 v[56:57], v4 offset:44864
    v_mfma_f32_16x16x32_bf16 v[16:19], v[76:79], v[156:159], v[16:19]
    ds_read_b64_tr_b16 v[58:59], v4 offset:46144
    buffer_load_dwordx4 v[212:215], v93, s[12:15], s44 offen offset:3072
    v_mfma_f32_16x16x32_bf16 v[40:43], v[80:83], v[152:155], v[40:43]
    ds_read_b64_tr_b16 v[60:61], v4 offset:44896
    v_mfma_f32_16x16x32_bf16 v[20:23], v[80:83], v[156:159], v[20:23]
    ds_read_b64_tr_b16 v[62:63], v4 offset:46176
    s_waitcnt lgkmcnt(8)
    v_mfma_f32_16x16x32_bf16 v[44:47], v[84:87], v[152:155], v[44:47]
    ds_read_b64_tr_b16 v[64:65], v4 offset:44928
    v_mfma_f32_16x16x32_bf16 v[24:27], v[84:87], v[156:159], v[24:27]
    ds_read_b64_tr_b16 v[66:67], v4 offset:46208
    s_waitcnt lgkmcnt(6)
    v_mfma_f32_16x16x32_bf16 v[28:31], v[48:51], v[160:163], v[28:31]
    ds_read_b64_tr_b16 v[68:69], v4 offset:49920
    v_mfma_f32_16x16x32_bf16 v[8:11], v[48:51], v[164:167], v[8:11]
    ds_read_b64_tr_b16 v[70:71], v4 offset:51200
    buffer_load_dwordx4 v[216:219], v93, s[12:15], s45 offen offset:1024
    v_mfma_f32_16x16x32_bf16 v[32:35], v[52:55], v[160:163], v[32:35]
    ds_read_b64_tr_b16 v[72:73], v4 offset:49952
    v_mfma_f32_16x16x32_bf16 v[12:15], v[52:55], v[164:167], v[12:15]
    ds_read_b64_tr_b16 v[74:75], v4 offset:51232
    buffer_load_dwordx4 v[220:223], v93, s[12:15], s45 offen offset:3072
    s_waitcnt lgkmcnt(6)
    v_mfma_f32_16x16x32_bf16 v[36:39], v[56:59], v[160:163], v[36:39]
    ds_read_b64_tr_b16 v[76:77], v4 offset:49984
    v_mfma_f32_16x16x32_bf16 v[16:19], v[56:59], v[164:167], v[16:19]
    ds_read_b64_tr_b16 v[78:79], v4 offset:51264
    buffer_load_dwordx4 v[224:227], v93, s[12:15], s46 offen offset:1024
    v_mfma_f32_16x16x32_bf16 v[40:43], v[60:63], v[160:163], v[40:43]
    ds_read_b64_tr_b16 v[80:81], v4 offset:50016
    v_mfma_f32_16x16x32_bf16 v[20:23], v[60:63], v[164:167], v[20:23]
    ds_read_b64_tr_b16 v[82:83], v4 offset:51296
    s_waitcnt lgkmcnt(8)
    v_mfma_f32_16x16x32_bf16 v[44:47], v[64:67], v[160:163], v[44:47]
    ds_read_b64_tr_b16 v[84:85], v4 offset:50048
    v_mfma_f32_16x16x32_bf16 v[24:27], v[64:67], v[164:167], v[24:27]
    ds_read_b64_tr_b16 v[86:87], v4 offset:51328
    s_waitcnt vmcnt(13)
    s_waitcnt lgkmcnt(6)
    v_mfma_f32_16x16x32_bf16 v[28:31], v[68:71], v[168:171], v[28:31]
    ds_read_b64_tr_b16 v[48:49], v4 offset:55040
    v_mfma_f32_16x16x32_bf16 v[8:11], v[68:71], v[172:175], v[8:11]
    ds_read_b64_tr_b16 v[50:51], v4 offset:56320
    buffer_load_dwordx4 v[228:231], v93, s[12:15], s46 offen offset:3072
    v_mfma_f32_16x16x32_bf16 v[32:35], v[72:75], v[168:171], v[32:35]
    ds_read_b64_tr_b16 v[52:53], v4 offset:55072
    v_mfma_f32_16x16x32_bf16 v[12:15], v[72:75], v[172:175], v[12:15]
    ds_read_b64_tr_b16 v[54:55], v4 offset:56352
    buffer_load_dwordx4 v[232:235], v93, s[12:15], s47 offen offset:1024
    s_waitcnt lgkmcnt(6)
    v_mfma_f32_16x16x32_bf16 v[36:39], v[76:79], v[168:171], v[36:39]
    ds_read_b64_tr_b16 v[56:57], v4 offset:55104
    v_mfma_f32_16x16x32_bf16 v[16:19], v[76:79], v[172:175], v[16:19]
    ds_read_b64_tr_b16 v[58:59], v4 offset:56384
    buffer_load_dwordx4 v[236:239], v93, s[12:15], s47 offen offset:3072
    v_mfma_f32_16x16x32_bf16 v[40:43], v[80:83], v[168:171], v[40:43]
    ds_read_b64_tr_b16 v[60:61], v4 offset:55136
    v_mfma_f32_16x16x32_bf16 v[20:23], v[80:83], v[172:175], v[20:23]
    ds_read_b64_tr_b16 v[62:63], v4 offset:56416
    s_waitcnt lgkmcnt(8)
    v_mfma_f32_16x16x32_bf16 v[44:47], v[84:87], v[168:171], v[44:47]
    ds_read_b64_tr_b16 v[64:65], v4 offset:55168
    v_mfma_f32_16x16x32_bf16 v[24:27], v[84:87], v[172:175], v[24:27]
    ds_read_b64_tr_b16 v[66:67], v4 offset:56448
    s_waitcnt vmcnt(14)
    s_waitcnt lgkmcnt(6)
    v_mfma_f32_16x16x32_bf16 v[28:31], v[48:51], v[176:179], v[28:31]
    ds_read_b64_tr_b16 v[68:69], v4 offset:60160
    v_mfma_f32_16x16x32_bf16 v[8:11], v[48:51], v[180:183], v[8:11]
    ds_read_b64_tr_b16 v[70:71], v4 offset:61440
    buffer_load_dwordx4 v[240:243], v92, s[12:15], s42 offen offset:1024
    v_mfma_f32_16x16x32_bf16 v[32:35], v[52:55], v[176:179], v[32:35]
    ds_read_b64_tr_b16 v[72:73], v4 offset:60192
    v_mfma_f32_16x16x32_bf16 v[12:15], v[52:55], v[180:183], v[12:15]
    ds_read_b64_tr_b16 v[74:75], v4 offset:61472
    buffer_load_dwordx4 v[244:247], v92, s[12:15], s42 offen offset:3072
    s_waitcnt lgkmcnt(6)
    v_mfma_f32_16x16x32_bf16 v[36:39], v[56:59], v[176:179], v[36:39]
    ds_read_b64_tr_b16 v[76:77], v4 offset:60224
    v_mfma_f32_16x16x32_bf16 v[16:19], v[56:59], v[180:183], v[16:19]
    ds_read_b64_tr_b16 v[78:79], v4 offset:61504
    buffer_load_dwordx4 v[248:251], v92, s[12:15], s43 offen offset:1024
    v_mfma_f32_16x16x32_bf16 v[40:43], v[60:63], v[176:179], v[40:43]
    ds_read_b64_tr_b16 v[80:81], v4 offset:60256
    v_mfma_f32_16x16x32_bf16 v[20:23], v[60:63], v[180:183], v[20:23]
    ds_read_b64_tr_b16 v[82:83], v4 offset:61536
    s_waitcnt lgkmcnt(8)
    v_mfma_f32_16x16x32_bf16 v[44:47], v[64:67], v[176:179], v[44:47]
    ds_read_b64_tr_b16 v[84:85], v4 offset:60288
    v_mfma_f32_16x16x32_bf16 v[24:27], v[64:67], v[180:183], v[24:27]
    ds_read_b64_tr_b16 v[86:87], v4 offset:61568
    s_waitcnt vmcnt(15)
    s_waitcnt lgkmcnt(6)
    v_mfma_f32_16x16x32_bf16 v[28:31], v[68:71], v[184:187], v[28:31]
    ds_read_b64_tr_b16 v[48:49], v3 offset:48896
    v_mfma_f32_16x16x32_bf16 v[8:11], v[68:71], v[188:191], v[8:11]
    ds_read_b64_tr_b16 v[50:51], v3 offset:50176
    buffer_load_dwordx4 v[252:255], v92, s[12:15], s43 offen offset:3072
    v_mfma_f32_16x16x32_bf16 v[32:35], v[72:75], v[184:187], v[32:35]
    ds_read_b64_tr_b16 v[52:53], v3 offset:48928
    v_mfma_f32_16x16x32_bf16 v[12:15], v[72:75], v[188:191], v[12:15]
    ds_read_b64_tr_b16 v[54:55], v3 offset:50208
    buffer_load_dwordx4 v[96:99], v92, s[12:15], s44 offen offset:1024
    s_waitcnt lgkmcnt(6)
    v_mfma_f32_16x16x32_bf16 v[36:39], v[76:79], v[184:187], v[36:39]
    ds_read_b64_tr_b16 v[56:57], v3 offset:48960
    v_mfma_f32_16x16x32_bf16 v[16:19], v[76:79], v[188:191], v[16:19]
    ds_read_b64_tr_b16 v[58:59], v3 offset:50240
    buffer_load_dwordx4 v[100:103], v92, s[12:15], s44 offen offset:3072
    v_mfma_f32_16x16x32_bf16 v[40:43], v[80:83], v[184:187], v[40:43]
    ds_read_b64_tr_b16 v[60:61], v3 offset:48992
    v_mfma_f32_16x16x32_bf16 v[20:23], v[80:83], v[188:191], v[20:23]
    ds_read_b64_tr_b16 v[62:63], v3 offset:50272
    s_waitcnt lgkmcnt(8)
    v_mfma_f32_16x16x32_bf16 v[44:47], v[84:87], v[184:187], v[44:47]
    ds_read_b64_tr_b16 v[64:65], v3 offset:49024
    v_mfma_f32_16x16x32_bf16 v[24:27], v[84:87], v[188:191], v[24:27]
    ds_read_b64_tr_b16 v[66:67], v3 offset:50304
    v_mov_b32 v88, 1
    ds_write_b32 v5, v88
    s_waitcnt vmcnt(16)
    s_waitcnt lgkmcnt(7)
    v_mfma_f32_16x16x32_bf16 v[28:31], v[48:51], v[192:195], v[28:31]
    ds_read_b64_tr_b16 v[68:69], v3 offset:54016
    ds_read_b64_tr_b16 v[70:71], v3 offset:55296
    buffer_load_dwordx4 v[104:107], v92, s[12:15], s45 offen offset:1024
    v_mfma_f32_16x16x32_bf16 v[32:35], v[52:55], v[192:195], v[32:35]
    ds_read_b64_tr_b16 v[72:73], v3 offset:54048
    ds_read_b64_tr_b16 v[74:75], v3 offset:55328
    buffer_load_dwordx4 v[108:111], v92, s[12:15], s45 offen offset:3072
    s_waitcnt lgkmcnt(7)
    v_mfma_f32_16x16x32_bf16 v[36:39], v[56:59], v[192:195], v[36:39]
    ds_read_b64_tr_b16 v[76:77], v3 offset:54080
    ds_read_b64_tr_b16 v[78:79], v3 offset:55360
    v_mfma_f32_16x16x32_bf16 v[40:43], v[60:63], v[192:195], v[40:43]
    ds_read_b64_tr_b16 v[80:81], v3 offset:54112
    ds_read_b64_tr_b16 v[82:83], v3 offset:55392
    s_waitcnt lgkmcnt(9)
    v_mfma_f32_16x16x32_bf16 v[44:47], v[64:67], v[192:195], v[44:47]
    ds_read_b64_tr_b16 v[84:85], v3 offset:54144
    ds_read_b64_tr_b16 v[86:87], v3 offset:55424
    s_waitcnt lgkmcnt(6)
    v_mfma_f32_16x16x32_bf16 v[28:31], v[68:71], v[196:199], v[28:31]
    ds_read_b64_tr_b16 v[48:49], v3 offset:59136
    ds_read_b64_tr_b16 v[50:51], v3 offset:60416
    buffer_load_dwordx4 v[112:115], v92, s[12:15], s46 offen offset:1024
    v_mfma_f32_16x16x32_bf16 v[32:35], v[72:75], v[196:199], v[32:35]
    ds_read_b64_tr_b16 v[52:53], v3 offset:59168
    ds_read_b64_tr_b16 v[54:55], v3 offset:60448
    buffer_load_dwordx4 v[116:119], v92, s[12:15], s46 offen offset:3072
    s_waitcnt lgkmcnt(6)
    v_mfma_f32_16x16x32_bf16 v[36:39], v[76:79], v[196:199], v[36:39]
    ds_read_b64_tr_b16 v[56:57], v3 offset:59200
    ds_read_b64_tr_b16 v[58:59], v3 offset:60480
    v_mfma_f32_16x16x32_bf16 v[40:43], v[80:83], v[196:199], v[40:43]
    ds_read_b64_tr_b16 v[60:61], v3 offset:59232
    ds_read_b64_tr_b16 v[62:63], v3 offset:60512
    s_waitcnt lgkmcnt(8)
    v_mfma_f32_16x16x32_bf16 v[44:47], v[84:87], v[196:199], v[44:47]
    ds_read_b64_tr_b16 v[64:65], v3 offset:59264
    ds_read_b64_tr_b16 v[66:67], v3 offset:60544
    s_waitcnt vmcnt(18)
    s_waitcnt lgkmcnt(6)
    v_mfma_f32_16x16x32_bf16 v[28:31], v[48:51], v[200:203], v[28:31]
    ds_read_b64_tr_b16 v[68:69], v3 offset:64256
    ds_read_b64_tr_b16 v[70:71], v4 offset:0
    buffer_load_dwordx4 v[120:123], v92, s[12:15], s47 offen offset:1024
    v_mfma_f32_16x16x32_bf16 v[32:35], v[52:55], v[200:203], v[32:35]
    ds_read_b64_tr_b16 v[72:73], v3 offset:64288
    ds_read_b64_tr_b16 v[74:75], v4 offset:32
    buffer_load_dwordx4 v[124:127], v92, s[12:15], s47 offen offset:3072
    s_waitcnt lgkmcnt(6)
    v_mfma_f32_16x16x32_bf16 v[36:39], v[56:59], v[200:203], v[36:39]
    ds_read_b64_tr_b16 v[76:77], v3 offset:64320
    ds_read_b64_tr_b16 v[78:79], v4 offset:64
    v_mfma_f32_16x16x32_bf16 v[40:43], v[60:63], v[200:203], v[40:43]
    ds_read_b64_tr_b16 v[80:81], v3 offset:64352
    ds_read_b64_tr_b16 v[82:83], v4 offset:96
    s_waitcnt lgkmcnt(8)
    v_mfma_f32_16x16x32_bf16 v[44:47], v[64:67], v[200:203], v[44:47]
    ds_read_b64_tr_b16 v[84:85], v3 offset:64384
    ds_read_b64_tr_b16 v[86:87], v4 offset:128
    s_waitcnt lgkmcnt(6)
    v_mfma_f32_16x16x32_bf16 v[28:31], v[68:71], v[204:207], v[28:31]
    ds_read_b64_tr_b16 v[48:49], v3 offset:0
    ds_read_b64_tr_b16 v[50:51], v3 offset:1280
    v_mfma_f32_16x16x32_bf16 v[32:35], v[72:75], v[204:207], v[32:35]
    ds_read_b64_tr_b16 v[52:53], v3 offset:32
    ds_read_b64_tr_b16 v[54:55], v3 offset:1312
    s_waitcnt lgkmcnt(6)
    v_mfma_f32_16x16x32_bf16 v[36:39], v[76:79], v[204:207], v[36:39]
    ds_read_b64_tr_b16 v[56:57], v3 offset:64
    ds_read_b64_tr_b16 v[58:59], v3 offset:1344
    v_mfma_f32_16x16x32_bf16 v[40:43], v[80:83], v[204:207], v[40:43]
    ds_read_b64_tr_b16 v[60:61], v3 offset:96
    ds_read_b64_tr_b16 v[62:63], v3 offset:1376
    s_waitcnt lgkmcnt(8)
    v_mfma_f32_16x16x32_bf16 v[44:47], v[84:87], v[204:207], v[44:47]
    ds_read_b64_tr_b16 v[64:65], v3 offset:128
    ds_read_b64_tr_b16 v[66:67], v3 offset:1408
    s_waitcnt vmcnt(18)
    s_waitcnt lgkmcnt(6)
    v_mfma_f32_16x16x32_bf16 v[28:31], v[48:51], v[208:211], v[28:31]
    ds_read_b64_tr_b16 v[68:69], v3 offset:5120
    ds_read_b64_tr_b16 v[70:71], v3 offset:6400
    v_mfma_f32_16x16x32_bf16 v[32:35], v[52:55], v[208:211], v[32:35]
    ds_read_b64_tr_b16 v[72:73], v3 offset:5152
    ds_read_b64_tr_b16 v[74:75], v3 offset:6432
    s_waitcnt lgkmcnt(6)
    v_mfma_f32_16x16x32_bf16 v[36:39], v[56:59], v[208:211], v[36:39]
    ds_read_b64_tr_b16 v[76:77], v3 offset:5184
    ds_read_b64_tr_b16 v[78:79], v3 offset:6464
    v_mfma_f32_16x16x32_bf16 v[40:43], v[60:63], v[208:211], v[40:43]
    ds_read_b64_tr_b16 v[80:81], v3 offset:5216
    ds_read_b64_tr_b16 v[82:83], v3 offset:6496
    s_waitcnt lgkmcnt(8)
    v_mfma_f32_16x16x32_bf16 v[44:47], v[64:67], v[208:211], v[44:47]
    ds_read_b64_tr_b16 v[84:85], v3 offset:5248
    ds_read_b64_tr_b16 v[86:87], v3 offset:6528
    s_waitcnt lgkmcnt(6)
    v_mfma_f32_16x16x32_bf16 v[28:31], v[68:71], v[212:215], v[28:31]
    ds_read_b64_tr_b16 v[48:49], v3 offset:10240
    ds_read_b64_tr_b16 v[50:51], v3 offset:11520
    v_mfma_f32_16x16x32_bf16 v[32:35], v[72:75], v[212:215], v[32:35]
    ds_read_b64_tr_b16 v[52:53], v3 offset:10272
    ds_read_b64_tr_b16 v[54:55], v3 offset:11552
    s_waitcnt lgkmcnt(6)
    v_mfma_f32_16x16x32_bf16 v[36:39], v[76:79], v[212:215], v[36:39]
    ds_read_b64_tr_b16 v[56:57], v3 offset:10304
    ds_read_b64_tr_b16 v[58:59], v3 offset:11584
    v_mfma_f32_16x16x32_bf16 v[40:43], v[80:83], v[212:215], v[40:43]
    ds_read_b64_tr_b16 v[60:61], v3 offset:10336
    ds_read_b64_tr_b16 v[62:63], v3 offset:11616
    s_waitcnt lgkmcnt(8)
    v_mfma_f32_16x16x32_bf16 v[44:47], v[84:87], v[212:215], v[44:47]
    ds_read_b64_tr_b16 v[64:65], v3 offset:10368
    ds_read_b64_tr_b16 v[66:67], v3 offset:11648
    s_waitcnt vmcnt(16)
    s_waitcnt lgkmcnt(6)
    v_mfma_f32_16x16x32_bf16 v[28:31], v[48:51], v[216:219], v[28:31]
    ds_read_b64_tr_b16 v[68:69], v3 offset:15360
    ds_read_b64_tr_b16 v[70:71], v3 offset:16640
    v_mfma_f32_16x16x32_bf16 v[32:35], v[52:55], v[216:219], v[32:35]
    ds_read_b64_tr_b16 v[72:73], v3 offset:15392
    ds_read_b64_tr_b16 v[74:75], v3 offset:16672
    s_waitcnt lgkmcnt(6)
    v_mfma_f32_16x16x32_bf16 v[36:39], v[56:59], v[216:219], v[36:39]
    ds_read_b64_tr_b16 v[76:77], v3 offset:15424
    ds_read_b64_tr_b16 v[78:79], v3 offset:16704
    v_mfma_f32_16x16x32_bf16 v[40:43], v[60:63], v[216:219], v[40:43]
    ds_read_b64_tr_b16 v[80:81], v3 offset:15456
    ds_read_b64_tr_b16 v[82:83], v3 offset:16736
    s_waitcnt lgkmcnt(8)
    v_mfma_f32_16x16x32_bf16 v[44:47], v[64:67], v[216:219], v[44:47]
    ds_read_b64_tr_b16 v[84:85], v3 offset:15488
    ds_read_b64_tr_b16 v[86:87], v3 offset:16768
    s_waitcnt lgkmcnt(6)
    v_mfma_f32_16x16x32_bf16 v[28:31], v[68:71], v[220:223], v[28:31]
    ds_read_b64_tr_b16 v[48:49], v3 offset:20480
    ds_read_b64_tr_b16 v[50:51], v3 offset:21760
    v_mfma_f32_16x16x32_bf16 v[32:35], v[72:75], v[220:223], v[32:35]
    ds_read_b64_tr_b16 v[52:53], v3 offset:20512
    ds_read_b64_tr_b16 v[54:55], v3 offset:21792
    s_waitcnt lgkmcnt(6)
    v_mfma_f32_16x16x32_bf16 v[36:39], v[76:79], v[220:223], v[36:39]
    ds_read_b64_tr_b16 v[56:57], v3 offset:20544
    ds_read_b64_tr_b16 v[58:59], v3 offset:21824
    v_mfma_f32_16x16x32_bf16 v[40:43], v[80:83], v[220:223], v[40:43]
    ds_read_b64_tr_b16 v[60:61], v3 offset:20576
    ds_read_b64_tr_b16 v[62:63], v3 offset:21856
    s_waitcnt lgkmcnt(8)
    v_mfma_f32_16x16x32_bf16 v[44:47], v[84:87], v[220:223], v[44:47]
    ds_read_b64_tr_b16 v[64:65], v3 offset:20608
    ds_read_b64_tr_b16 v[66:67], v3 offset:21888
    s_waitcnt vmcnt(14)
    s_waitcnt lgkmcnt(6)
    v_mfma_f32_16x16x32_bf16 v[28:31], v[48:51], v[224:227], v[28:31]
    ds_read_b64_tr_b16 v[68:69], v3 offset:25600
    ds_read_b64_tr_b16 v[70:71], v3 offset:26880
    v_mfma_f32_16x16x32_bf16 v[32:35], v[52:55], v[224:227], v[32:35]
    ds_read_b64_tr_b16 v[72:73], v3 offset:25632
    ds_read_b64_tr_b16 v[74:75], v3 offset:26912
    s_waitcnt lgkmcnt(6)
    v_mfma_f32_16x16x32_bf16 v[36:39], v[56:59], v[224:227], v[36:39]
    ds_read_b64_tr_b16 v[76:77], v3 offset:25664
    ds_read_b64_tr_b16 v[78:79], v3 offset:26944
    v_mfma_f32_16x16x32_bf16 v[40:43], v[60:63], v[224:227], v[40:43]
    ds_read_b64_tr_b16 v[80:81], v3 offset:25696
    ds_read_b64_tr_b16 v[82:83], v3 offset:26976
    s_waitcnt lgkmcnt(8)
    v_mfma_f32_16x16x32_bf16 v[44:47], v[64:67], v[224:227], v[44:47]
    ds_read_b64_tr_b16 v[84:85], v3 offset:25728
    ds_read_b64_tr_b16 v[86:87], v3 offset:27008
    s_waitcnt lgkmcnt(6)
    v_mfma_f32_16x16x32_bf16 v[28:31], v[68:71], v[228:231], v[28:31]
    ds_read_b64_tr_b16 v[48:49], v3 offset:30720
    ds_read_b64_tr_b16 v[50:51], v3 offset:32000
    v_mfma_f32_16x16x32_bf16 v[32:35], v[72:75], v[228:231], v[32:35]
    ds_read_b64_tr_b16 v[52:53], v3 offset:30752
    ds_read_b64_tr_b16 v[54:55], v3 offset:32032
    s_waitcnt lgkmcnt(6)
    v_mfma_f32_16x16x32_bf16 v[36:39], v[76:79], v[228:231], v[36:39]
    ds_read_b64_tr_b16 v[56:57], v3 offset:30784
    ds_read_b64_tr_b16 v[58:59], v3 offset:32064
    v_mfma_f32_16x16x32_bf16 v[40:43], v[80:83], v[228:231], v[40:43]
    ds_read_b64_tr_b16 v[60:61], v3 offset:30816
    ds_read_b64_tr_b16 v[62:63], v3 offset:32096
    s_waitcnt lgkmcnt(8)
    v_mfma_f32_16x16x32_bf16 v[44:47], v[84:87], v[228:231], v[44:47]
    ds_read_b64_tr_b16 v[64:65], v3 offset:30848
    ds_read_b64_tr_b16 v[66:67], v3 offset:32128
    s_waitcnt vmcnt(12)
    s_waitcnt lgkmcnt(6)
    v_mfma_f32_16x16x32_bf16 v[28:31], v[48:51], v[232:235], v[28:31]
    ds_read_b64_tr_b16 v[68:69], v3 offset:35840
    ds_read_b64_tr_b16 v[70:71], v3 offset:37120
    v_mfma_f32_16x16x32_bf16 v[32:35], v[52:55], v[232:235], v[32:35]
    ds_read_b64_tr_b16 v[72:73], v3 offset:35872
    ds_read_b64_tr_b16 v[74:75], v3 offset:37152
    s_waitcnt lgkmcnt(6)
    v_mfma_f32_16x16x32_bf16 v[36:39], v[56:59], v[232:235], v[36:39]
    ds_read_b64_tr_b16 v[76:77], v3 offset:35904
    ds_read_b64_tr_b16 v[78:79], v3 offset:37184
    v_mfma_f32_16x16x32_bf16 v[40:43], v[60:63], v[232:235], v[40:43]
    ds_read_b64_tr_b16 v[80:81], v3 offset:35936
    ds_read_b64_tr_b16 v[82:83], v3 offset:37216
    s_waitcnt lgkmcnt(8)
    v_mfma_f32_16x16x32_bf16 v[44:47], v[64:67], v[232:235], v[44:47]
    ds_read_b64_tr_b16 v[84:85], v3 offset:35968
    ds_read_b64_tr_b16 v[86:87], v3 offset:37248
    s_waitcnt lgkmcnt(6)
    v_mfma_f32_16x16x32_bf16 v[28:31], v[68:71], v[236:239], v[28:31]
    ds_read_b64_tr_b16 v[48:49], v3 offset:48896
    ds_read_b64_tr_b16 v[50:51], v3 offset:50176
    v_mfma_f32_16x16x32_bf16 v[32:35], v[72:75], v[236:239], v[32:35]
    ds_read_b64_tr_b16 v[52:53], v3 offset:48928
    ds_read_b64_tr_b16 v[54:55], v3 offset:50208
    s_waitcnt lgkmcnt(6)
    v_mfma_f32_16x16x32_bf16 v[36:39], v[76:79], v[236:239], v[36:39]
    ds_read_b64_tr_b16 v[56:57], v3 offset:48960
    ds_read_b64_tr_b16 v[58:59], v3 offset:50240
    v_mfma_f32_16x16x32_bf16 v[40:43], v[80:83], v[236:239], v[40:43]
    ds_read_b64_tr_b16 v[60:61], v3 offset:48992
    ds_read_b64_tr_b16 v[62:63], v3 offset:50272
    s_waitcnt lgkmcnt(8)
    v_mfma_f32_16x16x32_bf16 v[44:47], v[84:87], v[236:239], v[44:47]
    ds_read_b64_tr_b16 v[64:65], v3 offset:49024
    ds_read_b64_tr_b16 v[66:67], v3 offset:50304
    s_waitcnt vmcnt(10)
    s_waitcnt lgkmcnt(6)
    v_mfma_f32_16x16x32_bf16 v[8:11], v[48:51], v[240:243], v[8:11]
    ds_read_b64_tr_b16 v[68:69], v3 offset:54016
    ds_read_b64_tr_b16 v[70:71], v3 offset:55296
    v_mfma_f32_16x16x32_bf16 v[12:15], v[52:55], v[240:243], v[12:15]
    ds_read_b64_tr_b16 v[72:73], v3 offset:54048
    ds_read_b64_tr_b16 v[74:75], v3 offset:55328
    s_waitcnt lgkmcnt(6)
    v_mfma_f32_16x16x32_bf16 v[16:19], v[56:59], v[240:243], v[16:19]
    ds_read_b64_tr_b16 v[76:77], v3 offset:54080
    ds_read_b64_tr_b16 v[78:79], v3 offset:55360
    v_mfma_f32_16x16x32_bf16 v[20:23], v[60:63], v[240:243], v[20:23]
    ds_read_b64_tr_b16 v[80:81], v3 offset:54112
    ds_read_b64_tr_b16 v[82:83], v3 offset:55392
    s_waitcnt lgkmcnt(8)
    v_mfma_f32_16x16x32_bf16 v[24:27], v[64:67], v[240:243], v[24:27]
    ds_read_b64_tr_b16 v[84:85], v3 offset:54144
    ds_read_b64_tr_b16 v[86:87], v3 offset:55424
    s_waitcnt lgkmcnt(6)
    v_mfma_f32_16x16x32_bf16 v[8:11], v[68:71], v[244:247], v[8:11]
    ds_read_b64_tr_b16 v[48:49], v3 offset:59136
    ds_read_b64_tr_b16 v[50:51], v3 offset:60416
    v_cvt_pk_bf16_f32 v28, v28, v29
    v_cvt_pk_bf16_f32 v29, v30, v31
    v_mfma_f32_16x16x32_bf16 v[12:15], v[72:75], v[244:247], v[12:15]
    ds_read_b64_tr_b16 v[52:53], v3 offset:59168
    ds_read_b64_tr_b16 v[54:55], v3 offset:60448
    v_cvt_pk_bf16_f32 v30, v32, v33
    v_cvt_pk_bf16_f32 v31, v34, v35
    s_waitcnt lgkmcnt(6)
    v_mfma_f32_16x16x32_bf16 v[16:19], v[76:79], v[244:247], v[16:19]
    ds_read_b64_tr_b16 v[56:57], v3 offset:59200
    ds_read_b64_tr_b16 v[58:59], v3 offset:60480
    v_cvt_pk_bf16_f32 v32, v36, v37
    v_cvt_pk_bf16_f32 v33, v38, v39
    v_mfma_f32_16x16x32_bf16 v[20:23], v[80:83], v[244:247], v[20:23]
    ds_read_b64_tr_b16 v[60:61], v3 offset:59232
    ds_read_b64_tr_b16 v[62:63], v3 offset:60512
    v_cvt_pk_bf16_f32 v34, v40, v41
    v_cvt_pk_bf16_f32 v35, v42, v43
    s_waitcnt lgkmcnt(8)
    v_mfma_f32_16x16x32_bf16 v[24:27], v[84:87], v[244:247], v[24:27]
    ds_read_b64_tr_b16 v[64:65], v3 offset:59264
    ds_read_b64_tr_b16 v[66:67], v3 offset:60544
    v_cvt_pk_bf16_f32 v36, v44, v45
    v_cvt_pk_bf16_f32 v37, v46, v47
    s_waitcnt vmcnt(8)
    s_waitcnt lgkmcnt(6)
    v_mfma_f32_16x16x32_bf16 v[8:11], v[48:51], v[248:251], v[8:11]
    ds_read_b64_tr_b16 v[68:69], v3 offset:64256
    ds_read_b64_tr_b16 v[70:71], v4 offset:0
    buffer_store_dwordx4 v[28:31], v2, s[12:15], s24 offen offset:0 sc0 sc1
    v_mfma_f32_16x16x32_bf16 v[12:15], v[52:55], v[248:251], v[12:15]
    ds_read_b64_tr_b16 v[72:73], v3 offset:64288
    ds_read_b64_tr_b16 v[74:75], v4 offset:32
    buffer_store_dwordx4 v[32:35], v2, s[12:15], s24 offen offset:1024 sc0 sc1
    s_waitcnt lgkmcnt(6)
    v_mfma_f32_16x16x32_bf16 v[16:19], v[56:59], v[248:251], v[16:19]
    ds_read_b64_tr_b16 v[76:77], v3 offset:64320
    ds_read_b64_tr_b16 v[78:79], v4 offset:64
    buffer_store_dwordx2 v[36:37], v94, s[12:15], s24 offen offset:2048 sc0 sc1
    v_mfma_f32_16x16x32_bf16 v[20:23], v[60:63], v[248:251], v[20:23]
    ds_read_b64_tr_b16 v[80:81], v3 offset:64352
    ds_read_b64_tr_b16 v[82:83], v4 offset:96
    s_waitcnt lgkmcnt(8)
    v_mfma_f32_16x16x32_bf16 v[24:27], v[64:67], v[248:251], v[24:27]
    ds_read_b64_tr_b16 v[84:85], v3 offset:64384
    ds_read_b64_tr_b16 v[86:87], v4 offset:128
    s_waitcnt lgkmcnt(6)
    v_mfma_f32_16x16x32_bf16 v[8:11], v[68:71], v[252:255], v[8:11]
    ds_read_b64_tr_b16 v[48:49], v3 offset:0
    ds_read_b64_tr_b16 v[50:51], v3 offset:1280
    v_mfma_f32_16x16x32_bf16 v[12:15], v[72:75], v[252:255], v[12:15]
    ds_read_b64_tr_b16 v[52:53], v3 offset:32
    ds_read_b64_tr_b16 v[54:55], v3 offset:1312
    s_waitcnt lgkmcnt(6)
    v_mfma_f32_16x16x32_bf16 v[16:19], v[76:79], v[252:255], v[16:19]
    ds_read_b64_tr_b16 v[56:57], v3 offset:64
    ds_read_b64_tr_b16 v[58:59], v3 offset:1344
    v_mfma_f32_16x16x32_bf16 v[20:23], v[80:83], v[252:255], v[20:23]
    ds_read_b64_tr_b16 v[60:61], v3 offset:96
    ds_read_b64_tr_b16 v[62:63], v3 offset:1376
    s_waitcnt lgkmcnt(8)
    v_mfma_f32_16x16x32_bf16 v[24:27], v[84:87], v[252:255], v[24:27]
    ds_read_b64_tr_b16 v[64:65], v3 offset:128
    ds_read_b64_tr_b16 v[66:67], v3 offset:1408
    s_waitcnt vmcnt(9)
    s_waitcnt lgkmcnt(6)
    v_mfma_f32_16x16x32_bf16 v[8:11], v[48:51], v[96:99], v[8:11]
    ds_read_b64_tr_b16 v[68:69], v3 offset:5120
    ds_read_b64_tr_b16 v[70:71], v3 offset:6400
    v_mfma_f32_16x16x32_bf16 v[12:15], v[52:55], v[96:99], v[12:15]
    ds_read_b64_tr_b16 v[72:73], v3 offset:5152
    ds_read_b64_tr_b16 v[74:75], v3 offset:6432
    s_waitcnt lgkmcnt(6)
    v_mfma_f32_16x16x32_bf16 v[16:19], v[56:59], v[96:99], v[16:19]
    ds_read_b64_tr_b16 v[76:77], v3 offset:5184
    ds_read_b64_tr_b16 v[78:79], v3 offset:6464
    v_mfma_f32_16x16x32_bf16 v[20:23], v[60:63], v[96:99], v[20:23]
    ds_read_b64_tr_b16 v[80:81], v3 offset:5216
    ds_read_b64_tr_b16 v[82:83], v3 offset:6496
    s_waitcnt lgkmcnt(8)
    v_mfma_f32_16x16x32_bf16 v[24:27], v[64:67], v[96:99], v[24:27]
    ds_read_b64_tr_b16 v[84:85], v3 offset:5248
    ds_read_b64_tr_b16 v[86:87], v3 offset:6528
    s_waitcnt lgkmcnt(6)
    v_mfma_f32_16x16x32_bf16 v[8:11], v[68:71], v[100:103], v[8:11]
    ds_read_b64_tr_b16 v[48:49], v3 offset:10240
    ds_read_b64_tr_b16 v[50:51], v3 offset:11520
    v_mfma_f32_16x16x32_bf16 v[12:15], v[72:75], v[100:103], v[12:15]
    ds_read_b64_tr_b16 v[52:53], v3 offset:10272
    ds_read_b64_tr_b16 v[54:55], v3 offset:11552
    s_waitcnt lgkmcnt(6)
    v_mfma_f32_16x16x32_bf16 v[16:19], v[76:79], v[100:103], v[16:19]
    ds_read_b64_tr_b16 v[56:57], v3 offset:10304
    ds_read_b64_tr_b16 v[58:59], v3 offset:11584
    v_mfma_f32_16x16x32_bf16 v[20:23], v[80:83], v[100:103], v[20:23]
    ds_read_b64_tr_b16 v[60:61], v3 offset:10336
    ds_read_b64_tr_b16 v[62:63], v3 offset:11616
    s_waitcnt lgkmcnt(8)
    v_mfma_f32_16x16x32_bf16 v[24:27], v[84:87], v[100:103], v[24:27]
    ds_read_b64_tr_b16 v[64:65], v3 offset:10368
    ds_read_b64_tr_b16 v[66:67], v3 offset:11648
    s_waitcnt vmcnt(7)
    s_waitcnt lgkmcnt(6)
    v_mfma_f32_16x16x32_bf16 v[8:11], v[48:51], v[104:107], v[8:11]
    ds_read_b64_tr_b16 v[68:69], v3 offset:15360
    ds_read_b64_tr_b16 v[70:71], v3 offset:16640
    s_waitcnt vmcnt(0)
    s_atomic_add s26, s[58:59], s34
    s_waitcnt lgkmcnt(0)
    v_mfma_f32_16x16x32_bf16 v[12:15], v[52:55], v[104:107], v[12:15]
    ds_read_b64_tr_b16 v[72:73], v3 offset:15392
    ds_read_b64_tr_b16 v[74:75], v3 offset:16672
    s_waitcnt lgkmcnt(2)
    v_mfma_f32_16x16x32_bf16 v[16:19], v[56:59], v[104:107], v[16:19]
    ds_read_b64_tr_b16 v[76:77], v3 offset:15424
    ds_read_b64_tr_b16 v[78:79], v3 offset:16704
    v_mfma_f32_16x16x32_bf16 v[20:23], v[60:63], v[104:107], v[20:23]
    ds_read_b64_tr_b16 v[80:81], v3 offset:15456
    ds_read_b64_tr_b16 v[82:83], v3 offset:16736
    s_waitcnt lgkmcnt(6)
    v_mfma_f32_16x16x32_bf16 v[24:27], v[64:67], v[104:107], v[24:27]
    ds_read_b64_tr_b16 v[84:85], v3 offset:15488
    ds_read_b64_tr_b16 v[86:87], v3 offset:16768
    s_waitcnt lgkmcnt(6)
    v_mfma_f32_16x16x32_bf16 v[8:11], v[68:71], v[108:111], v[8:11]
    ds_read_b64_tr_b16 v[48:49], v3 offset:20480
    ds_read_b64_tr_b16 v[50:51], v3 offset:21760
    v_mfma_f32_16x16x32_bf16 v[12:15], v[72:75], v[108:111], v[12:15]
    ds_read_b64_tr_b16 v[52:53], v3 offset:20512
    ds_read_b64_tr_b16 v[54:55], v3 offset:21792
    s_waitcnt lgkmcnt(6)
    v_mfma_f32_16x16x32_bf16 v[16:19], v[76:79], v[108:111], v[16:19]
    ds_read_b64_tr_b16 v[56:57], v3 offset:20544
    ds_read_b64_tr_b16 v[58:59], v3 offset:21824
    v_mfma_f32_16x16x32_bf16 v[20:23], v[80:83], v[108:111], v[20:23]
    ds_read_b64_tr_b16 v[60:61], v3 offset:20576
    ds_read_b64_tr_b16 v[62:63], v3 offset:21856
    s_waitcnt lgkmcnt(8)
    v_mfma_f32_16x16x32_bf16 v[24:27], v[84:87], v[108:111], v[24:27]
    ds_read_b64_tr_b16 v[64:65], v3 offset:20608
    ds_read_b64_tr_b16 v[66:67], v3 offset:21888
    s_waitcnt lgkmcnt(6)
    v_mfma_f32_16x16x32_bf16 v[8:11], v[48:51], v[112:115], v[8:11]
    ds_read_b64_tr_b16 v[68:69], v3 offset:25600
    ds_read_b64_tr_b16 v[70:71], v3 offset:26880
    buffer_load_dword v90, v89, s[12:15], s35 offen sc1
    v_mfma_f32_16x16x32_bf16 v[12:15], v[52:55], v[112:115], v[12:15]
    ds_read_b64_tr_b16 v[72:73], v3 offset:25632
    ds_read_b64_tr_b16 v[74:75], v3 offset:26912
    s_waitcnt lgkmcnt(6)
    v_mfma_f32_16x16x32_bf16 v[16:19], v[56:59], v[112:115], v[16:19]
    ds_read_b64_tr_b16 v[76:77], v3 offset:25664
    ds_read_b64_tr_b16 v[78:79], v3 offset:26944
    v_mfma_f32_16x16x32_bf16 v[20:23], v[60:63], v[112:115], v[20:23]
    ds_read_b64_tr_b16 v[80:81], v3 offset:25696
    ds_read_b64_tr_b16 v[82:83], v3 offset:26976
    s_waitcnt lgkmcnt(8)
    v_mfma_f32_16x16x32_bf16 v[24:27], v[64:67], v[112:115], v[24:27]
    ds_read_b64_tr_b16 v[84:85], v3 offset:25728
    ds_read_b64_tr_b16 v[86:87], v3 offset:27008
    s_waitcnt lgkmcnt(6)
    v_mfma_f32_16x16x32_bf16 v[8:11], v[68:71], v[116:119], v[8:11]
    ds_read_b64_tr_b16 v[48:49], v3 offset:30720
    ds_read_b64_tr_b16 v[50:51], v3 offset:32000
    v_mfma_f32_16x16x32_bf16 v[12:15], v[72:75], v[116:119], v[12:15]
    ds_read_b64_tr_b16 v[52:53], v3 offset:30752
    ds_read_b64_tr_b16 v[54:55], v3 offset:32032
    s_waitcnt lgkmcnt(6)
    v_mfma_f32_16x16x32_bf16 v[16:19], v[76:79], v[116:119], v[16:19]
    ds_read_b64_tr_b16 v[56:57], v3 offset:30784
    ds_read_b64_tr_b16 v[58:59], v3 offset:32064
    v_mfma_f32_16x16x32_bf16 v[20:23], v[80:83], v[116:119], v[20:23]
    ds_read_b64_tr_b16 v[60:61], v3 offset:30816
    ds_read_b64_tr_b16 v[62:63], v3 offset:32096
    s_waitcnt lgkmcnt(8)
    v_mfma_f32_16x16x32_bf16 v[24:27], v[84:87], v[116:119], v[24:27]
    ds_read_b64_tr_b16 v[64:65], v3 offset:30848
    ds_read_b64_tr_b16 v[66:67], v3 offset:32128
    s_waitcnt lgkmcnt(6)
    v_mfma_f32_16x16x32_bf16 v[8:11], v[48:51], v[120:123], v[8:11]
    ds_read_b64_tr_b16 v[68:69], v3 offset:35840
    ds_read_b64_tr_b16 v[70:71], v3 offset:37120
    v_mfma_f32_16x16x32_bf16 v[12:15], v[52:55], v[120:123], v[12:15]
    ds_read_b64_tr_b16 v[72:73], v3 offset:35872
    ds_read_b64_tr_b16 v[74:75], v3 offset:37152
    s_waitcnt lgkmcnt(6)
    v_mfma_f32_16x16x32_bf16 v[16:19], v[56:59], v[120:123], v[16:19]
    ds_read_b64_tr_b16 v[76:77], v3 offset:35904
    ds_read_b64_tr_b16 v[78:79], v3 offset:37184
    v_mfma_f32_16x16x32_bf16 v[20:23], v[60:63], v[120:123], v[20:23]
    ds_read_b64_tr_b16 v[80:81], v3 offset:35936
    ds_read_b64_tr_b16 v[82:83], v3 offset:37216
    s_waitcnt lgkmcnt(8)
    v_mfma_f32_16x16x32_bf16 v[24:27], v[64:67], v[120:123], v[24:27]
    ds_read_b64_tr_b16 v[84:85], v3 offset:35968
    ds_read_b64_tr_b16 v[86:87], v3 offset:37248
    s_waitcnt lgkmcnt(6)
    v_mfma_f32_16x16x32_bf16 v[8:11], v[68:71], v[124:127], v[8:11]
    s_waitcnt vmcnt(0)
    v_cmp_eq_u32 vcc, 0, v90
    s_cbranch_vccnz k_pe
    buffer_load_dwordx4 v[96:99], v2, s[12:15], s29 offen offset:0
    buffer_load_dwordx4 v[100:103], v2, s[12:15], s29 offen offset:1024
    buffer_load_dwordx2 v[104:105], v94, s[12:15], s29 offen offset:2048
    s_mov_b32 s26, 0
k_pe:
    v_mfma_f32_16x16x32_bf16 v[12:15], v[72:75], v[124:127], v[12:15]
    s_waitcnt lgkmcnt(2)
    v_mfma_f32_16x16x32_bf16 v[16:19], v[76:79], v[124:127], v[16:19]
    v_mfma_f32_16x16x32_bf16 v[20:23], v[80:83], v[124:127], v[20:23]
    s_waitcnt lgkmcnt(0)
    v_mfma_f32_16x16x32_bf16 v[24:27], v[84:87], v[124:127], v[24:27]
    v_mov_b32 v91, 2
    ds_write_b32 v5, v91
    s_cmp_lg_u32 s26, 0
    s_cbranch_scc1 k_pp
k_pp_back:
    v_and_b32 v6, 3, v0
    v_lshlrev_b32 v6, 2, v6
    v_add_u32 v6, 163584, v6
k_gd:
    ds_read_b32 v88, v6
    s_waitcnt lgkmcnt(0)
    v_cmp_gt_u32 vcc, 2, v88
    s_cbranch_vccz k_gd_out
    s_sleep 1
    s_sub_u32 s97, s97, 1
    s_cmp_gt_i32 s97, 0
    s_cbranch_scc1 k_gd
k_gd_out:
    s_mov_b32 s28, 0xbfb8aa3b
    s_waitcnt vmcnt(2)
    v_lshlrev_b32 v28, 16, v96
    v_and_b32 v29, 0xffff0000, v96
    v_lshlrev_b32 v30, 16, v97
    v_and_b32 v31, 0xffff0000, v97
    v_add_f32 v8, v8, v28
    v_add_f32 v9, v9, v29
    v_add_f32 v10, v10, v30
    v_add_f32 v11, v11, v31
    v_mul_f32 v28, s28, v8
    v_mul_f32 v29, s28, v9
    v_mul_f32 v30, s28, v10
    v_mul_f32 v31, s28, v11
    v_exp_f32 v28, v28
    v_exp_f32 v29, v29
    v_exp_f32 v30, v30
    v_exp_f32 v31, v31
    v_lshlrev_b32 v32, 16, v98
    v_and_b32 v33, 0xffff0000, v98
    v_lshlrev_b32 v34, 16, v99
    v_and_b32 v35, 0xffff0000, v99
    v_add_f32 v12, v12, v32
    v_add_f32 v13, v13, v33
    v_add_f32 v14, v14, v34
    v_add_f32 v15, v15, v35
    v_mul_f32 v32, s28, v12
    v_mul_f32 v33, s28, v13
    v_mul_f32 v34, s28, v14
    v_mul_f32 v35, s28, v15
    v_exp_f32 v32, v32
    v_exp_f32 v33, v33
    v_exp_f32 v34, v34
    v_exp_f32 v35, v35
    s_waitcnt vmcnt(1)
    v_lshlrev_b32 v36, 16, v100
    v_and_b32 v37, 0xffff0000, v100
    v_lshlrev_b32 v38, 16, v101
    v_and_b32 v39, 0xffff0000, v101
    v_add_f32 v16, v16, v36
    v_add_f32 v17, v17, v37
    v_add_f32 v18, v18, v38
    v_add_f32 v19, v19, v39
    v_mul_f32 v36, s28, v16
    v_mul_f32 v37, s28, v17
    v_mul_f32 v38, s28, v18
    v_mul_f32 v39, s28, v19
    v_exp_f32 v36, v36
    v_exp_f32 v37, v37
    v_exp_f32 v38, v38
    v_exp_f32 v39, v39
    v_lshlrev_b32 v40, 16, v102
    v_and_b32 v41, 0xffff0000, v102
    v_lshlrev_b32 v42, 16, v103
    v_and_b32 v43, 0xffff0000, v103
    v_add_f32 v20, v20, v40
    v_add_f32 v21, v21, v41
    v_add_f32 v22, v22, v42
    v_add_f32 v23, v23, v43
    v_mul_f32 v40, s28, v20
    v_mul_f32 v41, s28, v21
    v_mul_f32 v42, s28, v22
    v_mul_f32 v43, s28, v23
    v_exp_f32 v40, v40
    v_exp_f32 v41, v41
    v_exp_f32 v42, v42
    v_exp_f32 v43, v43
    s_waitcnt vmcnt(0)
    v_lshlrev_b32 v44, 16, v104
    v_and_b32 v45, 0xffff0000, v104
    v_lshlrev_b32 v46, 16, v105
    v_and_b32 v47, 0xffff0000, v105
    v_add_f32 v24, v24, v44
    v_add_f32 v25, v25, v45
    v_add_f32 v26, v26, v46
    v_add_f32 v27, v27, v47
    v_mul_f32 v44, s28, v24
    v_mul_f32 v45, s28, v25
    v_mul_f32 v46, s28, v26
    v_mul_f32 v47, s28, v27
    v_exp_f32 v44, v44
    v_exp_f32 v45, v45
    v_exp_f32 v46, v46
    v_exp_f32 v47, v47
    v_add_f32 v28, 1.0, v28
    v_add_f32 v29, 1.0, v29
    v_add_f32 v30, 1.0, v30
    v_add_f32 v31, 1.0, v31
    v_add_f32 v32, 1.0, v32
    v_add_f32 v33, 1.0, v33
    v_add_f32 v34, 1.0, v34
    v_add_f32 v35, 1.0, v35
    v_add_f32 v36, 1.0, v36
    v_add_f32 v37, 1.0, v37
    v_add_f32 v38, 1.0, v38
    v_add_f32 v39, 1.0, v39
    v_add_f32 v40, 1.0, v40
    v_add_f32 v41, 1.0, v41
    v_add_f32 v42, 1.0, v42
    v_add_f32 v43, 1.0, v43
    v_add_f32 v44, 1.0, v44
    v_add_f32 v45, 1.0, v45
    v_add_f32 v46, 1.0, v46
    v_add_f32 v47, 1.0, v47
    v_rcp_f32 v28, v28
    v_rcp_f32 v29, v29
    v_rcp_f32 v30, v30
    v_rcp_f32 v31, v31
    v_rcp_f32 v32, v32
    v_rcp_f32 v33, v33
    v_rcp_f32 v34, v34
    v_rcp_f32 v35, v35
    v_rcp_f32 v36, v36
    v_rcp_f32 v37, v37
    v_rcp_f32 v38, v38
    v_rcp_f32 v39, v39
    v_rcp_f32 v40, v40
    v_rcp_f32 v41, v41
    v_rcp_f32 v42, v42
    v_rcp_f32 v43, v43
    v_rcp_f32 v44, v44
    v_rcp_f32 v45, v45
    v_rcp_f32 v46, v46
    v_rcp_f32 v47, v47
    v_mul_f32 v28, v28, v8
    v_mul_f32 v29, v29, v9
    v_mul_f32 v30, v30, v10
    v_mul_f32 v31, v31, v11
    ds_write_b128 v7, v[28:31] offset:0
    v_mul_f32 v32, v32, v12
    v_mul_f32 v33, v33, v13
    v_mul_f32 v34, v34, v14
    v_mul_f32 v35, v35, v15
    ds_write_b128 v7, v[32:35] offset:64
    v_mul_f32 v36, v36, v16
    v_mul_f32 v37, v37, v17
    v_mul_f32 v38, v38, v18
    v_mul_f32 v39, v39, v19
    ds_write_b128 v7, v[36:39] offset:128
    v_mul_f32 v40, v40, v20
    v_mul_f32 v41, v41, v21
    v_mul_f32 v42, v42, v22
    v_mul_f32 v43, v43, v23
    ds_write_b128 v7, v[40:43] offset:192
    v_mul_f32 v44, v44, v24
    v_mul_f32 v45, v45, v25
    v_mul_f32 v46, v46, v26
    v_mul_f32 v47, v47, v27
    ds_write_b128 v7, v[44:47] offset:256
    v_mov_b32 v88, 1
    s_waitcnt lgkmcnt(0)
    ds_write_b32 v5, v88 offset:32
    s_endpgm
k_fs:
    s_sub_u32 s18, s16, 4
    v_mov_b32 v45, 0
    global_load_dword v44, v45, s[56:57] offset:128 sc1
    v_and_b32 v8, 31, v0
    v_lshlrev_b32 v9, 3, v8
    v_add_u32 v9, 127488, v9
    ds_read_b64 v[10:11], v9
    v_and_b32 v9, 3, v8
    v_bfe_u32 v12, v8, 2, 1
    v_lshl_add_u32 v9, v12, 3, v9
    v_bfe_u32 v12, v8, 3, 1
    v_lshl_add_u32 v9, v12, 2, v9
    v_lshrrev_b32 v12, 4, v8
    v_lshl_add_u32 v9, v12, 5, v9
    v_lshlrev_b32 v9, 3, v9
    s_lshr_b32 s28, s17, 1
    s_lshl_b32 s28, s28, 6
    s_and_b32 s29, s17, 1
    s_lshl_b32 s29, s29, 4
    s_add_u32 s28, s28, s29
    s_lshl_b32 s28, s28, 3
    s_add_u32 s28, s28, 29360128
    s_cmp_eq_u32 s16, 5
    s_cselect_b32 s28, s28, 0x40000000
    s_waitcnt lgkmcnt(0)
    buffer_store_dwordx2 v[10:11], v9, s[12:15], s28 offen sc0 sc1
    s_mov_b32 s63, 81920
    s_bitcmp1_b32 s16, 0
    s_cselect_b32 s8, s44, s42
    s_cselect_b32 s9, s45, s43
    s_cselect_b32 s31, 102912, s63
    s_mov_b32 s10, 1314816
    s_mov_b32 s11, 0x20000
    s_and_b32 s28, s17, 3
    s_mul_i32 s28, s28, 5136
    s_lshr_b32 s29, s17, 2
    s_mul_i32 s29, s29, 82176
    s_add_u32 s28, s28, s29
    v_lshlrev_b32 v1, 4, v0
    s_bfm_b64 exec, 41, 0
    s_add_u32 m0, s31, 0
    s_add_u32 s30, s28, 0
    buffer_load_dwordx4 v1, s[8:11], s30 offen nt lds
    s_add_u32 m0, s31, 656
    s_add_u32 s30, s28, 640
    buffer_load_dwordx4 v1, s[8:11], s30 offen nt lds
    s_add_u32 m0, s31, 1312
    s_add_u32 s30, s28, 1280
    buffer_load_dwordx4 v1, s[8:11], s30 offen nt lds
    s_add_u32 m0, s31, 1968
    s_add_u32 s30, s28, 1920
    buffer_load_dwordx4 v1, s[8:11], s30 offen nt lds
    s_add_u32 m0, s31, 2624
    s_add_u32 s30, s28, 2560
    buffer_load_dwordx4 v1, s[8:11], s30 offen nt lds
    s_add_u32 m0, s31, 3280
    s_add_u32 s30, s28, 3200
    buffer_load_dwordx4 v1, s[8:11], s30 offen nt lds
    s_add_u32 m0, s31, 3936
    s_add_u32 s30, s28, 3840
    buffer_load_dwordx4 v1, s[8:11], s30 offen nt lds
    s_add_u32 m0, s31, 4592
    s_add_u32 s30, s28, 4480
    buffer_load_dwordx4 v1, s[8:11], s30 offen nt lds
    s_add_u32 m0, s31, 5248
    s_add_u32 s30, s28, 20544
    buffer_load_dwordx4 v1, s[8:11], s30 offen nt lds
    s_add_u32 m0, s31, 5904
    s_add_u32 s30, s28, 21184
    buffer_load_dwordx4 v1, s[8:11], s30 offen nt lds
    s_add_u32 m0, s31, 6560
    s_add_u32 s30, s28, 21824
    buffer_load_dwordx4 v1, s[8:11], s30 offen nt lds
    s_add_u32 m0, s31, 7216
    s_add_u32 s30, s28, 22464
    buffer_load_dwordx4 v1, s[8:11], s30 offen nt lds
    s_add_u32 m0, s31, 7872
    s_add_u32 s30, s28, 23104
    buffer_load_dwordx4 v1, s[8:11], s30 offen nt lds
    s_add_u32 m0, s31, 8528
    s_add_u32 s30, s28, 23744
    buffer_load_dwordx4 v1, s[8:11], s30 offen nt lds
    s_add_u32 m0, s31, 9184
    s_add_u32 s30, s28, 24384
    buffer_load_dwordx4 v1, s[8:11], s30 offen nt lds
    s_add_u32 m0, s31, 9840
    s_add_u32 s30, s28, 25024
    buffer_load_dwordx4 v1, s[8:11], s30 offen nt lds
    s_add_u32 m0, s31, 10496
    s_add_u32 s30, s28, 41088
    buffer_load_dwordx4 v1, s[8:11], s30 offen nt lds
    s_add_u32 m0, s31, 11152
    s_add_u32 s30, s28, 41728
    buffer_load_dwordx4 v1, s[8:11], s30 offen nt lds
    s_add_u32 m0, s31, 11808
    s_add_u32 s30, s28, 42368
    buffer_load_dwordx4 v1, s[8:11], s30 offen nt lds
    s_add_u32 m0, s31, 12464
    s_add_u32 s30, s28, 43008
    buffer_load_dwordx4 v1, s[8:11], s30 offen nt lds
    s_add_u32 m0, s31, 13120
    s_add_u32 s30, s28, 43648
    buffer_load_dwordx4 v1, s[8:11], s30 offen nt lds
    s_add_u32 m0, s31, 13776
    s_add_u32 s30, s28, 44288
    buffer_load_dwordx4 v1, s[8:11], s30 offen nt lds
    s_add_u32 m0, s31, 14432
    s_add_u32 s30, s28, 44928
    buffer_load_dwordx4 v1, s[8:11], s30 offen nt lds
    s_add_u32 m0, s31, 15088
    s_add_u32 s30, s28, 45568
    buffer_load_dwordx4 v1, s[8:11], s30 offen nt lds
    s_add_u32 m0, s31, 15744
    s_add_u32 s30, s28, 61632
    buffer_load_dwordx4 v1, s[8:11], s30 offen nt lds
    s_add_u32 m0, s31, 16400
    s_add_u32 s30, s28, 62272
    buffer_load_dwordx4 v1, s[8:11], s30 offen nt lds
    s_add_u32 m0, s31, 17056
    s_add_u32 s30, s28, 62912
    buffer_load_dwordx4 v1, s[8:11], s30 offen nt lds
    s_add_u32 m0, s31, 17712
    s_add_u32 s30, s28, 63552
    buffer_load_dwordx4 v1, s[8:11], s30 offen nt lds
    s_add_u32 m0, s31, 18368
    s_add_u32 s30, s28, 64192
    buffer_load_dwordx4 v1, s[8:11], s30 offen nt lds
    s_add_u32 m0, s31, 19024
    s_add_u32 s30, s28, 64832
    buffer_load_dwordx4 v1, s[8:11], s30 offen nt lds
    s_add_u32 m0, s31, 19680
    s_add_u32 s30, s28, 65472
    buffer_load_dwordx4 v1, s[8:11], s30 offen nt lds
    s_add_u32 m0, s31, 20336
    s_add_u32 s30, s28, 66112
    buffer_load_dwordx4 v1, s[8:11], s30 offen nt lds
    s_mov_b64 exec, -1
    s_cmp_lg_u32 s16, 5
    s_cbranch_scc1 k_fs4
    s_waitcnt vmcnt(32)
    v_cmp_eq_u32 vcc, 0, v44
    s_cbranch_vccnz k_clr2
k_clr2_back:
    s_mov_b32 s28, 1
    s_mov_b32 s29, 29509632
    s_atomic_add s28, s[58:59], s29
    s_mov_b32 s29, 29509760
    s_atomic_add s28, s[58:59], s29
    s_mov_b32 s29, 29509888
    s_atomic_add s28, s[58:59], s29
    s_mov_b32 s29, 29510016
    s_atomic_add s28, s[58:59], s29
    s_mov_b32 s29, 29510144
    s_atomic_add s28, s[58:59], s29
    s_mov_b32 s29, 29510272
    s_atomic_add s28, s[58:59], s29
    s_mov_b32 s29, 29510400
    s_atomic_add s28, s[58:59], s29
    s_mov_b32 s29, 29510528
    s_atomic_add s28, s[58:59], s29
k_fs4:
    s_and_b32 s19, s16, 3
    s_waitcnt vmcnt(24)
    s_and_b32 s21, s19, 1
    s_lshl_b32 s22, s19, 13
    s_add_u32 s22, s22, 130816
    v_lshlrev_b32 v2, 4, v0
    v_add_u32 v3, s22, v2
    s_xor_b32 s28, s19, 1
    s_lshl_b32 s28, s28, 13
    s_add_u32 s28, s28, 130816
    v_add_u32 v4, s28, v2
    s_lshl_b32 s28, s19, 2
    s_add_u32 s28, s28, 163600
    v_mov_b32 v6, s28
    s_and_b32 s28, s28, -8
    v_and_b32 v5, 1, v0
    v_lshl_add_u32 v5, v5, 2, s28
    s_getpc_b64 s[36:37]
sf_tab_pc0:
    s_add_u32 s36, s36, sf_tab-sf_tab_pc0
    s_addc_u32 s37, s37, 0
    s_mov_b32 s38, 63488
    s_mov_b32 s39, 0x20000
    s_movk_i32 s28, 3072
    buffer_load_dwordx4 v[120:123], v2, s[36:39], 0 offen offset:0
    buffer_load_dwordx4 v[124:127], v2, s[36:39], 0 offen offset:1024
    buffer_load_dwordx4 v[128:131], v2, s[36:39], 0 offen offset:2048
    buffer_load_dwordx4 v[132:135], v2, s[36:39], s28 offen offset:0
    buffer_load_dwordx4 v[136:139], v2, s[36:39], s28 offen offset:1024
    buffer_load_dwordx4 v[140:143], v2, s[36:39], s28 offen offset:2048
    s_lshl_b32 s28, s21, 13
    s_add_u32 s28, s28, 30720
    s_add_u32 s29, s28, 4096
    buffer_load_dwordx4 v[192:195], v2, s[36:39], s28 offen offset:0
    buffer_load_dwordx4 v[196:199], v2, s[36:39], s28 offen offset:1024
    buffer_load_dwordx4 v[200:203], v2, s[36:39], s28 offen offset:2048
    buffer_load_dwordx4 v[204:207], v2, s[36:39], s28 offen offset:3072
    buffer_load_dwordx4 v[208:211], v2, s[36:39], s29 offen offset:0
    buffer_load_dwordx4 v[212:215], v2, s[36:39], s29 offen offset:1024
    buffer_load_dwordx4 v[216:219], v2, s[36:39], s29 offen offset:2048
    buffer_load_dwordx4 v[220:223], v2, s[36:39], s29 offen offset:3072
    s_lshl_b32 s28, s21, 1
    s_xor_b32 s28, s28, 0
    s_mul_i32 s28, s28, 3072
    s_mul_i32 s29, s21, 12288
    s_add_u32 s28, s28, s29
    s_add_u32 s28, s28, 6144
    buffer_load_dwordx4 v[144:147], v2, s[36:39], s28 offen offset:0
    buffer_load_dwordx4 v[148:151], v2, s[36:39], s28 offen offset:1024
    buffer_load_dwordx4 v[152:155], v2, s[36:39], s28 offen offset:2048
    s_lshl_b32 s28, s21, 1
    s_xor_b32 s28, s28, 1
    s_mul_i32 s28, s28, 3072
    s_mul_i32 s29, s21, 12288
    s_add_u32 s28, s28, s29
    s_add_u32 s28, s28, 6144
    buffer_load_dwordx4 v[156:159], v2, s[36:39], s28 offen offset:0
    buffer_load_dwordx4 v[160:163], v2, s[36:39], s28 offen offset:1024
    buffer_load_dwordx4 v[164:167], v2, s[36:39], s28 offen offset:2048
    s_lshl_b32 s28, s21, 1
    s_xor_b32 s28, s28, 2
    s_mul_i32 s28, s28, 3072
    s_mul_i32 s29, s21, 12288
    s_add_u32 s28, s28, s29
    s_add_u32 s28, s28, 6144
    buffer_load_dwordx4 v[168:171], v2, s[36:39], s28 offen offset:0
    buffer_load_dwordx4 v[172:175], v2, s[36:39], s28 offen offset:1024
    buffer_load_dwordx4 v[176:179], v2, s[36:39], s28 offen offset:2048
    s_lshl_b32 s28, s21, 1
    s_xor_b32 s28, s28, 3
    s_mul_i32 s28, s28, 3072
    s_mul_i32 s29, s21, 12288
    s_add_u32 s28, s28, s29
    s_add_u32 s28, s28, 6144
    buffer_load_dwordx4 v[180:183], v2, s[36:39], s28 offen offset:0
    buffer_load_dwordx4 v[184:187], v2, s[36:39], s28 offen offset:1024
    buffer_load_dwordx4 v[188:191], v2, s[36:39], s28 offen offset:2048
    s_lshl_b32 s28, s21, 13
    s_add_u32 s28, s28, 47104
    s_add_u32 s29, s28, 4096
    buffer_load_dwordx4 v[224:227], v2, s[36:39], s28 offen offset:0
    buffer_load_dwordx4 v[228:231], v2, s[36:39], s28 offen offset:1024
    buffer_load_dwordx4 v[232:235], v2, s[36:39], s28 offen offset:2048
    buffer_load_dwordx4 v[236:239], v2, s[36:39], s28 offen offset:3072
    buffer_load_dwordx4 v[240:243], v2, s[36:39], s29 offen offset:0
    buffer_load_dwordx4 v[244:247], v2, s[36:39], s29 offen offset:1024
    buffer_load_dwordx4 v[248:251], v2, s[36:39], s29 offen offset:2048
    buffer_load_dwordx4 v[252:255], v2, s[36:39], s29 offen offset:3072
    s_lshl_b32 s28, s18, 2
    s_add_u32 s28, s28, 127232
    v_mov_b32 v8, s28
    s_waitcnt vmcnt(34)
    v_mov_b32 v10, 1
    ds_write_b32 v8, v10
    v_and_b32 v9, 1, v0
    v_lshlrev_b32 v9, 2, v9
    v_add_u32 v9, 127232, v9
k_wfl:
    ds_read_b32 v12, v9
    s_waitcnt lgkmcnt(0)
    v_cmp_gt_u32 vcc, 1, v12
    s_cbranch_vccz k_wfl_out
    s_sleep 1
    s_sub_u32 s97, s97, 1
    s_cmp_gt_i32 s97, 0
    s_cbranch_scc1 k_wfl
k_wfl_out:
    v_lshrrev_b32 v1, 3, v0
    s_lshl_b32 s28, s18, 3
    v_add_u32 v1, s28, v1
    v_and_b32 v6, 7, v0
    v_mul_u32_u24 v2, 658, v6
    v_lshl_add_u32 v2, v1, 1, v2
    v_add_u32 v2, 81920, v2
    v_lshlrev_b32 v6, 4, v6
    v_mul_u32_u24 v3, 8320, v1
    v_add_u32 v6, v6, v3
    v_cmp_eq_u32 vcc, 0, v1
    v_mov_b32 v3, 0x40000000
    s_lshr_b32 s28, s17, 2
    s_lshl_b32 s28, s28, 9
    s_and_b32 s29, s17, 3
    s_lshl_b32 s29, s29, 7
    s_add_u32 s28, s28, s29
    s_add_u32 s30, s28, 16777216
    v_cndmask_b32 v7, v3, v6, vcc
    ds_read_u16 v16, v2 offset:0
    ds_read_u16 v17, v2 offset:5248
    ds_read_u16 v18, v2 offset:10496
    ds_read_u16 v19, v2 offset:15744
    ds_read_u16 v20, v2 offset:20992
    ds_read_u16 v21, v2 offset:26240
    ds_read_u16 v22, v2 offset:31488
    ds_read_u16 v23, v2 offset:36736
    ds_read_u16 v24, v2 offset:32
    ds_read_u16 v25, v2 offset:5280
    ds_read_u16 v26, v2 offset:10528
    ds_read_u16 v27, v2 offset:15776
    ds_read_u16 v28, v2 offset:21024
    ds_read_u16 v29, v2 offset:26272
    ds_read_u16 v30, v2 offset:31520
    s_waitcnt lgkmcnt(7)
    v_lshl_or_b32 v32, v20, 16, v16
    v_lshl_or_b32 v33, v21, 16, v17
    v_lshl_or_b32 v34, v22, 16, v18
    v_lshl_or_b32 v35, v23, 16, v19
    ds_read_u16 v31, v2 offset:36768
    buffer_store_dwordx4 v[32:35], v6, s[12:15], s30 offen sc0 sc1
    s_add_u32 s30, s30, 133120
    ds_read_u16 v16, v2 offset:64
    ds_read_u16 v17, v2 offset:5312
    ds_read_u16 v18, v2 offset:10560
    ds_read_u16 v19, v2 offset:15808
    ds_read_u16 v20, v2 offset:21056
    ds_read_u16 v21, v2 offset:26304
    ds_read_u16 v22, v2 offset:31552
    s_waitcnt lgkmcnt(7)
    v_lshl_or_b32 v36, v28, 16, v24
    v_lshl_or_b32 v37, v29, 16, v25
    v_lshl_or_b32 v38, v30, 16, v26
    v_lshl_or_b32 v39, v31, 16, v27
    ds_read_u16 v23, v2 offset:36800
    buffer_store_dwordx4 v[36:39], v6, s[12:15], s30 offen sc0 sc1
    s_add_u32 s30, s30, 133120
    ds_read_u16 v24, v2 offset:96
    ds_read_u16 v25, v2 offset:5344
    ds_read_u16 v26, v2 offset:10592
    ds_read_u16 v27, v2 offset:15840
    ds_read_u16 v28, v2 offset:21088
    ds_read_u16 v29, v2 offset:26336
    ds_read_u16 v30, v2 offset:31584
    s_waitcnt lgkmcnt(7)
    v_lshl_or_b32 v40, v20, 16, v16
    v_lshl_or_b32 v41, v21, 16, v17
    v_lshl_or_b32 v42, v22, 16, v18
    v_lshl_or_b32 v43, v23, 16, v19
    ds_read_u16 v31, v2 offset:36832
    buffer_store_dwordx4 v[40:43], v6, s[12:15], s30 offen sc0 sc1
    s_add_u32 s30, s30, 133120
    ds_read_u16 v16, v2 offset:128
    ds_read_u16 v17, v2 offset:5376
    ds_read_u16 v18, v2 offset:10624
    ds_read_u16 v19, v2 offset:15872
    ds_read_u16 v20, v2 offset:21120
    ds_read_u16 v21, v2 offset:26368
    ds_read_u16 v22, v2 offset:31616
    s_waitcnt lgkmcnt(7)
    v_lshl_or_b32 v44, v28, 16, v24
    v_lshl_or_b32 v45, v29, 16, v25
    v_lshl_or_b32 v46, v30, 16, v26
    v_lshl_or_b32 v47, v31, 16, v27
    ds_read_u16 v23, v2 offset:36864
    buffer_store_dwordx4 v[44:47], v6, s[12:15], s30 offen sc0 sc1
    s_add_u32 s30, s30, 133120
    ds_read_u16 v24, v2 offset:160
    ds_read_u16 v25, v2 offset:5408
    ds_read_u16 v26, v2 offset:10656
    ds_read_u16 v27, v2 offset:15904
    ds_read_u16 v28, v2 offset:21152
    ds_read_u16 v29, v2 offset:26400
    ds_read_u16 v30, v2 offset:31648
    s_waitcnt lgkmcnt(7)
    v_lshl_or_b32 v32, v20, 16, v16
    v_lshl_or_b32 v33, v21, 16, v17
    v_lshl_or_b32 v34, v22, 16, v18
    v_lshl_or_b32 v35, v23, 16, v19
    ds_read_u16 v31, v2 offset:36896
    buffer_store_dwordx4 v[32:35], v6, s[12:15], s30 offen sc0 sc1
    s_add_u32 s30, s30, 133120
    ds_read_u16 v16, v2 offset:192
    ds_read_u16 v17, v2 offset:5440
    ds_read_u16 v18, v2 offset:10688
    ds_read_u16 v19, v2 offset:15936
    ds_read_u16 v20, v2 offset:21184
    ds_read_u16 v21, v2 offset:26432
    ds_read_u16 v22, v2 offset:31680
    s_waitcnt lgkmcnt(7)
    v_lshl_or_b32 v36, v28, 16, v24
    v_lshl_or_b32 v37, v29, 16, v25
    v_lshl_or_b32 v38, v30, 16, v26
    v_lshl_or_b32 v39, v31, 16, v27
    ds_read_u16 v23, v2 offset:36928
    buffer_store_dwordx4 v[36:39], v6, s[12:15], s30 offen sc0 sc1
    s_add_u32 s30, s30, 133120
    ds_read_u16 v24, v2 offset:224
    ds_read_u16 v25, v2 offset:5472
    ds_read_u16 v26, v2 offset:10720
    ds_read_u16 v27, v2 offset:15968
    ds_read_u16 v28, v2 offset:21216
    ds_read_u16 v29, v2 offset:26464
    ds_read_u16 v30, v2 offset:31712
    s_waitcnt lgkmcnt(7)
    v_lshl_or_b32 v40, v20, 16, v16
    v_lshl_or_b32 v41, v21, 16, v17
    v_lshl_or_b32 v42, v22, 16, v18
    v_lshl_or_b32 v43, v23, 16, v19
    ds_read_u16 v31, v2 offset:36960
    buffer_store_dwordx4 v[40:43], v6, s[12:15], s30 offen sc0 sc1
    s_add_u32 s30, s30, 133120
    ds_read_u16 v16, v2 offset:256
    ds_read_u16 v17, v2 offset:5504
    ds_read_u16 v18, v2 offset:10752
    ds_read_u16 v19, v2 offset:16000
    ds_read_u16 v20, v2 offset:21248
    ds_read_u16 v21, v2 offset:26496
    ds_read_u16 v22, v2 offset:31744
    s_waitcnt lgkmcnt(7)
    v_lshl_or_b32 v44, v28, 16, v24
    v_lshl_or_b32 v45, v29, 16, v25
    v_lshl_or_b32 v46, v30, 16, v26
    v_lshl_or_b32 v47, v31, 16, v27
    ds_read_u16 v23, v2 offset:36992
    buffer_store_dwordx4 v[44:47], v6, s[12:15], s30 offen sc0 sc1
    s_add_u32 s30, s30, 133120
    ds_read_u16 v24, v2 offset:288
    ds_read_u16 v25, v2 offset:5536
    ds_read_u16 v26, v2 offset:10784
    ds_read_u16 v27, v2 offset:16032
    ds_read_u16 v28, v2 offset:21280
    ds_read_u16 v29, v2 offset:26528
    ds_read_u16 v30, v2 offset:31776
    s_waitcnt lgkmcnt(7)
    v_lshl_or_b32 v32, v20, 16, v16
    v_lshl_or_b32 v33, v21, 16, v17
    v_lshl_or_b32 v34, v22, 16, v18
    v_lshl_or_b32 v35, v23, 16, v19
    ds_read_u16 v31, v2 offset:37024
    buffer_store_dwordx4 v[32:35], v6, s[12:15], s30 offen sc0 sc1
    s_add_u32 s30, s30, 133120
    ds_read_u16 v16, v2 offset:320
    ds_read_u16 v17, v2 offset:5568
    ds_read_u16 v18, v2 offset:10816
    ds_read_u16 v19, v2 offset:16064
    ds_read_u16 v20, v2 offset:21312
    ds_read_u16 v21, v2 offset:26560
    ds_read_u16 v22, v2 offset:31808
    s_waitcnt lgkmcnt(7)
    v_lshl_or_b32 v36, v28, 16, v24
    v_lshl_or_b32 v37, v29, 16, v25
    v_lshl_or_b32 v38, v30, 16, v26
    v_lshl_or_b32 v39, v31, 16, v27
    ds_read_u16 v23, v2 offset:37056
    buffer_store_dwordx4 v[36:39], v6, s[12:15], s30 offen sc0 sc1
    s_add_u32 s30, s30, 133120
    ds_read_u16 v24, v2 offset:352
    ds_read_u16 v25, v2 offset:5600
    ds_read_u16 v26, v2 offset:10848
    ds_read_u16 v27, v2 offset:16096
    ds_read_u16 v28, v2 offset:21344
    ds_read_u16 v29, v2 offset:26592
    ds_read_u16 v30, v2 offset:31840
    s_waitcnt lgkmcnt(7)
    v_lshl_or_b32 v40, v20, 16, v16
    v_lshl_or_b32 v41, v21, 16, v17
    v_lshl_or_b32 v42, v22, 16, v18
    v_lshl_or_b32 v43, v23, 16, v19
    ds_read_u16 v31, v2 offset:37088
    buffer_store_dwordx4 v[40:43], v6, s[12:15], s30 offen sc0 sc1
    s_add_u32 s30, s30, 133120
    ds_read_u16 v16, v2 offset:384
    ds_read_u16 v17, v2 offset:5632
    ds_read_u16 v18, v2 offset:10880
    ds_read_u16 v19, v2 offset:16128
    ds_read_u16 v20, v2 offset:21376
    ds_read_u16 v21, v2 offset:26624
    ds_read_u16 v22, v2 offset:31872
    s_waitcnt lgkmcnt(7)
    v_lshl_or_b32 v44, v28, 16, v24
    v_lshl_or_b32 v45, v29, 16, v25
    v_lshl_or_b32 v46, v30, 16, v26
    v_lshl_or_b32 v47, v31, 16, v27
    ds_read_u16 v23, v2 offset:37120
    buffer_store_dwordx4 v[44:47], v6, s[12:15], s30 offen sc0 sc1
    s_add_u32 s30, s30, 133120
    ds_read_u16 v24, v2 offset:416
    ds_read_u16 v25, v2 offset:5664
    ds_read_u16 v26, v2 offset:10912
    ds_read_u16 v27, v2 offset:16160
    ds_read_u16 v28, v2 offset:21408
    ds_read_u16 v29, v2 offset:26656
    ds_read_u16 v30, v2 offset:31904
    s_waitcnt lgkmcnt(7)
    v_lshl_or_b32 v32, v20, 16, v16
    v_lshl_or_b32 v33, v21, 16, v17
    v_lshl_or_b32 v34, v22, 16, v18
    v_lshl_or_b32 v35, v23, 16, v19
    ds_read_u16 v31, v2 offset:37152
    buffer_store_dwordx4 v[32:35], v6, s[12:15], s30 offen sc0 sc1
    s_add_u32 s30, s30, 133120
    ds_read_u16 v16, v2 offset:448
    ds_read_u16 v17, v2 offset:5696
    ds_read_u16 v18, v2 offset:10944
    ds_read_u16 v19, v2 offset:16192
    ds_read_u16 v20, v2 offset:21440
    ds_read_u16 v21, v2 offset:26688
    ds_read_u16 v22, v2 offset:31936
    s_waitcnt lgkmcnt(7)
    v_lshl_or_b32 v36, v28, 16, v24
    v_lshl_or_b32 v37, v29, 16, v25
    v_lshl_or_b32 v38, v30, 16, v26
    v_lshl_or_b32 v39, v31, 16, v27
    ds_read_u16 v23, v2 offset:37184
    buffer_store_dwordx4 v[36:39], v6, s[12:15], s30 offen sc0 sc1
    s_add_u32 s30, s30, 133120
    ds_read_u16 v24, v2 offset:480
    ds_read_u16 v25, v2 offset:5728
    ds_read_u16 v26, v2 offset:10976
    ds_read_u16 v27, v2 offset:16224
    ds_read_u16 v28, v2 offset:21472
    ds_read_u16 v29, v2 offset:26720
    ds_read_u16 v30, v2 offset:31968
    s_waitcnt lgkmcnt(7)
    v_lshl_or_b32 v40, v20, 16, v16
    v_lshl_or_b32 v41, v21, 16, v17
    v_lshl_or_b32 v42, v22, 16, v18
    v_lshl_or_b32 v43, v23, 16, v19
    ds_read_u16 v31, v2 offset:37216
    buffer_store_dwordx4 v[40:43], v6, s[12:15], s30 offen sc0 sc1
    s_add_u32 s30, s30, 133120
    ds_read_u16 v16, v2 offset:512
    ds_read_u16 v17, v2 offset:5760
    ds_read_u16 v18, v2 offset:11008
    ds_read_u16 v19, v2 offset:16256
    ds_read_u16 v20, v2 offset:21504
    ds_read_u16 v21, v2 offset:26752
    ds_read_u16 v22, v2 offset:32000
    s_waitcnt lgkmcnt(7)
    v_lshl_or_b32 v44, v28, 16, v24
    v_lshl_or_b32 v45, v29, 16, v25
    v_lshl_or_b32 v46, v30, 16, v26
    v_lshl_or_b32 v47, v31, 16, v27
    ds_read_u16 v23, v2 offset:37248
    buffer_store_dwordx4 v[44:47], v6, s[12:15], s30 offen sc0 sc1
    s_add_u32 s30, s30, 133120
    ds_read_u16 v24, v2 offset:544
    ds_read_u16 v25, v2 offset:5792
    ds_read_u16 v26, v2 offset:11040
    ds_read_u16 v27, v2 offset:16288
    ds_read_u16 v28, v2 offset:21536
    ds_read_u16 v29, v2 offset:26784
    ds_read_u16 v30, v2 offset:32032
    s_waitcnt lgkmcnt(7)
    v_lshl_or_b32 v32, v20, 16, v16
    v_lshl_or_b32 v33, v21, 16, v17
    v_lshl_or_b32 v34, v22, 16, v18
    v_lshl_or_b32 v35, v23, 16, v19
    ds_read_u16 v31, v2 offset:37280
    buffer_store_dwordx4 v[32:35], v6, s[12:15], s30 offen sc0 sc1
    s_add_u32 s30, s30, 133120
    ds_read_u16 v16, v2 offset:576
    ds_read_u16 v17, v2 offset:5824
    ds_read_u16 v18, v2 offset:11072
    ds_read_u16 v19, v2 offset:16320
    ds_read_u16 v20, v2 offset:21568
    ds_read_u16 v21, v2 offset:26816
    ds_read_u16 v22, v2 offset:32064
    s_waitcnt lgkmcnt(7)
    v_lshl_or_b32 v36, v28, 16, v24
    v_lshl_or_b32 v37, v29, 16, v25
    v_lshl_or_b32 v38, v30, 16, v26
    v_lshl_or_b32 v39, v31, 16, v27
    ds_read_u16 v23, v2 offset:37312
    buffer_store_dwordx4 v[36:39], v6, s[12:15], s30 offen sc0 sc1
    s_add_u32 s30, s30, 133120
    ds_read_u16 v24, v2 offset:608
    ds_read_u16 v25, v2 offset:5856
    ds_read_u16 v26, v2 offset:11104
    ds_read_u16 v27, v2 offset:16352
    ds_read_u16 v28, v2 offset:21600
    ds_read_u16 v29, v2 offset:26848
    ds_read_u16 v30, v2 offset:32096
    s_waitcnt lgkmcnt(7)
    v_lshl_or_b32 v40, v20, 16, v16
    v_lshl_or_b32 v41, v21, 16, v17
    v_lshl_or_b32 v42, v22, 16, v18
    v_lshl_or_b32 v43, v23, 16, v19
    ds_read_u16 v31, v2 offset:37344
    buffer_store_dwordx4 v[40:43], v6, s[12:15], s30 offen sc0 sc1
    s_add_u32 s30, s30, 133120
    ds_read_u16 v16, v2 offset:640
    ds_read_u16 v17, v2 offset:5888
    ds_read_u16 v18, v2 offset:11136
    ds_read_u16 v19, v2 offset:16384
    ds_read_u16 v20, v2 offset:21632
    ds_read_u16 v21, v2 offset:26880
    ds_read_u16 v22, v2 offset:32128
    s_waitcnt lgkmcnt(7)
    v_lshl_or_b32 v44, v28, 16, v24
    v_lshl_or_b32 v45, v29, 16, v25
    v_lshl_or_b32 v46, v30, 16, v26
    v_lshl_or_b32 v47, v31, 16, v27
    ds_read_u16 v23, v2 offset:37376
    buffer_store_dwordx4 v[44:47], v6, s[12:15], s30 offen sc0 sc1
    s_add_u32 s30, s30, 133120
    s_waitcnt lgkmcnt(0)
    v_lshl_or_b32 v32, v20, 16, v16
    v_lshl_or_b32 v33, v21, 16, v17
    v_lshl_or_b32 v34, v22, 16, v18
    v_lshl_or_b32 v35, v23, 16, v19
    buffer_store_dwordx4 v[32:35], v7, s[12:15], s30 offen sc0 sc1
    s_add_u32 s30, s30, 133120
    s_waitcnt vmcnt(0)
    s_barrier
    s_and_b32 s28, s2, 7
    s_lshr_b32 s29, s2, 3
    s_and_b32 s18, s29, 7
    s_lshr_b32 s29, s29, 3
    s_and_b32 s3, s28, 1
    s_lshr_b32 s28, s28, 1
    s_lshl_b32 s28, s28, 2
    s_add_u32 s17, s28, s29
    s_lshl_b32 s17, s17, 1
    s_add_u32 s17, s17, s3
    s_and_b32 s19, s16, 3
    s_and_b32 s21, s19, 1
    s_lshl_b32 s22, s19, 13
    s_add_u32 s22, s22, 130816
    v_lshlrev_b32 v2, 4, v0
    v_add_u32 v3, s22, v2
    s_xor_b32 s28, s19, 1
    s_lshl_b32 s28, s28, 13
    s_add_u32 s28, s28, 130816
    v_add_u32 v4, s28, v2
    s_lshl_b32 s28, s19, 2
    s_add_u32 s28, s28, 163600
    v_mov_b32 v6, s28
    s_and_b32 s28, s28, -8
    v_and_b32 v5, 1, v0
    v_lshl_add_u32 v5, v5, 2, s28
    s_mov_b32 s4, s40
    s_mov_b32 s5, s41
    s_mov_b32 s6, 2621440
    s_mov_b32 s7, 0x20000
    s_mov_b32 s8, s54
    s_mov_b32 s9, s55
    s_mov_b32 s10, 2621440
    s_mov_b32 s11, 0x20000
    s_mov_b32 s12, s58
    s_mov_b32 s13, s59
    s_mov_b32 s14, 268435456
    s_mov_b32 s15, 0x20000
    s_mov_b32 s20, s2
    s_mov_b32 s60, 1
    s_branch k_p2c
k_p2f:
    s_and_b32 s28, s2, 7
    s_lshr_b32 s29, s2, 3
    s_and_b32 s18, s29, 7
    s_lshr_b32 s29, s29, 3
    s_and_b32 s3, s28, 1
    s_lshr_b32 s28, s28, 1
    s_lshl_b32 s28, s28, 2
    s_add_u32 s17, s28, s29
    s_lshl_b32 s17, s17, 1
    s_add_u32 s17, s17, s3
    s_and_b32 s19, s16, 3
    s_and_b32 s21, s19, 1
    s_lshl_b32 s22, s19, 13
    s_add_u32 s22, s22, 130816
    v_lshlrev_b32 v2, 4, v0
    v_add_u32 v3, s22, v2
    s_xor_b32 s28, s19, 1
    s_lshl_b32 s28, s28, 13
    s_add_u32 s28, s28, 130816
    v_add_u32 v4, s28, v2
    s_lshl_b32 s28, s19, 2
    s_add_u32 s28, s28, 163600
    v_mov_b32 v6, s28
    s_and_b32 s28, s28, -8
    v_and_b32 v5, 1, v0
    v_lshl_add_u32 v5, v5, 2, s28
    s_mov_b32 s4, s40
    s_mov_b32 s5, s41
    s_mov_b32 s6, 2621440
    s_mov_b32 s7, 0x20000
    s_mov_b32 s8, s54
    s_mov_b32 s9, s55
    s_mov_b32 s10, 2621440
    s_mov_b32 s11, 0x20000
    s_mov_b32 s12, s58
    s_mov_b32 s13, s59
    s_mov_b32 s14, 268435456
    s_mov_b32 s15, 0x20000
    s_setprio 0
    s_lshr_b32 s28, s19, 1
    s_lshl_b32 s28, s28, 8
    s_add_u32 s20, s2, s28
    s_cmp_ge_u32 s20, 320
    s_cbranch_scc1 k_idle
    s_mov_b32 s60, 1
k_p2e:
    s_getpc_b64 s[36:37]
sf_tab_pc1:
    s_add_u32 s36, s36, sf_tab-sf_tab_pc1
    s_addc_u32 s37, s37, 0
    s_mov_b32 s38, 63488
    s_mov_b32 s39, 0x20000
    s_movk_i32 s28, 3072
    buffer_load_dwordx4 v[120:123], v2, s[36:39], 0 offen offset:0
    buffer_load_dwordx4 v[124:127], v2, s[36:39], 0 offen offset:1024
    buffer_load_dwordx4 v[128:131], v2, s[36:39], 0 offen offset:2048
    buffer_load_dwordx4 v[132:135], v2, s[36:39], s28 offen offset:0
    buffer_load_dwordx4 v[136:139], v2, s[36:39], s28 offen offset:1024
    buffer_load_dwordx4 v[140:143], v2, s[36:39], s28 offen offset:2048
    s_lshl_b32 s28, s21, 13
    s_add_u32 s28, s28, 30720
    s_add_u32 s29, s28, 4096
    buffer_load_dwordx4 v[192:195], v2, s[36:39], s28 offen offset:0
    buffer_load_dwordx4 v[196:199], v2, s[36:39], s28 offen offset:1024
    buffer_load_dwordx4 v[200:203], v2, s[36:39], s28 offen offset:2048
    buffer_load_dwordx4 v[204:207], v2, s[36:39], s28 offen offset:3072
    buffer_load_dwordx4 v[208:211], v2, s[36:39], s29 offen offset:0
    buffer_load_dwordx4 v[212:215], v2, s[36:39], s29 offen offset:1024
    buffer_load_dwordx4 v[216:219], v2, s[36:39], s29 offen offset:2048
    buffer_load_dwordx4 v[220:223], v2, s[36:39], s29 offen offset:3072
    s_lshl_b32 s28, s21, 1
    s_xor_b32 s28, s28, 0
    s_mul_i32 s28, s28, 3072
    s_mul_i32 s29, s21, 12288
    s_add_u32 s28, s28, s29
    s_add_u32 s28, s28, 6144
    buffer_load_dwordx4 v[144:147], v2, s[36:39], s28 offen offset:0
    buffer_load_dwordx4 v[148:151], v2, s[36:39], s28 offen offset:1024
    buffer_load_dwordx4 v[152:155], v2, s[36:39], s28 offen offset:2048
    s_lshl_b32 s28, s21, 1
    s_xor_b32 s28, s28, 1
    s_mul_i32 s28, s28, 3072
    s_mul_i32 s29, s21, 12288
    s_add_u32 s28, s28, s29
    s_add_u32 s28, s28, 6144
    buffer_load_dwordx4 v[156:159], v2, s[36:39], s28 offen offset:0
    buffer_load_dwordx4 v[160:163], v2, s[36:39], s28 offen offset:1024
    buffer_load_dwordx4 v[164:167], v2, s[36:39], s28 offen offset:2048
    s_lshl_b32 s28, s21, 1
    s_xor_b32 s28, s28, 2
    s_mul_i32 s28, s28, 3072
    s_mul_i32 s29, s21, 12288
    s_add_u32 s28, s28, s29
    s_add_u32 s28, s28, 6144
    buffer_load_dwordx4 v[168:171], v2, s[36:39], s28 offen offset:0
    buffer_load_dwordx4 v[172:175], v2, s[36:39], s28 offen offset:1024
    buffer_load_dwordx4 v[176:179], v2, s[36:39], s28 offen offset:2048
    s_lshl_b32 s28, s21, 1
    s_xor_b32 s28, s28, 3
    s_mul_i32 s28, s28, 3072
    s_mul_i32 s29, s21, 12288
    s_add_u32 s28, s28, s29
    s_add_u32 s28, s28, 6144
    buffer_load_dwordx4 v[180:183], v2, s[36:39], s28 offen offset:0
    buffer_load_dwordx4 v[184:187], v2, s[36:39], s28 offen offset:1024
    buffer_load_dwordx4 v[188:191], v2, s[36:39], s28 offen offset:2048
    s_lshl_b32 s28, s21, 13
    s_add_u32 s28, s28, 47104
    s_add_u32 s29, s28, 4096
    buffer_load_dwordx4 v[224:227], v2, s[36:39], s28 offen offset:0
    buffer_load_dwordx4 v[228:231], v2, s[36:39], s28 offen offset:1024
    buffer_load_dwordx4 v[232:235], v2, s[36:39], s28 offen offset:2048
    buffer_load_dwordx4 v[236:239], v2, s[36:39], s28 offen offset:3072
    buffer_load_dwordx4 v[240:243], v2, s[36:39], s29 offen offset:0
    buffer_load_dwordx4 v[244:247], v2, s[36:39], s29 offen offset:1024
    buffer_load_dwordx4 v[248:251], v2, s[36:39], s29 offen offset:2048
    buffer_load_dwordx4 v[252:255], v2, s[36:39], s29 offen offset:3072
    v_mov_b32 v16, 163708
    v_mov_b32 v17, 1
    ds_write_b32 v16, v17
k_p2c:
    s_cmp_lg_u32 s16, 4
    s_cbranch_scc1 k_yl
    s_and_b32 s29, s2, 7
    s_lshl_b32 s29, s29, 7
    s_add_u32 s29, s29, 29507592
    v_mov_b32 v16, 0
k_yp:
    buffer_load_dword v17, v16, s[12:15], s29 offen sc1
    s_waitcnt vmcnt(0)
    v_readfirstlane_b32 s28, v17
    s_cmp_ge_u32 s28, 1
    s_cbranch_scc1 k_yp_ok
    s_sleep 3
    s_sub_u32 s97, s97, 1
    s_cmp_gt_i32 s97, 0
    s_cbranch_scc1 k_yp
k_yp_ok:
    v_mov_b32 v16, 163644
    v_mov_b32 v17, 1
    ds_write_b32 v16, v17
    s_branch k_yl_ok
k_yl:
    v_mov_b32 v16, 163644
k_yl2:
    ds_read_b32 v17, v16
    s_waitcnt lgkmcnt(0)
    v_readfirstlane_b32 s28, v17
    s_cmp_lg_u32 s28, 0
    s_cbranch_scc1 k_yl2_ok
    s_sleep 1
    s_sub_u32 s97, s97, 1
    s_cmp_gt_i32 s97, 0
    s_cbranch_scc1 k_yl2
k_yl2_ok:
k_yl_ok:
    s_cmp_eq_u32 s20, 320
    s_cselect_b32 s28, 0, s20
    s_mul_i32 s28, s28, 8320
    s_lshl_b32 s30, s21, 12
    s_add_u32 s28, s28, s30
    s_add_u32 s28, s28, 12582912
    v_lshrrev_b32 v8, 4, v0
    v_and_b32 v9, 7, v0
    v_xor_b32 v8, v8, v9
    v_lshlrev_b32 v8, 4, v8
    v_lshrrev_b32 v9, 3, v0
    v_lshl_add_u32 v8, v9, 7, v8
    v_xor_b32 v9, 64, v8
    s_add_u32 m0, s22, 0
    s_add_u32 s29, s28, 0
    buffer_load_dwordx4 v8, s[12:15], s29 offen lds
    s_add_u32 m0, s22, 1024
    s_add_u32 s29, s28, 1024
    buffer_load_dwordx4 v9, s[12:15], s29 offen lds
    s_add_u32 m0, s22, 2048
    s_add_u32 s29, s28, 2048
    buffer_load_dwordx4 v8, s[12:15], s29 offen lds
    s_add_u32 m0, s22, 3072
    s_add_u32 s29, s28, 3072
    buffer_load_dwordx4 v9, s[12:15], s29 offen lds
    s_mul_i32 s28, s20, 8320
    s_add_u32 s28, s28, s30
    s_add_u32 s28, s28, 16777216
    buffer_load_dwordx4 v[104:107], v2, s[12:15], s28 offen offset:0
    buffer_load_dwordx4 v[108:111], v2, s[12:15], s28 offen offset:1024
    buffer_load_dwordx4 v[112:115], v2, s[12:15], s28 offen offset:2048
    buffer_load_dwordx4 v[116:119], v2, s[12:15], s28 offen offset:3072
    s_lshl_b32 s28, s16, 2
    s_add_u32 s28, s28, 163744
    v_mov_b32 v16, s28
    v_mov_b32 v17, 1
    ds_write_b32 v16, v17
    s_setprio 3
    v_and_b32 v1, 31, v0
    v_lshl_add_u32 v1, v1, 7, s22
    v_bfe_u32 v12, v0, 1, 3
    v_lshrrev_b32 v13, 5, v0
    v_xor_b32 v12, v12, v13
    s_cmp_eq_u32 s20, 320
    s_cselect_b32 s28, 4, 0
    v_xor_b32 v13, s28, v12
    v_xor_b32 v14, 0, v13
    v_lshl_add_u32 v8, v14, 4, v1
    v_xor_b32 v14, 4, v12
    v_lshl_add_u32 v10, v14, 4, v1
    v_xor_b32 v14, 2, v13
    v_lshl_add_u32 v9, v14, 4, v1
    v_xor_b32 v14, 6, v12
    v_lshl_add_u32 v11, v14, 4, v1
    s_cmp_eq_u32 s20, 320
    s_cselect_b32 s25, 0, s20
    s_cselect_b32 s31, 1351680, 0
    s_mul_i32 s29, s25, 6554
    s_lshr_b32 s29, s29, 16
    s_mul_i32 s30, s29, 10
    s_sub_u32 s30, s25, s30
    s_lshl_b32 s30, s30, 5
    s_add_u32 s30, s30, s29
    s_mul_i32 s30, s30, 4224
    s_add_u32 s30, s30, s31
    s_lshl_b32 s29, s21, 11
    s_add_u32 s30, s30, s29
    s_add_u32 s26, s30, 25165824
    s_add_u32 s27, s26, 1351680
    v_bfe_u32 v1, v0, 1, 4
    v_lshlrev_b32 v1, 7, v1
    v_and_b32 v12, 1, v0
    v_lshl_add_u32 v1, v12, 5, v1
    v_lshrrev_b32 v12, 5, v0
    v_lshl_add_u32 v7, v12, 4, v1
    s_waitcnt vmcnt(4)
    ds_read_b128 v[56:59], v8
    ds_read_b128 v[60:63], v9
    ds_read_b128 v[64:67], v10
    ds_read_b128 v[68:71], v11
    s_cmp_eq_u32 s25, 0
    s_waitcnt lgkmcnt(0)
    s_cbranch_scc0 k_cplx
    v_mov_b32 v64, 0
    v_mov_b32 v65, 0
    v_mov_b32 v66, 0
    v_mov_b32 v67, 0
    v_mov_b32 v68, 0
    v_mov_b32 v69, 0
    v_mov_b32 v70, 0
    v_mov_b32 v71, 0
    s_nop 1
k_cplx:
    v_mfma_f32_32x32x16_bf16 v[72:87], v[56:59], v[120:123], 0
    v_mfma_f32_32x32x16_bf16 v[88:103], v[64:67], v[120:123], 0
    v_mfma_f32_32x32x16_bf16 v[72:87], v[64:67], v[124:127], v[72:87]
    v_mfma_f32_32x32x16_bf16 v[88:103], v[56:59], v[128:131], v[88:103]
    v_mfma_f32_32x32x16_bf16 v[72:87], v[60:63], v[132:135], v[72:87]
    v_mfma_f32_32x32x16_bf16 v[88:103], v[68:71], v[132:135], v[88:103]
    v_mfma_f32_32x32x16_bf16 v[72:87], v[68:71], v[136:139], v[72:87]
    v_mfma_f32_32x32x16_bf16 v[88:103], v[60:63], v[140:143], v[88:103]
    s_nop 10
    v_mul_f32 v24, v72, v192
    v_mul_f32 v25, v73, v193
    v_mul_f32 v26, v74, v194
    v_mul_f32 v27, v75, v195
    v_mul_f32 v28, v88, v192
    v_mul_f32 v29, v89, v193
    v_mul_f32 v30, v90, v194
    v_mul_f32 v31, v91, v195
    v_fmac_f32 v24, v88, v196
    v_fmac_f32 v25, v89, v197
    v_fmac_f32 v26, v90, v198
    v_fmac_f32 v27, v91, v199
    v_fma_f32 v28, -v72, v196, v28
    v_fma_f32 v29, -v73, v197, v29
    v_fma_f32 v30, -v74, v198, v30
    v_fma_f32 v31, -v75, v199, v31
    v_cvt_pk_bf16_f32 v40, v24, v25
    v_cvt_pk_bf16_f32 v41, v26, v27
    v_cvt_pk_bf16_f32 v48, v28, v29
    v_cvt_pk_bf16_f32 v49, v30, v31
    v_mul_f32 v24, v76, v200
    v_mul_f32 v25, v77, v201
    v_mul_f32 v26, v78, v202
    v_mul_f32 v27, v79, v203
    v_mul_f32 v28, v92, v200
    v_mul_f32 v29, v93, v201
    v_mul_f32 v30, v94, v202
    v_mul_f32 v31, v95, v203
    v_fmac_f32 v24, v92, v204
    v_fmac_f32 v25, v93, v205
    v_fmac_f32 v26, v94, v206
    v_fmac_f32 v27, v95, v207
    v_fma_f32 v28, -v76, v204, v28
    v_fma_f32 v29, -v77, v205, v29
    v_fma_f32 v30, -v78, v206, v30
    v_fma_f32 v31, -v79, v207, v31
    v_cvt_pk_bf16_f32 v42, v24, v25
    v_cvt_pk_bf16_f32 v43, v26, v27
    v_cvt_pk_bf16_f32 v50, v28, v29
    v_cvt_pk_bf16_f32 v51, v30, v31
    v_mul_f32 v24, v80, v208
    v_mul_f32 v25, v81, v209
    v_mul_f32 v26, v82, v210
    v_mul_f32 v27, v83, v211
    v_mul_f32 v28, v96, v208
    v_mul_f32 v29, v97, v209
    v_mul_f32 v30, v98, v210
    v_mul_f32 v31, v99, v211
    v_fmac_f32 v24, v96, v212
    v_fmac_f32 v25, v97, v213
    v_fmac_f32 v26, v98, v214
    v_fmac_f32 v27, v99, v215
    v_fma_f32 v28, -v80, v212, v28
    v_fma_f32 v29, -v81, v213, v29
    v_fma_f32 v30, -v82, v214, v30
    v_fma_f32 v31, -v83, v215, v31
    v_cvt_pk_bf16_f32 v44, v24, v25
    v_cvt_pk_bf16_f32 v45, v26, v27
    v_cvt_pk_bf16_f32 v52, v28, v29
    v_cvt_pk_bf16_f32 v53, v30, v31
    v_mul_f32 v24, v84, v216
    v_mul_f32 v25, v85, v217
    v_mul_f32 v26, v86, v218
    v_mul_f32 v27, v87, v219
    v_mul_f32 v28, v100, v216
    v_mul_f32 v29, v101, v217
    v_mul_f32 v30, v102, v218
    v_mul_f32 v31, v103, v219
    v_fmac_f32 v24, v100, v220
    v_fmac_f32 v25, v101, v221
    v_fmac_f32 v26, v102, v222
    v_fmac_f32 v27, v103, v223
    v_fma_f32 v28, -v84, v220, v28
    v_fma_f32 v29, -v85, v221, v29
    v_fma_f32 v30, -v86, v222, v30
    v_fma_f32 v31, -v87, v223, v31
    v_cvt_pk_bf16_f32 v46, v24, v25
    v_cvt_pk_bf16_f32 v47, v26, v27
    v_cvt_pk_bf16_f32 v54, v28, v29
    v_cvt_pk_bf16_f32 v55, v30, v31
    s_waitcnt vmcnt(4)
    ds_write_b128 v3, v[40:43] offset:0
    ds_write_b128 v3, v[44:47] offset:1024
    ds_write_b128 v3, v[48:51] offset:2048
    ds_write_b128 v3, v[52:55] offset:3072
    v_mfma_f32_32x32x16_bf16 v[72:87], v[144:147], v[40:43], 0
    v_mfma_f32_32x32x16_bf16 v[88:103], v[144:147], v[48:51], 0
    v_mfma_f32_32x32x16_bf16 v[72:87], v[148:151], v[48:51], v[72:87]
    s_waitcnt lgkmcnt(0)
    v_mov_b32 v24, 1
    ds_write_b32 v6, v24
    v_mfma_f32_32x32x16_bf16 v[88:103], v[152:155], v[40:43], v[88:103]
    v_mfma_f32_32x32x16_bf16 v[72:87], v[156:159], v[44:47], v[72:87]
    v_mfma_f32_32x32x16_bf16 v[88:103], v[156:159], v[52:55], v[88:103]
k_x1:
    ds_read_b32 v24, v5
    s_waitcnt lgkmcnt(0)
    v_cmp_gt_u32 vcc, 1, v24
    s_cbranch_vccz k_x1_out
    s_sleep 1
    s_sub_u32 s97, s97, 1
    s_cmp_gt_i32 s97, 0
    s_cbranch_scc1 k_x1
k_x1_out:
    ds_read_b128 v[56:59], v4 offset:0
    ds_read_b128 v[60:63], v4 offset:1024
    ds_read_b128 v[64:67], v4 offset:2048
    ds_read_b128 v[68:71], v4 offset:3072
    v_mfma_f32_32x32x16_bf16 v[72:87], v[160:163], v[52:55], v[72:87]
    v_mfma_f32_32x32x16_bf16 v[88:103], v[164:167], v[44:47], v[88:103]
    s_waitcnt lgkmcnt(0)
    v_mov_b32 v24, 2
    ds_write_b32 v6, v24
    v_mfma_f32_32x32x16_bf16 v[72:87], v[168:171], v[56:59], v[72:87]
    v_mfma_f32_32x32x16_bf16 v[88:103], v[168:171], v[64:67], v[88:103]
    v_mfma_f32_32x32x16_bf16 v[72:87], v[172:175], v[64:67], v[72:87]
    v_mfma_f32_32x32x16_bf16 v[88:103], v[176:179], v[56:59], v[88:103]
    v_mfma_f32_32x32x16_bf16 v[72:87], v[180:183], v[60:63], v[72:87]
    v_mfma_f32_32x32x16_bf16 v[88:103], v[180:183], v[68:71], v[88:103]
    v_mfma_f32_32x32x16_bf16 v[72:87], v[184:187], v[68:71], v[72:87]
    v_mfma_f32_32x32x16_bf16 v[88:103], v[188:191], v[60:63], v[88:103]
    s_waitcnt vmcnt(0)
    v_lshlrev_b32 v8, 16, v104
    v_and_b32 v12, 0xffff0000, v104
    v_lshlrev_b32 v9, 16, v105
    v_and_b32 v13, 0xffff0000, v105
    v_lshlrev_b32 v10, 16, v106
    v_and_b32 v14, 0xffff0000, v106
    v_lshlrev_b32 v11, 16, v107
    v_and_b32 v15, 0xffff0000, v107
    s_nop 3
    v_mul_f32 v24, v72, v8
    v_mul_f32 v25, v73, v9
    v_mul_f32 v26, v74, v10
    v_mul_f32 v27, v75, v11
    v_mul_f32 v28, v88, v8
    v_mul_f32 v29, v89, v9
    v_mul_f32 v30, v90, v10
    v_mul_f32 v31, v91, v11
    v_fma_f32 v24, -v88, v12, v24
    v_fma_f32 v25, -v89, v13, v25
    v_fma_f32 v26, -v90, v14, v26
    v_fma_f32 v27, -v91, v15, v27
    v_fmac_f32 v28, v72, v12
    v_fmac_f32 v29, v73, v13
    v_fmac_f32 v30, v74, v14
    v_fmac_f32 v31, v75, v15
    v_cvt_pk_bf16_f32 v40, v24, v25
    v_cvt_pk_bf16_f32 v41, v26, v27
    v_cvt_pk_bf16_f32 v48, v28, v29
    v_cvt_pk_bf16_f32 v49, v30, v31
    v_lshlrev_b32 v16, 16, v108
    v_and_b32 v20, 0xffff0000, v108
    v_lshlrev_b32 v17, 16, v109
    v_and_b32 v21, 0xffff0000, v109
    v_lshlrev_b32 v18, 16, v110
    v_and_b32 v22, 0xffff0000, v110
    v_lshlrev_b32 v19, 16, v111
    v_and_b32 v23, 0xffff0000, v111
    v_mul_f32 v24, v76, v16
    v_mul_f32 v25, v77, v17
    v_mul_f32 v26, v78, v18
    v_mul_f32 v27, v79, v19
    v_mul_f32 v28, v92, v16
    v_mul_f32 v29, v93, v17
    v_mul_f32 v30, v94, v18
    v_mul_f32 v31, v95, v19
    v_fma_f32 v24, -v92, v20, v24
    v_fma_f32 v25, -v93, v21, v25
    v_fma_f32 v26, -v94, v22, v26
    v_fma_f32 v27, -v95, v23, v27
    v_fmac_f32 v28, v76, v20
    v_fmac_f32 v29, v77, v21
    v_fmac_f32 v30, v78, v22
    v_fmac_f32 v31, v79, v23
    v_cvt_pk_bf16_f32 v42, v24, v25
    v_cvt_pk_bf16_f32 v43, v26, v27
    v_cvt_pk_bf16_f32 v50, v28, v29
    v_cvt_pk_bf16_f32 v51, v30, v31
    v_lshlrev_b32 v8, 16, v112
    v_and_b32 v12, 0xffff0000, v112
    v_lshlrev_b32 v9, 16, v113
    v_and_b32 v13, 0xffff0000, v113
    v_lshlrev_b32 v10, 16, v114
    v_and_b32 v14, 0xffff0000, v114
    v_lshlrev_b32 v11, 16, v115
    v_and_b32 v15, 0xffff0000, v115
    v_mul_f32 v24, v80, v8
    v_mul_f32 v25, v81, v9
    v_mul_f32 v26, v82, v10
    v_mul_f32 v27, v83, v11
    v_mul_f32 v28, v96, v8
    v_mul_f32 v29, v97, v9
    v_mul_f32 v30, v98, v10
    v_mul_f32 v31, v99, v11
    v_fma_f32 v24, -v96, v12, v24
    v_fma_f32 v25, -v97, v13, v25
    v_fma_f32 v26, -v98, v14, v26
    v_fma_f32 v27, -v99, v15, v27
    v_fmac_f32 v28, v80, v12
    v_fmac_f32 v29, v81, v13
    v_fmac_f32 v30, v82, v14
    v_fmac_f32 v31, v83, v15
    v_cvt_pk_bf16_f32 v44, v24, v25
    v_cvt_pk_bf16_f32 v45, v26, v27
    v_cvt_pk_bf16_f32 v52, v28, v29
    v_cvt_pk_bf16_f32 v53, v30, v31
    v_lshlrev_b32 v16, 16, v116
    v_and_b32 v20, 0xffff0000, v116
    v_lshlrev_b32 v17, 16, v117
    v_and_b32 v21, 0xffff0000, v117
    v_lshlrev_b32 v18, 16, v118
    v_and_b32 v22, 0xffff0000, v118
    v_lshlrev_b32 v19, 16, v119
    v_and_b32 v23, 0xffff0000, v119
    v_mul_f32 v24, v84, v16
    v_mul_f32 v25, v85, v17
    v_mul_f32 v26, v86, v18
    v_mul_f32 v27, v87, v19
    v_mul_f32 v28, v100, v16
    v_mul_f32 v29, v101, v17
    v_mul_f32 v30, v102, v18
    v_mul_f32 v31, v103, v19
    v_fma_f32 v24, -v100, v20, v24
    v_fma_f32 v25, -v101, v21, v25
    v_fma_f32 v26, -v102, v22, v26
    v_fma_f32 v27, -v103, v23, v27
    v_fmac_f32 v28, v84, v20
    v_fmac_f32 v29, v85, v21
    v_fmac_f32 v30, v86, v22
    v_fmac_f32 v31, v87, v23
    v_cvt_pk_bf16_f32 v46, v24, v25
    v_cvt_pk_bf16_f32 v47, v26, v27
    v_cvt_pk_bf16_f32 v54, v28, v29
    v_cvt_pk_bf16_f32 v55, v30, v31
k_x2p:
    ds_read_b32 v24, v5
    s_waitcnt lgkmcnt(0)
    v_cmp_gt_u32 vcc, 2, v24
    s_cbranch_vccz k_x2p_out
    s_sleep 1
    s_sub_u32 s97, s97, 1
    s_cmp_gt_i32 s97, 0
    s_cbranch_scc1 k_x2p
k_x2p_out:
    ds_write_b128 v3, v[40:43] offset:0
    ds_write_b128 v3, v[44:47] offset:1024
    ds_write_b128 v3, v[48:51] offset:2048
    ds_write_b128 v3, v[52:55] offset:3072
    v_mfma_f32_32x32x16_bf16 v[72:87], v[40:43], v[144:147], 0
    v_mfma_f32_32x32x16_bf16 v[88:103], v[48:51], v[144:147], 0
    v_mfma_f32_32x32x16_bf16 v[72:87], v[48:51], v[152:155], v[72:87]
    s_waitcnt lgkmcnt(0)
    v_mov_b32 v24, 3
    ds_write_b32 v6, v24
    v_mfma_f32_32x32x16_bf16 v[88:103], v[40:43], v[148:151], v[88:103]
    v_mfma_f32_32x32x16_bf16 v[72:87], v[44:47], v[156:159], v[72:87]
    v_mfma_f32_32x32x16_bf16 v[88:103], v[52:55], v[156:159], v[88:103]
k_x2:
    ds_read_b32 v24, v5
    s_waitcnt lgkmcnt(0)
    v_cmp_gt_u32 vcc, 3, v24
    s_cbranch_vccz k_x2_out
    s_sleep 1
    s_sub_u32 s97, s97, 1
    s_cmp_gt_i32 s97, 0
    s_cbranch_scc1 k_x2
k_x2_out:
    ds_read_b128 v[56:59], v4 offset:0
    ds_read_b128 v[60:63], v4 offset:1024
    ds_read_b128 v[64:67], v4 offset:2048
    ds_read_b128 v[68:71], v4 offset:3072
    v_mfma_f32_32x32x16_bf16 v[72:87], v[52:55], v[164:167], v[72:87]
    v_mfma_f32_32x32x16_bf16 v[88:103], v[44:47], v[160:163], v[88:103]
    s_waitcnt lgkmcnt(0)
    v_mov_b32 v24, 4
    ds_write_b32 v6, v24
    v_mfma_f32_32x32x16_bf16 v[72:87], v[56:59], v[168:171], v[72:87]
    v_mfma_f32_32x32x16_bf16 v[88:103], v[64:67], v[168:171], v[88:103]
    v_mfma_f32_32x32x16_bf16 v[72:87], v[64:67], v[176:179], v[72:87]
    v_mfma_f32_32x32x16_bf16 v[88:103], v[56:59], v[172:175], v[88:103]
    v_mfma_f32_32x32x16_bf16 v[72:87], v[60:63], v[180:183], v[72:87]
    v_mfma_f32_32x32x16_bf16 v[88:103], v[68:71], v[180:183], v[88:103]
    v_mfma_f32_32x32x16_bf16 v[72:87], v[68:71], v[188:191], v[72:87]
    v_mfma_f32_32x32x16_bf16 v[88:103], v[60:63], v[184:187], v[88:103]
    s_waitcnt vmcnt(0)
    s_nop 9
    v_mul_f32 v24, v72, v224
    v_mul_f32 v25, v73, v225
    v_mul_f32 v26, v74, v226
    v_mul_f32 v27, v75, v227
    v_mul_f32 v28, v88, v224
    v_mul_f32 v29, v89, v225
    v_mul_f32 v30, v90, v226
    v_mul_f32 v31, v91, v227
    v_fma_f32 v24, -v88, v228, v24
    v_fma_f32 v25, -v89, v229, v25
    v_fma_f32 v26, -v90, v230, v26
    v_fma_f32 v27, -v91, v231, v27
    v_fmac_f32 v28, v72, v228
    v_fmac_f32 v29, v73, v229
    v_fmac_f32 v30, v74, v230
    v_fmac_f32 v31, v75, v231
    v_cvt_pk_bf16_f32 v40, v24, v25
    v_cvt_pk_bf16_f32 v41, v26, v27
    v_cvt_pk_bf16_f32 v48, v28, v29
    v_cvt_pk_bf16_f32 v49, v30, v31
    v_mul_f32 v24, v76, v232
    v_mul_f32 v25, v77, v233
    v_mul_f32 v26, v78, v234
    v_mul_f32 v27, v79, v235
    v_mul_f32 v28, v92, v232
    v_mul_f32 v29, v93, v233
    v_mul_f32 v30, v94, v234
    v_mul_f32 v31, v95, v235
    v_fma_f32 v24, -v92, v236, v24
    v_fma_f32 v25, -v93, v237, v25
    v_fma_f32 v26, -v94, v238, v26
    v_fma_f32 v27, -v95, v239, v27
    v_fmac_f32 v28, v76, v236
    v_fmac_f32 v29, v77, v237
    v_fmac_f32 v30, v78, v238
    v_fmac_f32 v31, v79, v239
    v_cvt_pk_bf16_f32 v42, v24, v25
    v_cvt_pk_bf16_f32 v43, v26, v27
    v_cvt_pk_bf16_f32 v50, v28, v29
    v_cvt_pk_bf16_f32 v51, v30, v31
    v_mul_f32 v24, v80, v240
    v_mul_f32 v25, v81, v241
    v_mul_f32 v26, v82, v242
    v_mul_f32 v27, v83, v243
    v_mul_f32 v28, v96, v240
    v_mul_f32 v29, v97, v241
    v_mul_f32 v30, v98, v242
    v_mul_f32 v31, v99, v243
    v_fma_f32 v24, -v96, v244, v24
    v_fma_f32 v25, -v97, v245, v25
    v_fma_f32 v26, -v98, v246, v26
    v_fma_f32 v27, -v99, v247, v27
    v_fmac_f32 v28, v80, v244
    v_fmac_f32 v29, v81, v245
    v_fmac_f32 v30, v82, v246
    v_fmac_f32 v31, v83, v247
    v_cvt_pk_bf16_f32 v44, v24, v25
    v_cvt_pk_bf16_f32 v45, v26, v27
    v_cvt_pk_bf16_f32 v52, v28, v29
    v_cvt_pk_bf16_f32 v53, v30, v31
    v_mul_f32 v24, v84, v248
    v_mul_f32 v25, v85, v249
    v_mul_f32 v26, v86, v250
    v_mul_f32 v27, v87, v251
    v_mul_f32 v28, v100, v248
    v_mul_f32 v29, v101, v249
    v_mul_f32 v30, v102, v250
    v_mul_f32 v31, v103, v251
    v_fma_f32 v24, -v100, v252, v24
    v_fma_f32 v25, -v101, v253, v25
    v_fma_f32 v26, -v102, v254, v26
    v_fma_f32 v27, -v103, v255, v27
    v_fmac_f32 v28, v84, v252
    v_fmac_f32 v29, v85, v253
    v_fmac_f32 v30, v86, v254
    v_fmac_f32 v31, v87, v255
    v_cvt_pk_bf16_f32 v46, v24, v25
    v_cvt_pk_bf16_f32 v47, v26, v27
    v_cvt_pk_bf16_f32 v54, v28, v29
    v_cvt_pk_bf16_f32 v55, v30, v31
    s_nop 0
    v_mfma_f32_32x32x16_bf16 v[72:87], v[120:123], v[40:43], 0
    v_mfma_f32_32x32x16_bf16 v[88:103], v[120:123], v[48:51], 0
    v_mfma_f32_32x32x16_bf16 v[72:87], v[128:131], v[48:51], v[72:87]
    v_mfma_f32_32x32x16_bf16 v[88:103], v[124:127], v[40:43], v[88:103]
    v_mfma_f32_32x32x16_bf16 v[72:87], v[132:135], v[44:47], v[72:87]
    v_mfma_f32_32x32x16_bf16 v[88:103], v[132:135], v[52:55], v[88:103]
    v_mfma_f32_32x32x16_bf16 v[72:87], v[140:143], v[52:55], v[72:87]
    v_mfma_f32_32x32x16_bf16 v[88:103], v[136:139], v[44:47], v[88:103]
    s_nop 10
    v_cvt_pk_bf16_f32 v56, v72, v73
    v_cvt_pk_bf16_f32 v57, v74, v75
    v_cvt_pk_bf16_f32 v58, v76, v77
    v_cvt_pk_bf16_f32 v59, v78, v79
    buffer_store_dwordx4 v[56:59], v7, s[12:15], s26 offen offset:0 sc0 sc1
    v_cvt_pk_bf16_f32 v60, v80, v81
    v_cvt_pk_bf16_f32 v61, v82, v83
    v_cvt_pk_bf16_f32 v62, v84, v85
    v_cvt_pk_bf16_f32 v63, v86, v87
    buffer_store_dwordx4 v[60:63], v7, s[12:15], s26 offen offset:64 sc0 sc1
    s_cmp_eq_u32 s25, 0
    s_cbranch_scc1 k_noim
    v_cvt_pk_bf16_f32 v64, v88, v89
    v_cvt_pk_bf16_f32 v65, v90, v91
    v_cvt_pk_bf16_f32 v66, v92, v93
    v_cvt_pk_bf16_f32 v67, v94, v95
    buffer_store_dwordx4 v[64:67], v7, s[12:15], s27 offen offset:0 sc0 sc1
    v_cvt_pk_bf16_f32 v68, v96, v97
    v_cvt_pk_bf16_f32 v69, v98, v99
    v_cvt_pk_bf16_f32 v70, v100, v101
    v_cvt_pk_bf16_f32 v71, v102, v103
    buffer_store_dwordx4 v[68:71], v7, s[12:15], s27 offen offset:64 sc0 sc1
k_noim:
    s_setprio 0
    s_cmp_eq_u32 s60, 1
    s_cbranch_scc1 k_join
    s_and_b32 s29, s20, 15
    s_lshl_b32 s29, s29, 7
    s_add_u32 s29, s29, 29491200
    s_mov_b32 s28, 1
    s_waitcnt vmcnt(0)
    s_atomic_add s28, s[58:59], s29
    s_add_u32 s29, s29, 2048
    s_atomic_add s28, s[58:59], s29
    s_add_u32 s29, s29, 2048
    s_atomic_add s28, s[58:59], s29
    s_add_u32 s29, s29, 2048
    s_atomic_add s28, s[58:59], s29
    s_add_u32 s29, s29, 2048
    s_atomic_add s28, s[58:59], s29
    s_add_u32 s29, s29, 2048
    s_atomic_add s28, s[58:59], s29
    s_add_u32 s29, s29, 2048
    s_atomic_add s28, s[58:59], s29
    s_add_u32 s29, s29, 2048
    s_atomic_add s28, s[58:59], s29
    s_branch k_fg3
k_idle:
    s_mov_b32 s60, 0
    s_and_b32 s26, s19, 1
    s_lshl_b32 s26, s26, 1
    s_add_u32 s27, s26, 1
    s_mov_b32 s36, s52
    s_mov_b32 s37, s53
    s_mov_b32 s38, 1966080
    s_mov_b32 s39, 0x20000
    s_mul_i32 s25, s18, 160
    s_mul_i32 s28, s3, 983040
    s_add_u32 s25, s25, s28
    s_lshl_b32 s23, s26, 10
    s_lshl_b32 s28, s26, 6
    v_add_u32 v16, s28, v0
    s_movk_i32 s29, 1120
    s_mov_b32 s30, 40960
    v_add_u32 v17, 0, v16
    v_mul_u32_u24 v18, 6554, v17
    v_lshrrev_b32 v18, 16, v18
    v_lshlrev_b32 v17, 4, v17
    v_mad_u32_u24 v17, v18, s29, v17
    v_lshrrev_b32 v18, 5, v18
    v_mad_u32_u24 v8, v18, s30, v17
    v_add_u32 v17, 256, v16
    v_mul_u32_u24 v18, 6554, v17
    v_lshrrev_b32 v18, 16, v18
    v_lshlrev_b32 v17, 4, v17
    v_mad_u32_u24 v17, v18, s29, v17
    v_lshrrev_b32 v18, 5, v18
    v_mad_u32_u24 v9, v18, s30, v17
    v_add_u32 v17, 512, v16
    v_mul_u32_u24 v18, 6554, v17
    v_lshrrev_b32 v18, 16, v18
    v_lshlrev_b32 v17, 4, v17
    v_mad_u32_u24 v17, v18, s29, v17
    v_lshrrev_b32 v18, 5, v18
    v_mad_u32_u24 v10, v18, s30, v17
    v_add_u32 v17, 768, v16
    v_mul_u32_u24 v18, 6554, v17
    v_lshrrev_b32 v18, 16, v18
    v_lshlrev_b32 v17, 4, v17
    v_mad_u32_u24 v17, v18, s29, v17
    v_lshrrev_b32 v18, 5, v18
    v_mad_u32_u24 v11, v18, s30, v17
    v_add_u32 v17, 1024, v16
    v_mul_u32_u24 v18, 6554, v17
    v_lshrrev_b32 v18, 16, v18
    v_lshlrev_b32 v17, 4, v17
    v_mad_u32_u24 v17, v18, s29, v17
    v_lshrrev_b32 v18, 5, v18
    v_mad_u32_u24 v12, v18, s30, v17
    s_mov_b32 s36, s52
    s_mov_b32 s37, s53
    s_mov_b32 s38, 1966080
    s_mov_b32 s39, 0x20000
    s_mul_i32 s25, s18, 160
    s_mul_i32 s28, s3, 983040
    s_add_u32 s25, s25, s28
    s_lshl_b32 s21, s27, 10
    s_lshl_b32 s28, s27, 6
    v_add_u32 v16, s28, v0
    s_movk_i32 s29, 1120
    s_mov_b32 s30, 40960
    v_add_u32 v17, 0, v16
    v_mul_u32_u24 v18, 6554, v17
    v_lshrrev_b32 v18, 16, v18
    v_lshlrev_b32 v17, 4, v17
    v_mad_u32_u24 v17, v18, s29, v17
    v_lshrrev_b32 v18, 5, v18
    v_mad_u32_u24 v61, v18, s30, v17
    v_add_u32 v17, 256, v16
    v_mul_u32_u24 v18, 6554, v17
    v_lshrrev_b32 v18, 16, v18
    v_lshlrev_b32 v17, 4, v17
    v_mad_u32_u24 v17, v18, s29, v17
    v_lshrrev_b32 v18, 5, v18
    v_mad_u32_u24 v62, v18, s30, v17
    v_add_u32 v17, 512, v16
    v_mul_u32_u24 v18, 6554, v17
    v_lshrrev_b32 v18, 16, v18
    v_lshlrev_b32 v17, 4, v17
    v_mad_u32_u24 v17, v18, s29, v17
    v_lshrrev_b32 v18, 5, v18
    v_mad_u32_u24 v63, v18, s30, v17
    v_add_u32 v17, 768, v16
    v_mul_u32_u24 v18, 6554, v17
    v_lshrrev_b32 v18, 16, v18
    v_lshlrev_b32 v17, 4, v17
    v_mad_u32_u24 v17, v18, s29, v17
    v_lshrrev_b32 v18, 5, v18
    v_mad_u32_u24 v64, v18, s30, v17
    v_add_u32 v17, 1024, v16
    v_mul_u32_u24 v18, 6554, v17
    v_lshrrev_b32 v18, 16, v18
    v_lshlrev_b32 v17, 4, v17
    v_mad_u32_u24 v17, v18, s29, v17
    v_lshrrev_b32 v18, 5, v18
    v_mad_u32_u24 v65, v18, s30, v17
    s_add_u32 s24, s25, 0
    s_add_u32 m0, s23, 69376
    s_nop 0
    buffer_load_dwordx4 v8, s[36:39], s24 offen lds
    s_add_u32 m0, s23, 73472
    s_nop 0
    buffer_load_dwordx4 v9, s[36:39], s24 offen lds
    s_add_u32 m0, s23, 77568
    s_nop 0
    buffer_load_dwordx4 v10, s[36:39], s24 offen lds
    s_add_u32 m0, s23, 81664
    s_nop 0
    buffer_load_dwordx4 v11, s[36:39], s24 offen lds
    s_add_u32 m0, s23, 85760
    s_nop 0
    buffer_load_dwordx4 v12, s[36:39], s24 offen lds
    s_add_u32 s24, s25, 327680
    s_add_u32 m0, s23, 89856
    s_nop 0
    buffer_load_dwordx4 v8, s[36:39], s24 offen lds
    s_add_u32 m0, s23, 93952
    s_nop 0
    buffer_load_dwordx4 v9, s[36:39], s24 offen lds
    s_add_u32 m0, s23, 98048
    s_nop 0
    buffer_load_dwordx4 v10, s[36:39], s24 offen lds
    s_add_u32 m0, s23, 102144
    s_nop 0
    buffer_load_dwordx4 v11, s[36:39], s24 offen lds
    s_add_u32 m0, s23, 106240
    s_nop 0
    buffer_load_dwordx4 v12, s[36:39], s24 offen lds
    s_add_u32 s24, s25, 655360
    s_add_u32 m0, s23, 110336
    s_nop 0
    buffer_load_dwordx4 v8, s[36:39], s24 offen lds
    s_add_u32 m0, s23, 114432
    s_nop 0
    buffer_load_dwordx4 v9, s[36:39], s24 offen lds
    s_add_u32 m0, s23, 118528
    s_nop 0
    buffer_load_dwordx4 v10, s[36:39], s24 offen lds
    s_add_u32 m0, s23, 122624
    s_nop 0
    buffer_load_dwordx4 v11, s[36:39], s24 offen lds
    s_add_u32 m0, s23, 126720
    s_nop 0
    buffer_load_dwordx4 v12, s[36:39], s24 offen lds
    s_add_u32 s24, s25, 0
    s_add_u32 m0, s21, 69376
    s_nop 0
    buffer_load_dwordx4 v61, s[36:39], s24 offen lds
    s_add_u32 m0, s21, 73472
    s_nop 0
    buffer_load_dwordx4 v62, s[36:39], s24 offen lds
    s_add_u32 m0, s21, 77568
    s_nop 0
    buffer_load_dwordx4 v63, s[36:39], s24 offen lds
    s_add_u32 m0, s21, 81664
    s_nop 0
    buffer_load_dwordx4 v64, s[36:39], s24 offen lds
    s_add_u32 m0, s21, 85760
    s_nop 0
    buffer_load_dwordx4 v65, s[36:39], s24 offen lds
    s_add_u32 s24, s25, 327680
    s_add_u32 m0, s21, 89856
    s_nop 0
    buffer_load_dwordx4 v61, s[36:39], s24 offen lds
    s_add_u32 m0, s21, 93952
    s_nop 0
    buffer_load_dwordx4 v62, s[36:39], s24 offen lds
    s_add_u32 m0, s21, 98048
    s_nop 0
    buffer_load_dwordx4 v63, s[36:39], s24 offen lds
    s_add_u32 m0, s21, 102144
    s_nop 0
    buffer_load_dwordx4 v64, s[36:39], s24 offen lds
    s_add_u32 m0, s21, 106240
    s_nop 0
    buffer_load_dwordx4 v65, s[36:39], s24 offen lds
    s_add_u32 s24, s25, 655360
    s_add_u32 m0, s21, 110336
    s_nop 0
    buffer_load_dwordx4 v61, s[36:39], s24 offen lds
    s_add_u32 m0, s21, 114432
    s_nop 0
    buffer_load_dwordx4 v62, s[36:39], s24 offen lds
    s_add_u32 m0, s21, 118528
    s_nop 0
    buffer_load_dwordx4 v63, s[36:39], s24 offen lds
    s_add_u32 m0, s21, 122624
    s_nop 0
    buffer_load_dwordx4 v64, s[36:39], s24 offen lds
    s_add_u32 m0, s21, 126720
    s_nop 0
    buffer_load_dwordx4 v65, s[36:39], s24 offen lds
    s_waitcnt vmcnt(0)
    s_lshl_b32 s28, s19, 2
    s_add_u32 s28, s28, 163784
    v_mov_b32 v20, s28
    v_mov_b32 v16, 1
    ds_write_b32 v20, v16
    s_cmp_eq_u32 s19, 2
    s_cbranch_scc1 k_fill6
    v_and_b32 v20, 3, v0
    v_lshlrev_b32 v20, 2, v20
    v_add_u32 v20, 163648, v20
k_g1done:
    ds_read_b32 v16, v20
    s_waitcnt lgkmcnt(0)
    v_cmp_gt_u32 vcc, 1, v16
    s_cbranch_vccz k_g1done_out
    s_sleep 2
    s_sub_u32 s97, s97, 1
    s_cmp_gt_i32 s97, 0
    s_cbranch_scc1 k_g1done
k_g1done_out:
    v_and_b32 v20, 1, v0
    v_lshlrev_b32 v20, 2, v20
    v_add_u32 v20, 163760, v20
k_gyw:
    ds_read_b32 v16, v20
    s_waitcnt lgkmcnt(0)
    v_cmp_gt_u32 vcc, 1, v16
    s_cbranch_vccz k_gyw_out
    s_sleep 2
    s_sub_u32 s97, s97, 1
    s_cmp_gt_i32 s97, 0
    s_cbranch_scc1 k_gyw
k_gyw_out:
    s_add_u32 s24, s25, 40960
    s_add_u32 m0, s23, 48896
    s_nop 0
    buffer_load_dwordx4 v8, s[36:39], s24 offen lds
    s_add_u32 m0, s23, 52992
    s_nop 0
    buffer_load_dwordx4 v9, s[36:39], s24 offen lds
    s_add_u32 m0, s23, 57088
    s_nop 0
    buffer_load_dwordx4 v10, s[36:39], s24 offen lds
    s_add_u32 m0, s23, 61184
    s_nop 0
    buffer_load_dwordx4 v11, s[36:39], s24 offen lds
    s_add_u32 m0, s23, 65280
    s_nop 0
    buffer_load_dwordx4 v12, s[36:39], s24 offen lds
    s_add_u32 s24, s25, 368640
    s_add_u32 m0, s23, 0
    s_nop 0
    buffer_load_dwordx4 v8, s[36:39], s24 offen lds
    s_add_u32 m0, s23, 4096
    s_nop 0
    buffer_load_dwordx4 v9, s[36:39], s24 offen lds
    s_add_u32 m0, s23, 8192
    s_nop 0
    buffer_load_dwordx4 v10, s[36:39], s24 offen lds
    s_add_u32 m0, s23, 12288
    s_nop 0
    buffer_load_dwordx4 v11, s[36:39], s24 offen lds
    s_add_u32 m0, s23, 16384
    s_nop 0
    buffer_load_dwordx4 v12, s[36:39], s24 offen lds
    s_add_u32 s24, s25, 696320
    s_add_u32 m0, s23, 20480
    s_nop 0
    buffer_load_dwordx4 v8, s[36:39], s24 offen lds
    s_add_u32 m0, s23, 24576
    s_nop 0
    buffer_load_dwordx4 v9, s[36:39], s24 offen lds
    s_add_u32 m0, s23, 28672
    s_nop 0
    buffer_load_dwordx4 v10, s[36:39], s24 offen lds
    s_add_u32 m0, s23, 32768
    s_nop 0
    buffer_load_dwordx4 v11, s[36:39], s24 offen lds
    s_add_u32 m0, s23, 36864
    s_nop 0
    buffer_load_dwordx4 v12, s[36:39], s24 offen lds
    s_add_u32 s24, s25, 40960
    s_add_u32 m0, s21, 48896
    s_nop 0
    buffer_load_dwordx4 v61, s[36:39], s24 offen lds
    s_add_u32 m0, s21, 52992
    s_nop 0
    buffer_load_dwordx4 v62, s[36:39], s24 offen lds
    s_add_u32 m0, s21, 57088
    s_nop 0
    buffer_load_dwordx4 v63, s[36:39], s24 offen lds
    s_add_u32 m0, s21, 61184
    s_nop 0
    buffer_load_dwordx4 v64, s[36:39], s24 offen lds
    s_add_u32 m0, s21, 65280
    s_nop 0
    buffer_load_dwordx4 v65, s[36:39], s24 offen lds
    s_add_u32 s24, s25, 368640
    s_add_u32 m0, s21, 0
    s_nop 0
    buffer_load_dwordx4 v61, s[36:39], s24 offen lds
    s_add_u32 m0, s21, 4096
    s_nop 0
    buffer_load_dwordx4 v62, s[36:39], s24 offen lds
    s_add_u32 m0, s21, 8192
    s_nop 0
    buffer_load_dwordx4 v63, s[36:39], s24 offen lds
    s_add_u32 m0, s21, 12288
    s_nop 0
    buffer_load_dwordx4 v64, s[36:39], s24 offen lds
    s_add_u32 m0, s21, 16384
    s_nop 0
    buffer_load_dwordx4 v65, s[36:39], s24 offen lds
    s_add_u32 s24, s25, 696320
    s_add_u32 m0, s21, 20480
    s_nop 0
    buffer_load_dwordx4 v61, s[36:39], s24 offen lds
    s_add_u32 m0, s21, 24576
    s_nop 0
    buffer_load_dwordx4 v62, s[36:39], s24 offen lds
    s_add_u32 m0, s21, 28672
    s_nop 0
    buffer_load_dwordx4 v63, s[36:39], s24 offen lds
    s_add_u32 m0, s21, 32768
    s_nop 0
    buffer_load_dwordx4 v64, s[36:39], s24 offen lds
    s_add_u32 m0, s21, 36864
    s_nop 0
    buffer_load_dwordx4 v65, s[36:39], s24 offen lds
    s_mov_b32 s26, 0
    s_mov_b32 s27, 1
    s_mov_b32 s36, s52
    s_mov_b32 s37, s53
    s_mov_b32 s38, 1966080
    s_mov_b32 s39, 0x20000
    s_mul_i32 s25, s18, 160
    s_mul_i32 s28, s3, 983040
    s_add_u32 s25, s25, s28
    s_lshl_b32 s23, s26, 10
    s_lshl_b32 s28, s26, 6
    v_add_u32 v16, s28, v0
    s_movk_i32 s29, 1120
    s_mov_b32 s30, 40960
    v_add_u32 v17, 0, v16
    v_mul_u32_u24 v18, 6554, v17
    v_lshrrev_b32 v18, 16, v18
    v_lshlrev_b32 v17, 4, v17
    v_mad_u32_u24 v17, v18, s29, v17
    v_lshrrev_b32 v18, 5, v18
    v_mad_u32_u24 v8, v18, s30, v17
    v_add_u32 v17, 256, v16
    v_mul_u32_u24 v18, 6554, v17
    v_lshrrev_b32 v18, 16, v18
    v_lshlrev_b32 v17, 4, v17
    v_mad_u32_u24 v17, v18, s29, v17
    v_lshrrev_b32 v18, 5, v18
    v_mad_u32_u24 v9, v18, s30, v17
    v_add_u32 v17, 512, v16
    v_mul_u32_u24 v18, 6554, v17
    v_lshrrev_b32 v18, 16, v18
    v_lshlrev_b32 v17, 4, v17
    v_mad_u32_u24 v17, v18, s29, v17
    v_lshrrev_b32 v18, 5, v18
    v_mad_u32_u24 v10, v18, s30, v17
    v_add_u32 v17, 768, v16
    v_mul_u32_u24 v18, 6554, v17
    v_lshrrev_b32 v18, 16, v18
    v_lshlrev_b32 v17, 4, v17
    v_mad_u32_u24 v17, v18, s29, v17
    v_lshrrev_b32 v18, 5, v18
    v_mad_u32_u24 v11, v18, s30, v17
    v_add_u32 v17, 1024, v16
    v_mul_u32_u24 v18, 6554, v17
    v_lshrrev_b32 v18, 16, v18
    v_lshlrev_b32 v17, 4, v17
    v_mad_u32_u24 v17, v18, s29, v17
    v_lshrrev_b32 v18, 5, v18
    v_mad_u32_u24 v12, v18, s30, v17
    s_mov_b32 s36, s52
    s_mov_b32 s37, s53
    s_mov_b32 s38, 1966080
    s_mov_b32 s39, 0x20000
    s_mul_i32 s25, s18, 160
    s_mul_i32 s28, s3, 983040
    s_add_u32 s25, s25, s28
    s_lshl_b32 s21, s27, 10
    s_lshl_b32 s28, s27, 6
    v_add_u32 v16, s28, v0
    s_movk_i32 s29, 1120
    s_mov_b32 s30, 40960
    v_add_u32 v17, 0, v16
    v_mul_u32_u24 v18, 6554, v17
    v_lshrrev_b32 v18, 16, v18
    v_lshlrev_b32 v17, 4, v17
    v_mad_u32_u24 v17, v18, s29, v17
    v_lshrrev_b32 v18, 5, v18
    v_mad_u32_u24 v61, v18, s30, v17
    v_add_u32 v17, 256, v16
    v_mul_u32_u24 v18, 6554, v17
    v_lshrrev_b32 v18, 16, v18
    v_lshlrev_b32 v17, 4, v17
    v_mad_u32_u24 v17, v18, s29, v17
    v_lshrrev_b32 v18, 5, v18
    v_mad_u32_u24 v62, v18, s30, v17
    v_add_u32 v17, 512, v16
    v_mul_u32_u24 v18, 6554, v17
    v_lshrrev_b32 v18, 16, v18
    v_lshlrev_b32 v17, 4, v17
    v_mad_u32_u24 v17, v18, s29, v17
    v_lshrrev_b32 v18, 5, v18
    v_mad_u32_u24 v63, v18, s30, v17
    v_add_u32 v17, 768, v16
    v_mul_u32_u24 v18, 6554, v17
    v_lshrrev_b32 v18, 16, v18
    v_lshlrev_b32 v17, 4, v17
    v_mad_u32_u24 v17, v18, s29, v17
    v_lshrrev_b32 v18, 5, v18
    v_mad_u32_u24 v64, v18, s30, v17
    v_add_u32 v17, 1024, v16
    v_mul_u32_u24 v18, 6554, v17
    v_lshrrev_b32 v18, 16, v18
    v_lshlrev_b32 v17, 4, v17
    v_mad_u32_u24 v17, v18, s29, v17
    v_lshrrev_b32 v18, 5, v18
    v_mad_u32_u24 v65, v18, s30, v17
    s_waitcnt vmcnt(30)
    s_add_u32 s24, s25, 40960
    s_add_u32 m0, s23, 48896
    s_nop 0
    buffer_load_dwordx4 v8, s[36:39], s24 offen lds
    s_add_u32 m0, s23, 52992
    s_nop 0
    buffer_load_dwordx4 v9, s[36:39], s24 offen lds
    s_add_u32 m0, s23, 57088
    s_nop 0
    buffer_load_dwordx4 v10, s[36:39], s24 offen lds
    s_add_u32 m0, s23, 61184
    s_nop 0
    buffer_load_dwordx4 v11, s[36:39], s24 offen lds
    s_add_u32 m0, s23, 65280
    s_nop 0
    buffer_load_dwordx4 v12, s[36:39], s24 offen lds
    s_add_u32 s24, s25, 368640
    s_add_u32 m0, s23, 0
    s_nop 0
    buffer_load_dwordx4 v8, s[36:39], s24 offen lds
    s_add_u32 m0, s23, 4096
    s_nop 0
    buffer_load_dwordx4 v9, s[36:39], s24 offen lds
    s_add_u32 m0, s23, 8192
    s_nop 0
    buffer_load_dwordx4 v10, s[36:39], s24 offen lds
    s_add_u32 m0, s23, 12288
    s_nop 0
    buffer_load_dwordx4 v11, s[36:39], s24 offen lds
    s_add_u32 m0, s23, 16384
    s_nop 0
    buffer_load_dwordx4 v12, s[36:39], s24 offen lds
    s_add_u32 s24, s25, 696320
    s_add_u32 m0, s23, 20480
    s_nop 0
    buffer_load_dwordx4 v8, s[36:39], s24 offen lds
    s_add_u32 m0, s23, 24576
    s_nop 0
    buffer_load_dwordx4 v9, s[36:39], s24 offen lds
    s_add_u32 m0, s23, 28672
    s_nop 0
    buffer_load_dwordx4 v10, s[36:39], s24 offen lds
    s_add_u32 m0, s23, 32768
    s_nop 0
    buffer_load_dwordx4 v11, s[36:39], s24 offen lds
    s_add_u32 m0, s23, 36864
    s_nop 0
    buffer_load_dwordx4 v12, s[36:39], s24 offen lds
    s_add_u32 s24, s25, 40960
    s_add_u32 m0, s21, 48896
    s_nop 0
    buffer_load_dwordx4 v61, s[36:39], s24 offen lds
    s_add_u32 m0, s21, 52992
    s_nop 0
    buffer_load_dwordx4 v62, s[36:39], s24 offen lds
    s_add_u32 m0, s21, 57088
    s_nop 0
    buffer_load_dwordx4 v63, s[36:39], s24 offen lds
    s_add_u32 m0, s21, 61184
    s_nop 0
    buffer_load_dwordx4 v64, s[36:39], s24 offen lds
    s_add_u32 m0, s21, 65280
    s_nop 0
    buffer_load_dwordx4 v65, s[36:39], s24 offen lds
    s_add_u32 s24, s25, 368640
    s_add_u32 m0, s21, 0
    s_nop 0
    buffer_load_dwordx4 v61, s[36:39], s24 offen lds
    s_add_u32 m0, s21, 4096
    s_nop 0
    buffer_load_dwordx4 v62, s[36:39], s24 offen lds
    s_add_u32 m0, s21, 8192
    s_nop 0
    buffer_load_dwordx4 v63, s[36:39], s24 offen lds
    s_add_u32 m0, s21, 12288
    s_nop 0
    buffer_load_dwordx4 v64, s[36:39], s24 offen lds
    s_add_u32 m0, s21, 16384
    s_nop 0
    buffer_load_dwordx4 v65, s[36:39], s24 offen lds
    s_add_u32 s24, s25, 696320
    s_add_u32 m0, s21, 20480
    s_nop 0
    buffer_load_dwordx4 v61, s[36:39], s24 offen lds
    s_add_u32 m0, s21, 24576
    s_nop 0
    buffer_load_dwordx4 v62, s[36:39], s24 offen lds
    s_add_u32 m0, s21, 28672
    s_nop 0
    buffer_load_dwordx4 v63, s[36:39], s24 offen lds
    s_add_u32 m0, s21, 32768
    s_nop 0
    buffer_load_dwordx4 v64, s[36:39], s24 offen lds
    s_add_u32 m0, s21, 36864
    s_nop 0
    buffer_load_dwordx4 v65, s[36:39], s24 offen lds
    s_waitcnt vmcnt(0)
    v_mov_b32 v16, 163640
    v_mov_b32 v17, 1
    ds_write_b32 v16, v17
    s_branch k_join
k_fill6:
    v_and_b32 v20, 1, v0
    v_lshlrev_b32 v20, 2, v20
    v_add_u32 v20, 163792, v20
k_fill7:
    ds_read_b32 v16, v20
    s_waitcnt lgkmcnt(0)
    v_cmp_gt_u32 vcc, 1, v16
    s_cbranch_vccz k_fill7_out
    s_sleep 1
    s_sub_u32 s97, s97, 1
    s_cmp_gt_i32 s97, 0
    s_cbranch_scc1 k_fill7
k_fill7_out:
    v_mov_b32 v16, 163776
k_hsig:
    ds_read_b32 v17, v16
    s_waitcnt lgkmcnt(0)
    v_readfirstlane_b32 s28, v17
    s_cmp_lg_u32 s28, 0
    s_cbranch_scc1 k_hsig_ok
    s_sleep 2
    s_sub_u32 s97, s97, 1
    s_cmp_gt_i32 s97, 0
    s_cbranch_scc1 k_hsig
k_hsig_ok:
    s_lshl_b32 s61, s17, 7
    s_add_u32 s61, s61, 29510656
    v_mov_b32 v16, 0
    v_mov_b32 v18, 24
k_hq:
    buffer_load_dword v17, v16, s[12:15], s61 offen sc1
    s_waitcnt vmcnt(0)
    v_cmp_eq_u32 vcc, v17, v18
    s_cmp_eq_u64 vcc, -1
    s_cbranch_scc1 k_hq_ok
    s_sleep 2
    s_sub_u32 s97, s97, 1
    s_cmp_gt_i32 s97, 0
    s_cbranch_scc1 k_hq
k_hq_ok:
    v_mov_b32 v16, 163636
    v_mov_b32 v17, 1
    ds_write_b32 v16, v17
k_join:
    s_lshr_b32 s30, s19, 1
    s_mul_i32 s34, s30, 0x3e800000
    s_lshl_b32 s30, s30, 31
    s_and_b32 s29, s19, 1
    s_mul_i32 s31, s29, 5
    s_cmp_eq_u32 s29, 0
    s_cselect_b64 s[32:33], 0xffff, 0
    s_mov_b32 s35, 0x3acccccd
    s_mul_i32 s28, s18, 80
    v_lshlrev_b32 v23, 31, v0
    v_and_b32 v23, s30, v23
    v_xor_b32 v23, 0.5, v23
    v_lshrrev_b32 v22, 4, v0
    v_mul_u32_u24 v22, 80, v22
    v_add_u32 v22, s31, v22
    v_cvt_f32_u32 v22, v22
    v_and_b32 v56, 15, v0
    v_add_u32 v56, s28, v56
    v_cvt_f32_u32 v24, v56
    v_add_f32 v25, 0x41800000, v24
    v_add_f32 v26, 0x42000000, v24
    v_add_f32 v27, 0x42400000, v24
    v_add_f32 v28, 0x42800000, v24
    v_mul_f32 v72, v22, v24
    v_mul_f32 v88, v22, v25
    v_mul_f32 v104, v22, v26
    v_mul_f32 v120, v22, v27
    v_mul_f32 v136, v22, v28
    v_mul_f32 v56, s35, v72
    v_mul_f32 v57, s35, v88
    v_mul_f32 v58, s35, v104
    v_mul_f32 v59, s35, v120
    v_mul_f32 v60, s35, v136
    v_mul_f32 v34, 0x3c800000, v24
    v_mul_f32 v35, 0x3c800000, v25
    v_mul_f32 v36, 0x3c800000, v26
    v_mul_f32 v37, 0x3c800000, v27
    v_mul_f32 v38, 0x3c800000, v28
    v_floor_f32 v56, v56
    v_floor_f32 v57, v57
    v_floor_f32 v58, v58
    v_floor_f32 v59, v59
    v_floor_f32 v60, v60
    v_mul_f32 v29, s35, v24
    v_mul_f32 v30, s35, v25
    v_mul_f32 v31, s35, v26
    v_mul_f32 v32, s35, v27
    v_mul_f32 v33, s35, v28
    v_fmac_f32 v72, 0xc4200000, v56
    v_fmac_f32 v88, 0xc4200000, v57
    v_fmac_f32 v104, 0xc4200000, v58
    v_fmac_f32 v120, 0xc4200000, v59
    v_fmac_f32 v136, 0xc4200000, v60
    v_fract_f32 v34, v34
    v_fract_f32 v35, v35
    v_fract_f32 v36, v36
    v_fract_f32 v37, v37
    v_fract_f32 v38, v38
    v_mul_f32 v72, s35, v72
    v_mul_f32 v88, s35, v88
    v_mul_f32 v104, s35, v104
    v_mul_f32 v120, s35, v120
    v_mul_f32 v136, s35, v136
    v_add_f32 v72, s34, v72
    v_add_f32 v88, s34, v88
    v_add_f32 v104, s34, v104
    v_add_f32 v120, s34, v120
    v_add_f32 v136, s34, v136
    v_add_f32 v80, v72, v29
    v_add_f32 v96, v88, v30
    v_add_f32 v112, v104, v31
    v_add_f32 v128, v120, v32
    v_add_f32 v144, v136, v33
    v_add_f32 v73, v72, v34
    v_add_f32 v89, v88, v35
    v_add_f32 v105, v104, v36
    v_add_f32 v121, v120, v37
    v_add_f32 v137, v136, v38
    v_add_f32 v81, v80, v34
    v_add_f32 v97, v96, v35
    v_add_f32 v113, v112, v36
    v_add_f32 v129, v128, v37
    v_add_f32 v145, v144, v38
    v_cos_f32 v34, v34
    v_cos_f32 v35, v35
    v_cos_f32 v36, v36
    v_cos_f32 v37, v37
    v_cos_f32 v38, v38
    v_cos_f32 v72, v72
    v_cos_f32 v73, v73
    v_cos_f32 v80, v80
    v_cos_f32 v81, v81
    v_cos_f32 v88, v88
    v_cos_f32 v89, v89
    v_cos_f32 v96, v96
    v_cos_f32 v97, v97
    v_cos_f32 v104, v104
    v_cos_f32 v105, v105
    v_cos_f32 v112, v112
    v_cos_f32 v113, v113
    v_cos_f32 v120, v120
    v_cos_f32 v121, v121
    v_cos_f32 v128, v128
    v_cos_f32 v129, v129
    v_cos_f32 v136, v136
    v_cos_f32 v137, v137
    v_cos_f32 v144, v144
    v_cos_f32 v145, v145
    v_cos_f32 v29, v29
    v_cos_f32 v30, v30
    v_cos_f32 v31, v31
    v_cos_f32 v32, v32
    v_cos_f32 v33, v33
    v_add_f32 v34, v34, v34
    v_add_f32 v35, v35, v35
    v_add_f32 v36, v36, v36
    v_add_f32 v37, v37, v37
    v_add_f32 v38, v38, v38
    v_add_f32 v29, v29, v29
    v_add_f32 v30, v30, v30
    v_add_f32 v31, v31, v31
    v_add_f32 v32, v32, v32
    v_add_f32 v33, v33, v33
    s_cmp_eq_u32 s60, 0
    s_cbranch_scc1 k_nosig
    s_and_b32 s29, s20, 15
    s_lshl_b32 s29, s29, 7
    s_add_u32 s29, s29, 29491200
    s_mov_b32 s28, 1
    s_waitcnt vmcnt(0)
    s_atomic_add s28, s[58:59], s29
    s_add_u32 s29, s29, 2048
    s_atomic_add s28, s[58:59], s29
    s_add_u32 s29, s29, 2048
    s_atomic_add s28, s[58:59], s29
    s_add_u32 s29, s29, 2048
    s_atomic_add s28, s[58:59], s29
    s_add_u32 s29, s29, 2048
    s_atomic_add s28, s[58:59], s29
    s_add_u32 s29, s29, 2048
    s_atomic_add s28, s[58:59], s29
    s_add_u32 s29, s29, 2048
    s_atomic_add s28, s[58:59], s29
    s_add_u32 s29, s29, 2048
    s_atomic_add s28, s[58:59], s29
k_x4:
    ds_read_b32 v12, v5
    s_waitcnt lgkmcnt(0)
    v_cmp_gt_u32 vcc, 4, v12
    s_cbranch_vccz k_x4_out
    s_sleep 1
    s_sub_u32 s97, s97, 1
    s_cmp_gt_i32 s97, 0
    s_cbranch_scc1 k_x4
k_x4_out:
k_nosig:
    s_lshr_b32 s28, s19, 1
    s_lshl_b32 s28, s28, 10
    s_lshl_b32 s29, s17, 1
    s_add_u32 s28, s28, s29
    s_and_b32 s29, s19, 1
    s_add_u32 s28, s28, s29
    s_mul_i32 s28, s28, 1280
    s_mul_i32 s29, s18, 160
    s_add_u32 s24, s28, s29
    s_mov_b32 s29, 81920
    v_add_u32 v16, 0, v0
    v_mul_u32_u24 v17, 6554, v16
    v_lshrrev_b32 v17, 16, v17
    v_mul_u32_u24 v18, 10, v17
    v_sub_u32 v16, v16, v18
    v_mul_u32_u24 v18, 320, v17
    v_lshl_add_u32 v18, v16, 5, v18
    v_bfe_u32 v19, v17, 1, 2
    v_lshlrev_b32 v19, 4, v19
    v_xor_b32 v52, v18, v19
    v_and_b32 v18, 3, v17
    v_bfe_u32 v19, v17, 2, 1
    v_lshl_add_u32 v18, v19, 3, v18
    v_bfe_u32 v19, v17, 3, 1
    v_lshl_add_u32 v18, v19, 2, v18
    v_mul_lo_u32 v18, v18, s29
    v_lshl_add_u32 v8, v16, 4, v18
    v_add_u32 v16, 64, v0
    v_mul_u32_u24 v17, 6554, v16
    v_lshrrev_b32 v17, 16, v17
    v_mul_u32_u24 v18, 10, v17
    v_sub_u32 v16, v16, v18
    v_mul_u32_u24 v18, 320, v17
    v_lshl_add_u32 v18, v16, 5, v18
    v_bfe_u32 v19, v17, 1, 2
    v_lshlrev_b32 v19, 4, v19
    v_xor_b32 v53, v18, v19
    v_and_b32 v18, 3, v17
    v_bfe_u32 v19, v17, 2, 1
    v_lshl_add_u32 v18, v19, 3, v18
    v_bfe_u32 v19, v17, 3, 1
    v_lshl_add_u32 v18, v19, 2, v18
    v_mul_lo_u32 v18, v18, s29
    v_lshl_add_u32 v9, v16, 4, v18
    v_add_u32 v16, 128, v0
    v_mul_u32_u24 v17, 6554, v16
    v_lshrrev_b32 v17, 16, v17
    v_mul_u32_u24 v18, 10, v17
    v_sub_u32 v16, v16, v18
    v_mul_u32_u24 v18, 320, v17
    v_lshl_add_u32 v18, v16, 5, v18
    v_bfe_u32 v19, v17, 1, 2
    v_lshlrev_b32 v19, 4, v19
    v_xor_b32 v54, v18, v19
    v_and_b32 v18, 3, v17
    v_bfe_u32 v19, v17, 2, 1
    v_lshl_add_u32 v18, v19, 3, v18
    v_bfe_u32 v19, v17, 3, 1
    v_lshl_add_u32 v18, v19, 2, v18
    v_mul_lo_u32 v18, v18, s29
    v_lshl_add_u32 v10, v16, 4, v18
    v_lshrrev_b32 v16, 5, v0
    v_lshl_or_b32 v10, v16, 30, v10
    v_min_u32 v54, 5104, v54
    buffer_load_dwordx4 v[40:43], v8, s[4:7], s24 offen
    buffer_load_dwordx4 v[44:47], v9, s[4:7], s24 offen
    buffer_load_dwordx4 v[48:51], v10, s[4:7], s24 offen
    v_lshrrev_b32 v16, 3, v0
    v_mul_u32_u24 v16, 4224, v16
    v_bfe_u32 v17, v0, 1, 2
    v_bfe_u32 v18, v0, 4, 1
    v_xor_b32 v17, v17, v18
    v_and_b32 v18, 1, v0
    v_lshl_add_u32 v16, v18, 4, v16
    v_lshl_add_u32 v12, v17, 5, v16
    v_xor_b32 v17, 2, v17
    v_lshl_add_u32 v13, v17, 5, v16
    v_add_u32 v13, 33792, v13
    s_mul_i32 s26, s19, 675840
    s_lshl_b32 s28, s17, 7
    s_add_u32 s26, s26, s28
    s_add_u32 s26, s26, 25165824
    v_lshrrev_b32 v16, 4, v0
    v_bfe_u32 v17, v0, 2, 2
    v_lshl_add_u32 v18, v16, 3, v17
    v_lshlrev_b32 v18, 7, v18
    v_and_b32 v16, 1, v16
    v_lshrrev_b32 v17, 1, v17
    v_lshl_add_u32 v16, v16, 1, v17
    v_lshl_add_u32 v18, v16, 5, v18
    v_and_b32 v16, 3, v0
    v_lshl_add_u32 v18, v16, 3, v18
    v_add_u32 v11, s22, v18
    v_and_b32 v16, 15, v0
    v_lshlrev_b32 v14, 7, v16
    v_cmp_eq_u32 vcc, 0, v16
    v_mov_b32 v15, 40
    s_and_b32 s27, s2, 7
    s_lshl_b32 s27, s27, 11
    s_add_u32 s27, s27, 29491200
    v_cndmask_b32 v15, v15, 42, vcc
    v_fma_f32 v74, v34, v73, -v72
    v_fma_f32 v82, v34, v81, -v80
    v_fma_f32 v90, v35, v89, -v88
    v_fma_f32 v98, v35, v97, -v96
    v_fma_f32 v106, v36, v105, -v104
    v_fma_f32 v114, v36, v113, -v112
    v_fma_f32 v122, v37, v121, -v120
    v_fma_f32 v130, v37, v129, -v128
    v_fma_f32 v138, v38, v137, -v136
    v_fma_f32 v146, v38, v145, -v144
    v_fma_f32 v75, v34, v74, -v73
    v_fma_f32 v83, v34, v82, -v81
    v_fma_f32 v91, v35, v90, -v89
    v_fma_f32 v99, v35, v98, -v97
    v_fma_f32 v107, v36, v106, -v105
    v_fma_f32 v115, v36, v114, -v113
    v_fma_f32 v123, v37, v122, -v121
    v_fma_f32 v131, v37, v130, -v129
    v_fma_f32 v139, v38, v138, -v137
    v_fma_f32 v147, v38, v146, -v145
    v_fma_f32 v76, v34, v75, -v74
    v_fma_f32 v84, v34, v83, -v82
    v_fma_f32 v92, v35, v91, -v90
    v_fma_f32 v100, v35, v99, -v98
    v_fma_f32 v108, v36, v107, -v106
    v_fma_f32 v116, v36, v115, -v114
    v_fma_f32 v124, v37, v123, -v122
    v_fma_f32 v132, v37, v131, -v130
    v_fma_f32 v140, v38, v139, -v138
    v_fma_f32 v148, v38, v147, -v146
    v_fma_f32 v77, v34, v76, -v75
    v_fma_f32 v85, v34, v84, -v83
    v_fma_f32 v93, v35, v92, -v91
    v_fma_f32 v101, v35, v100, -v99
    v_fma_f32 v109, v36, v108, -v107
    v_fma_f32 v117, v36, v116, -v115
    v_fma_f32 v125, v37, v124, -v123
    v_fma_f32 v133, v37, v132, -v131
    v_fma_f32 v141, v38, v140, -v139
    v_fma_f32 v149, v38, v148, -v147
    v_fma_f32 v78, v34, v77, -v76
    v_fma_f32 v86, v34, v85, -v84
    v_fma_f32 v94, v35, v93, -v92
    v_fma_f32 v102, v35, v101, -v100
    v_fma_f32 v110, v36, v109, -v108
    v_fma_f32 v118, v36, v117, -v116
    v_fma_f32 v126, v37, v125, -v124
    v_fma_f32 v134, v37, v133, -v132
    v_fma_f32 v142, v38, v141, -v140
    v_fma_f32 v150, v38, v149, -v148
    v_fma_f32 v79, v34, v78, -v77
    v_fma_f32 v87, v34, v86, -v85
    v_fma_f32 v95, v35, v94, -v93
    v_fma_f32 v103, v35, v102, -v101
    v_fma_f32 v111, v36, v110, -v109
    v_fma_f32 v119, v36, v118, -v117
    v_fma_f32 v127, v37, v126, -v125
    v_fma_f32 v135, v37, v134, -v133
    v_fma_f32 v143, v38, v142, -v141
    v_fma_f32 v151, v38, v150, -v149
    v_cndmask_b32 v56, v72, v23, s[32:33]
    v_cndmask_b32 v57, v88, v23, s[32:33]
    v_cndmask_b32 v58, v104, v23, s[32:33]
    v_cndmask_b32 v59, v120, v23, s[32:33]
    v_cndmask_b32 v60, v136, v23, s[32:33]
    v_cvt_pk_bf16_f32 v152, v56, v73
    v_cvt_pk_bf16_f32 v153, v74, v75
    v_cvt_pk_bf16_f32 v154, v76, v77
    v_cvt_pk_bf16_f32 v155, v78, v79
    v_cvt_pk_bf16_f32 v172, v57, v89
    v_cvt_pk_bf16_f32 v173, v90, v91
    v_cvt_pk_bf16_f32 v174, v92, v93
    v_cvt_pk_bf16_f32 v175, v94, v95
    v_cvt_pk_bf16_f32 v192, v58, v105
    v_cvt_pk_bf16_f32 v193, v106, v107
    v_cvt_pk_bf16_f32 v194, v108, v109
    v_cvt_pk_bf16_f32 v195, v110, v111
    v_cvt_pk_bf16_f32 v212, v59, v121
    v_cvt_pk_bf16_f32 v213, v122, v123
    v_cvt_pk_bf16_f32 v214, v124, v125
    v_cvt_pk_bf16_f32 v215, v126, v127
    v_cvt_pk_bf16_f32 v232, v60, v137
    v_cvt_pk_bf16_f32 v233, v138, v139
    v_cvt_pk_bf16_f32 v234, v140, v141
    v_cvt_pk_bf16_f32 v235, v142, v143
    v_cvt_pk_bf16_f32 v156, v80, v81
    v_cvt_pk_bf16_f32 v157, v82, v83
    v_cvt_pk_bf16_f32 v158, v84, v85
    v_cvt_pk_bf16_f32 v159, v86, v87
    v_cvt_pk_bf16_f32 v176, v96, v97
    v_cvt_pk_bf16_f32 v177, v98, v99
    v_cvt_pk_bf16_f32 v178, v100, v101
    v_cvt_pk_bf16_f32 v179, v102, v103
    v_cvt_pk_bf16_f32 v196, v112, v113
    v_cvt_pk_bf16_f32 v197, v114, v115
    v_cvt_pk_bf16_f32 v198, v116, v117
    v_cvt_pk_bf16_f32 v199, v118, v119
    v_cvt_pk_bf16_f32 v216, v128, v129
    v_cvt_pk_bf16_f32 v217, v130, v131
    v_cvt_pk_bf16_f32 v218, v132, v133
    v_cvt_pk_bf16_f32 v219, v134, v135
    v_cvt_pk_bf16_f32 v236, v144, v145
    v_cvt_pk_bf16_f32 v237, v146, v147
    v_cvt_pk_bf16_f32 v238, v148, v149
    v_cvt_pk_bf16_f32 v239, v150, v151
    v_fma_f32 v72, v29, v80, -v72
    v_fma_f32 v73, v29, v81, -v73
    v_fma_f32 v74, v29, v82, -v74
    v_fma_f32 v75, v29, v83, -v75
    v_fma_f32 v76, v29, v84, -v76
    v_fma_f32 v77, v29, v85, -v77
    v_fma_f32 v78, v29, v86, -v78
    v_fma_f32 v79, v29, v87, -v79
    v_cvt_pk_bf16_f32 v160, v72, v73
    v_cvt_pk_bf16_f32 v161, v74, v75
    v_cvt_pk_bf16_f32 v162, v76, v77
    v_cvt_pk_bf16_f32 v163, v78, v79
    v_fma_f32 v88, v30, v96, -v88
    v_fma_f32 v89, v30, v97, -v89
    v_fma_f32 v90, v30, v98, -v90
    v_fma_f32 v91, v30, v99, -v91
    v_fma_f32 v92, v30, v100, -v92
    v_fma_f32 v93, v30, v101, -v93
    v_fma_f32 v94, v30, v102, -v94
    v_fma_f32 v95, v30, v103, -v95
    v_cvt_pk_bf16_f32 v180, v88, v89
    v_cvt_pk_bf16_f32 v181, v90, v91
    v_cvt_pk_bf16_f32 v182, v92, v93
    v_cvt_pk_bf16_f32 v183, v94, v95
    v_fma_f32 v104, v31, v112, -v104
    v_fma_f32 v105, v31, v113, -v105
    v_fma_f32 v106, v31, v114, -v106
    v_fma_f32 v107, v31, v115, -v107
    v_fma_f32 v108, v31, v116, -v108
    v_fma_f32 v109, v31, v117, -v109
    v_fma_f32 v110, v31, v118, -v110
    v_fma_f32 v111, v31, v119, -v111
    v_cvt_pk_bf16_f32 v200, v104, v105
    v_cvt_pk_bf16_f32 v201, v106, v107
    v_cvt_pk_bf16_f32 v202, v108, v109
    v_cvt_pk_bf16_f32 v203, v110, v111
    v_fma_f32 v120, v32, v128, -v120
    v_fma_f32 v121, v32, v129, -v121
    v_fma_f32 v122, v32, v130, -v122
    v_fma_f32 v123, v32, v131, -v123
    v_fma_f32 v124, v32, v132, -v124
    v_fma_f32 v125, v32, v133, -v125
    v_fma_f32 v126, v32, v134, -v126
    v_fma_f32 v127, v32, v135, -v127
    v_cvt_pk_bf16_f32 v220, v120, v121
    v_cvt_pk_bf16_f32 v221, v122, v123
    v_cvt_pk_bf16_f32 v222, v124, v125
    v_cvt_pk_bf16_f32 v223, v126, v127
    v_fma_f32 v136, v33, v144, -v136
    v_fma_f32 v137, v33, v145, -v137
    v_fma_f32 v138, v33, v146, -v138
    v_fma_f32 v139, v33, v147, -v139
    v_fma_f32 v140, v33, v148, -v140
    v_fma_f32 v141, v33, v149, -v141
    v_fma_f32 v142, v33, v150, -v142
    v_fma_f32 v143, v33, v151, -v143
    v_cvt_pk_bf16_f32 v240, v136, v137
    v_cvt_pk_bf16_f32 v241, v138, v139
    v_cvt_pk_bf16_f32 v242, v140, v141
    v_cvt_pk_bf16_f32 v243, v142, v143
    s_cmp_lg_u32 s19, 0
    s_cbranch_scc1 k_uw_na
    buffer_load_dword v16, v14, s[12:15], s27 offen sc1
k_uw_na:
    v_fma_f32 v80, v29, v72, -v80
    v_fma_f32 v81, v29, v73, -v81
    v_fma_f32 v82, v29, v74, -v82
    v_fma_f32 v83, v29, v75, -v83
    v_fma_f32 v84, v29, v76, -v84
    v_fma_f32 v85, v29, v77, -v85
    v_fma_f32 v86, v29, v78, -v86
    v_fma_f32 v87, v29, v79, -v87
    v_cvt_pk_bf16_f32 v164, v80, v81
    v_cvt_pk_bf16_f32 v165, v82, v83
    v_cvt_pk_bf16_f32 v166, v84, v85
    v_cvt_pk_bf16_f32 v167, v86, v87
    v_fma_f32 v96, v30, v88, -v96
    v_fma_f32 v97, v30, v89, -v97
    v_fma_f32 v98, v30, v90, -v98
    v_fma_f32 v99, v30, v91, -v99
    v_fma_f32 v100, v30, v92, -v100
    v_fma_f32 v101, v30, v93, -v101
    v_fma_f32 v102, v30, v94, -v102
    v_fma_f32 v103, v30, v95, -v103
    v_cvt_pk_bf16_f32 v184, v96, v97
    v_cvt_pk_bf16_f32 v185, v98, v99
    v_cvt_pk_bf16_f32 v186, v100, v101
    v_cvt_pk_bf16_f32 v187, v102, v103
    v_fma_f32 v112, v31, v104, -v112
    v_fma_f32 v113, v31, v105, -v113
    v_fma_f32 v114, v31, v106, -v114
    v_fma_f32 v115, v31, v107, -v115
    v_fma_f32 v116, v31, v108, -v116
    v_fma_f32 v117, v31, v109, -v117
    v_fma_f32 v118, v31, v110, -v118
    v_fma_f32 v119, v31, v111, -v119
    v_cvt_pk_bf16_f32 v204, v112, v113
    v_cvt_pk_bf16_f32 v205, v114, v115
    v_cvt_pk_bf16_f32 v206, v116, v117
    v_cvt_pk_bf16_f32 v207, v118, v119
    v_fma_f32 v128, v32, v120, -v128
    v_fma_f32 v129, v32, v121, -v129
    v_fma_f32 v130, v32, v122, -v130
    v_fma_f32 v131, v32, v123, -v131
    v_fma_f32 v132, v32, v124, -v132
    v_fma_f32 v133, v32, v125, -v133
    v_fma_f32 v134, v32, v126, -v134
    v_fma_f32 v135, v32, v127, -v135
    v_cvt_pk_bf16_f32 v224, v128, v129
    v_cvt_pk_bf16_f32 v225, v130, v131
    v_cvt_pk_bf16_f32 v226, v132, v133
    v_cvt_pk_bf16_f32 v227, v134, v135
    v_fma_f32 v144, v33, v136, -v144
    v_fma_f32 v145, v33, v137, -v145
    v_fma_f32 v146, v33, v138, -v146
    v_fma_f32 v147, v33, v139, -v147
    v_fma_f32 v148, v33, v140, -v148
    v_fma_f32 v149, v33, v141, -v149
    v_fma_f32 v150, v33, v142, -v150
    v_fma_f32 v151, v33, v143, -v151
    v_cvt_pk_bf16_f32 v244, v144, v145
    v_cvt_pk_bf16_f32 v245, v146, v147
    v_cvt_pk_bf16_f32 v246, v148, v149
    v_cvt_pk_bf16_f32 v247, v150, v151
    v_fma_f32 v72, v29, v80, -v72
    v_fma_f32 v73, v29, v81, -v73
    v_fma_f32 v74, v29, v82, -v74
    v_fma_f32 v75, v29, v83, -v75
    v_fma_f32 v76, v29, v84, -v76
    v_fma_f32 v77, v29, v85, -v77
    v_fma_f32 v78, v29, v86, -v78
    v_fma_f32 v79, v29, v87, -v79
    v_cvt_pk_bf16_f32 v168, v72, v73
    v_cvt_pk_bf16_f32 v169, v74, v75
    v_cvt_pk_bf16_f32 v170, v76, v77
    v_cvt_pk_bf16_f32 v171, v78, v79
    v_fma_f32 v88, v30, v96, -v88
    v_fma_f32 v89, v30, v97, -v89
    v_fma_f32 v90, v30, v98, -v90
    v_fma_f32 v91, v30, v99, -v91
    v_fma_f32 v92, v30, v100, -v92
    v_fma_f32 v93, v30, v101, -v93
    v_fma_f32 v94, v30, v102, -v94
    v_fma_f32 v95, v30, v103, -v95
    v_cvt_pk_bf16_f32 v188, v88, v89
    v_cvt_pk_bf16_f32 v189, v90, v91
    v_cvt_pk_bf16_f32 v190, v92, v93
    v_cvt_pk_bf16_f32 v191, v94, v95
    v_fma_f32 v104, v31, v112, -v104
    v_fma_f32 v105, v31, v113, -v105
    v_fma_f32 v106, v31, v114, -v106
    v_fma_f32 v107, v31, v115, -v107
    v_fma_f32 v108, v31, v116, -v108
    v_fma_f32 v109, v31, v117, -v109
    v_fma_f32 v110, v31, v118, -v110
    v_fma_f32 v111, v31, v119, -v111
    v_cvt_pk_bf16_f32 v208, v104, v105
    v_cvt_pk_bf16_f32 v209, v106, v107
    v_cvt_pk_bf16_f32 v210, v108, v109
    v_cvt_pk_bf16_f32 v211, v110, v111
    v_fma_f32 v120, v32, v128, -v120
    v_fma_f32 v121, v32, v129, -v121
    v_fma_f32 v122, v32, v130, -v122
    v_fma_f32 v123, v32, v131, -v123
    v_fma_f32 v124, v32, v132, -v124
    v_fma_f32 v125, v32, v133, -v125
    v_fma_f32 v126, v32, v134, -v126
    v_fma_f32 v127, v32, v135, -v127
    v_cvt_pk_bf16_f32 v228, v120, v121
    v_cvt_pk_bf16_f32 v229, v122, v123
    v_cvt_pk_bf16_f32 v230, v124, v125
    v_cvt_pk_bf16_f32 v231, v126, v127
    v_fma_f32 v136, v33, v144, -v136
    v_fma_f32 v137, v33, v145, -v137
    v_fma_f32 v138, v33, v146, -v138
    v_fma_f32 v139, v33, v147, -v139
    v_fma_f32 v140, v33, v148, -v140
    v_fma_f32 v141, v33, v149, -v141
    v_fma_f32 v142, v33, v150, -v142
    v_fma_f32 v143, v33, v151, -v143
    v_cvt_pk_bf16_f32 v248, v136, v137
    v_cvt_pk_bf16_f32 v249, v138, v139
    v_cvt_pk_bf16_f32 v250, v140, v141
    v_cvt_pk_bf16_f32 v251, v142, v143
    v_mov_b32 v21, 163632
    s_cmp_lg_u32 s19, 0
    s_cbranch_scc1 k_uw_l
    s_branch k_uw_c
k_uw:
    buffer_load_dword v16, v14, s[12:15], s27 offen sc1
k_uw_c:
    s_waitcnt vmcnt(0)
    v_cmp_eq_u32 vcc, v16, v15
    s_cmp_eq_u64 vcc, -1
    s_cbranch_scc1 k_uw_s
    s_sleep 3
    s_sub_u32 s97, s97, 1
    s_cmp_gt_i32 s97, 0
    s_cbranch_scc1 k_uw
k_uw_s:
    ds_write_b32 v21, v15
    s_branch k_uw_ok
k_uw_l:
    ds_read_b32 v16, v21
    s_waitcnt lgkmcnt(0)
    v_readfirstlane_b32 s28, v16
    s_cmp_lg_u32 s28, 0
    s_cbranch_scc1 k_uw_ok
    s_sleep 1
    s_sub_u32 s97, s97, 1
    s_cmp_gt_i32 s97, 0
    s_cbranch_scc1 k_uw_l
k_uw_ok:
    s_waitcnt lgkmcnt(0)
    s_mul_i32 s25, s19, 15360
    s_add_u32 s25, s25, 69376
    s_add_u32 m0, s22, 0
    s_add_u32 s29, s26, 0
    buffer_load_dwordx4 v12, s[12:15], s29 offen lds
    s_add_u32 m0, s22, 1024
    s_add_u32 s29, s26, 0
    buffer_load_dwordx4 v13, s[12:15], s29 offen lds
    s_add_u32 m0, s22, 2048
    s_add_u32 s29, s26, 67584
    buffer_load_dwordx4 v12, s[12:15], s29 offen lds
    s_add_u32 m0, s22, 3072
    s_add_u32 s29, s26, 67584
    buffer_load_dwordx4 v13, s[12:15], s29 offen lds
    s_add_u32 m0, s22, 4096
    s_add_u32 s29, s26, 135168
    buffer_load_dwordx4 v12, s[12:15], s29 offen lds
    s_add_u32 m0, s22, 5120
    s_add_u32 s29, s26, 135168
    buffer_load_dwordx4 v13, s[12:15], s29 offen lds
    s_add_u32 m0, s22, 6144
    s_add_u32 s29, s26, 202752
    buffer_load_dwordx4 v12, s[12:15], s29 offen lds
    s_add_u32 m0, s22, 7168
    s_add_u32 s29, s26, 202752
    buffer_load_dwordx4 v13, s[12:15], s29 offen lds
    v_and_b32 v21, 3, v0
    v_lshlrev_b32 v21, 2, v21
    v_add_u32 v21, 163584, v21
k_big:
    ds_read_b32 v24, v21
    s_waitcnt lgkmcnt(0)
    v_cmp_gt_u32 vcc, 1, v24
    s_cbranch_vccz k_big_out
    s_sleep 1
    s_sub_u32 s97, s97, 1
    s_cmp_gt_i32 s97, 0
    s_cbranch_scc1 k_big
k_big_out:
    s_add_u32 m0, s25, 0
    s_add_u32 s29, s26, 270336
    buffer_load_dwordx4 v12, s[12:15], s29 offen lds
    s_add_u32 m0, s25, 1024
    s_add_u32 s29, s26, 270336
    buffer_load_dwordx4 v13, s[12:15], s29 offen lds
    s_add_u32 m0, s25, 2048
    s_add_u32 s29, s26, 337920
    buffer_load_dwordx4 v12, s[12:15], s29 offen lds
    s_add_u32 m0, s25, 3072
    s_add_u32 s29, s26, 337920
    buffer_load_dwordx4 v13, s[12:15], s29 offen lds
    s_add_u32 m0, s25, 4096
    s_add_u32 s29, s26, 405504
    buffer_load_dwordx4 v12, s[12:15], s29 offen lds
    s_add_u32 m0, s25, 5120
    s_add_u32 s29, s26, 405504
    buffer_load_dwordx4 v13, s[12:15], s29 offen lds
    s_add_u32 m0, s25, 6144
    s_add_u32 s29, s26, 473088
    buffer_load_dwordx4 v12, s[12:15], s29 offen lds
    s_add_u32 m0, s25, 7168
    s_add_u32 s29, s26, 473088
    buffer_load_dwordx4 v13, s[12:15], s29 offen lds
    s_add_u32 m0, s25, 8192
    s_add_u32 s29, s26, 540672
    buffer_load_dwordx4 v12, s[12:15], s29 offen lds
    s_add_u32 m0, s25, 9216
    s_add_u32 s29, s26, 540672
    buffer_load_dwordx4 v13, s[12:15], s29 offen lds
    s_add_u32 m0, s25, 10240
    s_add_u32 s29, s26, 608256
    buffer_load_dwordx4 v12, s[12:15], s29 offen lds
    s_add_u32 m0, s25, 11264
    s_add_u32 s29, s26, 608256
    buffer_load_dwordx4 v13, s[12:15], s29 offen lds
    s_sub_u32 s28, s25, s22
    v_xor_b32 v16, 32, v11
    v_xor_b32 v17, 64, v11
    v_xor_b32 v18, 96, v11
    s_waitcnt vmcnt(16)
    ds_read_b64_tr_b16 v[56:57], v11 offset:0
    ds_read_b64_tr_b16 v[58:59], v11 offset:512
    ds_read_b64_tr_b16 v[60:61], v16 offset:0
    ds_read_b64_tr_b16 v[62:63], v16 offset:512
    ds_read_b64_tr_b16 v[64:65], v17 offset:0
    ds_read_b64_tr_b16 v[66:67], v17 offset:512
    ds_read_b64_tr_b16 v[68:69], v18 offset:0
    ds_read_b64_tr_b16 v[70:71], v18 offset:512
    s_waitcnt lgkmcnt(6)
    v_mfma_f32_16x16x32_bf16 v[72:75], v[152:155], v[56:59], 0
    v_mfma_f32_16x16x32_bf16 v[76:79], v[172:175], v[56:59], 0
    v_mfma_f32_16x16x32_bf16 v[80:83], v[192:195], v[56:59], 0
    v_mfma_f32_16x16x32_bf16 v[84:87], v[212:215], v[56:59], 0
    s_waitcnt vmcnt(12)
    v_mfma_f32_16x16x32_bf16 v[88:91], v[232:235], v[56:59], 0
    ds_read_b64_tr_b16 v[56:57], v11 offset:4096
    ds_read_b64_tr_b16 v[58:59], v11 offset:4608
    s_waitcnt lgkmcnt(6)
    v_mfma_f32_16x16x32_bf16 v[92:95], v[152:155], v[60:63], 0
    v_mfma_f32_16x16x32_bf16 v[96:99], v[172:175], v[60:63], 0
    v_mfma_f32_16x16x32_bf16 v[100:103], v[192:195], v[60:63], 0
    v_mfma_f32_16x16x32_bf16 v[104:107], v[212:215], v[60:63], 0
    v_mfma_f32_16x16x32_bf16 v[108:111], v[232:235], v[60:63], 0
    ds_read_b64_tr_b16 v[60:61], v16 offset:4096
    ds_read_b64_tr_b16 v[62:63], v16 offset:4608
    s_waitcnt lgkmcnt(6)
    v_mfma_f32_16x16x32_bf16 v[112:115], v[152:155], v[64:67], 0
    v_mfma_f32_16x16x32_bf16 v[116:119], v[172:175], v[64:67], 0
    v_mfma_f32_16x16x32_bf16 v[120:123], v[192:195], v[64:67], 0
    v_mfma_f32_16x16x32_bf16 v[124:127], v[212:215], v[64:67], 0
    v_mfma_f32_16x16x32_bf16 v[128:131], v[232:235], v[64:67], 0
    ds_read_b64_tr_b16 v[64:65], v17 offset:4096
    ds_read_b64_tr_b16 v[66:67], v17 offset:4608
    s_waitcnt lgkmcnt(6)
    v_mfma_f32_16x16x32_bf16 v[132:135], v[152:155], v[68:71], 0
    v_mfma_f32_16x16x32_bf16 v[136:139], v[172:175], v[68:71], 0
    v_mfma_f32_16x16x32_bf16 v[140:143], v[192:195], v[68:71], 0
    v_mfma_f32_16x16x32_bf16 v[144:147], v[212:215], v[68:71], 0
    v_mfma_f32_16x16x32_bf16 v[148:151], v[232:235], v[68:71], 0
    ds_read_b64_tr_b16 v[68:69], v18 offset:4096
    ds_read_b64_tr_b16 v[70:71], v18 offset:4608
    s_waitcnt lgkmcnt(6)
    v_mfma_f32_16x16x32_bf16 v[72:75], v[156:159], v[56:59], v[72:75]
    v_mfma_f32_16x16x32_bf16 v[76:79], v[176:179], v[56:59], v[76:79]
    v_mfma_f32_16x16x32_bf16 v[80:83], v[196:199], v[56:59], v[80:83]
    v_mfma_f32_16x16x32_bf16 v[84:87], v[216:219], v[56:59], v[84:87]
    s_waitcnt vmcnt(8)
    v_add_u32 v11, s28, v11
    v_add_u32 v16, s28, v16
    v_add_u32 v17, s28, v17
    v_add_u32 v18, s28, v18
    v_mfma_f32_16x16x32_bf16 v[88:91], v[236:239], v[56:59], v[88:91]
    ds_read_b64_tr_b16 v[56:57], v11 offset:0
    ds_read_b64_tr_b16 v[58:59], v11 offset:512
    s_waitcnt lgkmcnt(6)
    v_mfma_f32_16x16x32_bf16 v[92:95], v[156:159], v[60:63], v[92:95]
    v_mfma_f32_16x16x32_bf16 v[96:99], v[176:179], v[60:63], v[96:99]
    v_mfma_f32_16x16x32_bf16 v[100:103], v[196:199], v[60:63], v[100:103]
    v_mfma_f32_16x16x32_bf16 v[104:107], v[216:219], v[60:63], v[104:107]
    v_mfma_f32_16x16x32_bf16 v[108:111], v[236:239], v[60:63], v[108:111]
    ds_read_b64_tr_b16 v[60:61], v16 offset:0
    ds_read_b64_tr_b16 v[62:63], v16 offset:512
    s_waitcnt lgkmcnt(6)
    v_mfma_f32_16x16x32_bf16 v[112:115], v[156:159], v[64:67], v[112:115]
    v_mfma_f32_16x16x32_bf16 v[116:119], v[176:179], v[64:67], v[116:119]
    v_mfma_f32_16x16x32_bf16 v[120:123], v[196:199], v[64:67], v[120:123]
    v_mfma_f32_16x16x32_bf16 v[124:127], v[216:219], v[64:67], v[124:127]
    v_mfma_f32_16x16x32_bf16 v[128:131], v[236:239], v[64:67], v[128:131]
    ds_read_b64_tr_b16 v[64:65], v17 offset:0
    ds_read_b64_tr_b16 v[66:67], v17 offset:512
    s_waitcnt lgkmcnt(6)
    v_mfma_f32_16x16x32_bf16 v[132:135], v[156:159], v[68:71], v[132:135]
    v_mfma_f32_16x16x32_bf16 v[136:139], v[176:179], v[68:71], v[136:139]
    v_mfma_f32_16x16x32_bf16 v[140:143], v[196:199], v[68:71], v[140:143]
    v_mfma_f32_16x16x32_bf16 v[144:147], v[216:219], v[68:71], v[144:147]
    v_mfma_f32_16x16x32_bf16 v[148:151], v[236:239], v[68:71], v[148:151]
    ds_read_b64_tr_b16 v[68:69], v18 offset:0
    ds_read_b64_tr_b16 v[70:71], v18 offset:512
    s_waitcnt lgkmcnt(6)
    v_mfma_f32_16x16x32_bf16 v[72:75], v[160:163], v[56:59], v[72:75]
    v_mfma_f32_16x16x32_bf16 v[76:79], v[180:183], v[56:59], v[76:79]
    v_mfma_f32_16x16x32_bf16 v[80:83], v[200:203], v[56:59], v[80:83]
    v_mfma_f32_16x16x32_bf16 v[84:87], v[220:223], v[56:59], v[84:87]
    s_waitcnt vmcnt(4)
    v_mfma_f32_16x16x32_bf16 v[88:91], v[240:243], v[56:59], v[88:91]
    ds_read_b64_tr_b16 v[56:57], v11 offset:4096
    ds_read_b64_tr_b16 v[58:59], v11 offset:4608
    s_waitcnt lgkmcnt(6)
    v_mfma_f32_16x16x32_bf16 v[92:95], v[160:163], v[60:63], v[92:95]
    v_mfma_f32_16x16x32_bf16 v[96:99], v[180:183], v[60:63], v[96:99]
    v_mfma_f32_16x16x32_bf16 v[100:103], v[200:203], v[60:63], v[100:103]
    v_mfma_f32_16x16x32_bf16 v[104:107], v[220:223], v[60:63], v[104:107]
    v_mfma_f32_16x16x32_bf16 v[108:111], v[240:243], v[60:63], v[108:111]
    ds_read_b64_tr_b16 v[60:61], v16 offset:4096
    ds_read_b64_tr_b16 v[62:63], v16 offset:4608
    s_waitcnt lgkmcnt(6)
    v_mfma_f32_16x16x32_bf16 v[112:115], v[160:163], v[64:67], v[112:115]
    v_mfma_f32_16x16x32_bf16 v[116:119], v[180:183], v[64:67], v[116:119]
    v_mfma_f32_16x16x32_bf16 v[120:123], v[200:203], v[64:67], v[120:123]
    v_mfma_f32_16x16x32_bf16 v[124:127], v[220:223], v[64:67], v[124:127]
    v_mfma_f32_16x16x32_bf16 v[128:131], v[240:243], v[64:67], v[128:131]
    ds_read_b64_tr_b16 v[64:65], v17 offset:4096
    ds_read_b64_tr_b16 v[66:67], v17 offset:4608
    s_waitcnt lgkmcnt(6)
    v_mfma_f32_16x16x32_bf16 v[132:135], v[160:163], v[68:71], v[132:135]
    v_mfma_f32_16x16x32_bf16 v[136:139], v[180:183], v[68:71], v[136:139]
    v_mfma_f32_16x16x32_bf16 v[140:143], v[200:203], v[68:71], v[140:143]
    v_mfma_f32_16x16x32_bf16 v[144:147], v[220:223], v[68:71], v[144:147]
    v_mfma_f32_16x16x32_bf16 v[148:151], v[240:243], v[68:71], v[148:151]
    ds_read_b64_tr_b16 v[68:69], v18 offset:4096
    ds_read_b64_tr_b16 v[70:71], v18 offset:4608
    s_waitcnt lgkmcnt(6)
    v_mfma_f32_16x16x32_bf16 v[72:75], v[164:167], v[56:59], v[72:75]
    v_mfma_f32_16x16x32_bf16 v[76:79], v[184:187], v[56:59], v[76:79]
    v_mfma_f32_16x16x32_bf16 v[80:83], v[204:207], v[56:59], v[80:83]
    v_mfma_f32_16x16x32_bf16 v[84:87], v[224:227], v[56:59], v[84:87]
    s_waitcnt vmcnt(0)
    v_mfma_f32_16x16x32_bf16 v[88:91], v[244:247], v[56:59], v[88:91]
    ds_read_b64_tr_b16 v[56:57], v11 offset:8192
    ds_read_b64_tr_b16 v[58:59], v11 offset:8704
    s_waitcnt lgkmcnt(6)
    v_mfma_f32_16x16x32_bf16 v[92:95], v[164:167], v[60:63], v[92:95]
    v_mfma_f32_16x16x32_bf16 v[96:99], v[184:187], v[60:63], v[96:99]
    v_mfma_f32_16x16x32_bf16 v[100:103], v[204:207], v[60:63], v[100:103]
    v_mfma_f32_16x16x32_bf16 v[104:107], v[224:227], v[60:63], v[104:107]
    v_mfma_f32_16x16x32_bf16 v[108:111], v[244:247], v[60:63], v[108:111]
    ds_read_b64_tr_b16 v[60:61], v16 offset:8192
    ds_read_b64_tr_b16 v[62:63], v16 offset:8704
    s_waitcnt lgkmcnt(6)
    v_mfma_f32_16x16x32_bf16 v[112:115], v[164:167], v[64:67], v[112:115]
    v_mfma_f32_16x16x32_bf16 v[116:119], v[184:187], v[64:67], v[116:119]
    v_mfma_f32_16x16x32_bf16 v[120:123], v[204:207], v[64:67], v[120:123]
    v_mfma_f32_16x16x32_bf16 v[124:127], v[224:227], v[64:67], v[124:127]
    v_mfma_f32_16x16x32_bf16 v[128:131], v[244:247], v[64:67], v[128:131]
    ds_read_b64_tr_b16 v[64:65], v17 offset:8192
    ds_read_b64_tr_b16 v[66:67], v17 offset:8704
    s_waitcnt lgkmcnt(6)
    v_mfma_f32_16x16x32_bf16 v[132:135], v[164:167], v[68:71], v[132:135]
    v_mfma_f32_16x16x32_bf16 v[136:139], v[184:187], v[68:71], v[136:139]
    v_mfma_f32_16x16x32_bf16 v[140:143], v[204:207], v[68:71], v[140:143]
    v_mfma_f32_16x16x32_bf16 v[144:147], v[224:227], v[68:71], v[144:147]
    v_mfma_f32_16x16x32_bf16 v[148:151], v[244:247], v[68:71], v[148:151]
    ds_read_b64_tr_b16 v[68:69], v18 offset:8192
    ds_read_b64_tr_b16 v[70:71], v18 offset:8704
    s_waitcnt lgkmcnt(6)
    v_mfma_f32_16x16x32_bf16 v[72:75], v[168:171], v[56:59], v[72:75]
    v_mfma_f32_16x16x32_bf16 v[76:79], v[188:191], v[56:59], v[76:79]
    v_mfma_f32_16x16x32_bf16 v[80:83], v[208:211], v[56:59], v[80:83]
    v_mfma_f32_16x16x32_bf16 v[84:87], v[228:231], v[56:59], v[84:87]
    v_mfma_f32_16x16x32_bf16 v[88:91], v[248:251], v[56:59], v[88:91]
    s_waitcnt lgkmcnt(4)
    v_mfma_f32_16x16x32_bf16 v[92:95], v[168:171], v[60:63], v[92:95]
    v_mfma_f32_16x16x32_bf16 v[96:99], v[188:191], v[60:63], v[96:99]
    v_mfma_f32_16x16x32_bf16 v[100:103], v[208:211], v[60:63], v[100:103]
    v_mfma_f32_16x16x32_bf16 v[104:107], v[228:231], v[60:63], v[104:107]
    v_mfma_f32_16x16x32_bf16 v[108:111], v[248:251], v[60:63], v[108:111]
    s_waitcnt lgkmcnt(2)
    v_mfma_f32_16x16x32_bf16 v[112:115], v[168:171], v[64:67], v[112:115]
    v_mfma_f32_16x16x32_bf16 v[116:119], v[188:191], v[64:67], v[116:119]
    v_mfma_f32_16x16x32_bf16 v[120:123], v[208:211], v[64:67], v[120:123]
    v_mfma_f32_16x16x32_bf16 v[124:127], v[228:231], v[64:67], v[124:127]
    v_mfma_f32_16x16x32_bf16 v[128:131], v[248:251], v[64:67], v[128:131]
    s_waitcnt lgkmcnt(0)
    v_mfma_f32_16x16x32_bf16 v[132:135], v[168:171], v[68:71], v[132:135]
    v_mfma_f32_16x16x32_bf16 v[136:139], v[188:191], v[68:71], v[136:139]
    v_mfma_f32_16x16x32_bf16 v[140:143], v[208:211], v[68:71], v[140:143]
    v_mfma_f32_16x16x32_bf16 v[144:147], v[228:231], v[68:71], v[144:147]
    v_mfma_f32_16x16x32_bf16 v[148:151], v[248:251], v[68:71], v[148:151]
    v_and_b32 v16, 15, v0
    v_mul_u32_u24 v16, 320, v16
    v_lshrrev_b32 v18, 4, v0
    v_bfe_u32 v19, v0, 1, 2
    v_xor_b32 v18, v18, v19
    v_lshl_add_u32 v16, v18, 4, v16
    v_add_u32 v17, s22, v16
    v_add_u32 v16, s25, v16
    s_cmp_lg_u32 s19, 0
    s_cbranch_scc1 k_w1
    ds_write_b128 v16, v[92:95] offset:0
    ds_write_b128 v16, v[96:99] offset:64
    ds_write_b128 v16, v[100:103] offset:128
    ds_write_b128 v16, v[104:107] offset:192
    ds_write_b128 v16, v[108:111] offset:256
    ds_write_b128 v16, v[112:115] offset:5120
    ds_write_b128 v16, v[116:119] offset:5184
    ds_write_b128 v16, v[120:123] offset:5248
    ds_write_b128 v16, v[124:127] offset:5312
    ds_write_b128 v16, v[128:131] offset:5376
    ds_write_b128 v16, v[132:135] offset:10240
    ds_write_b128 v16, v[136:139] offset:10304
    ds_write_b128 v16, v[140:143] offset:10368
    ds_write_b128 v16, v[144:147] offset:10432
    ds_write_b128 v16, v[148:151] offset:10496
    v_mov_b32 v12, 5
    s_waitcnt lgkmcnt(0)
    ds_write_b32 v6, v12
    ds_write_b128 v17, v[72:75] offset:0
    ds_write_b128 v17, v[76:79] offset:64
    ds_write_b128 v17, v[80:83] offset:128
    ds_write_b128 v17, v[84:87] offset:192
    ds_write_b128 v17, v[88:91] offset:256
    s_branch k_wd
k_w1:
    s_cmp_lg_u32 s19, 1
    s_cbranch_scc1 k_w2
    ds_write_b128 v16, v[72:75] offset:10240
    ds_write_b128 v16, v[76:79] offset:10304
    ds_write_b128 v16, v[80:83] offset:10368
    ds_write_b128 v16, v[84:87] offset:10432
    ds_write_b128 v16, v[88:91] offset:10496
    ds_write_b128 v16, v[112:115] offset:0
    ds_write_b128 v16, v[116:119] offset:64
    ds_write_b128 v16, v[120:123] offset:128
    ds_write_b128 v16, v[124:127] offset:192
    ds_write_b128 v16, v[128:131] offset:256
    ds_write_b128 v16, v[132:135] offset:5120
    ds_write_b128 v16, v[136:139] offset:5184
    ds_write_b128 v16, v[140:143] offset:5248
    ds_write_b128 v16, v[144:147] offset:5312
    ds_write_b128 v16, v[148:151] offset:5376
    v_mov_b32 v12, 5
    s_waitcnt lgkmcnt(0)
    ds_write_b32 v6, v12
    ds_write_b128 v17, v[92:95] offset:0
    ds_write_b128 v17, v[96:99] offset:64
    ds_write_b128 v17, v[100:103] offset:128
    ds_write_b128 v17, v[104:107] offset:192
    ds_write_b128 v17, v[108:111] offset:256
    s_branch k_wd
k_w2:
    s_cmp_lg_u32 s19, 2
    s_cbranch_scc1 k_w3
    ds_write_b128 v16, v[72:75] offset:5120
    ds_write_b128 v16, v[76:79] offset:5184
    ds_write_b128 v16, v[80:83] offset:5248
    ds_write_b128 v16, v[84:87] offset:5312
    ds_write_b128 v16, v[88:91] offset:5376
    ds_write_b128 v16, v[92:95] offset:10240
    ds_write_b128 v16, v[96:99] offset:10304
    ds_write_b128 v16, v[100:103] offset:10368
    ds_write_b128 v16, v[104:107] offset:10432
    ds_write_b128 v16, v[108:111] offset:10496
    ds_write_b128 v16, v[132:135] offset:0
    ds_write_b128 v16, v[136:139] offset:64
    ds_write_b128 v16, v[140:143] offset:128
    ds_write_b128 v16, v[144:147] offset:192
    ds_write_b128 v16, v[148:151] offset:256
    v_mov_b32 v12, 5
    s_waitcnt lgkmcnt(0)
    ds_write_b32 v6, v12
    ds_write_b128 v17, v[112:115] offset:0
    ds_write_b128 v17, v[116:119] offset:64
    ds_write_b128 v17, v[120:123] offset:128
    ds_write_b128 v17, v[124:127] offset:192
    ds_write_b128 v17, v[128:131] offset:256
    s_branch k_wd
k_w3:
    ds_write_b128 v16, v[72:75] offset:0
    ds_write_b128 v16, v[76:79] offset:64
    ds_write_b128 v16, v[80:83] offset:128
    ds_write_b128 v16, v[84:87] offset:192
    ds_write_b128 v16, v[88:91] offset:256
    ds_write_b128 v16, v[92:95] offset:5120
    ds_write_b128 v16, v[96:99] offset:5184
    ds_write_b128 v16, v[100:103] offset:5248
    ds_write_b128 v16, v[104:107] offset:5312
    ds_write_b128 v16, v[108:111] offset:5376
    ds_write_b128 v16, v[112:115] offset:10240
    ds_write_b128 v16, v[116:119] offset:10304
    ds_write_b128 v16, v[120:123] offset:10368
    ds_write_b128 v16, v[124:127] offset:10432
    ds_write_b128 v16, v[128:131] offset:10496
    v_mov_b32 v12, 5
    s_waitcnt lgkmcnt(0)
    ds_write_b32 v6, v12
    ds_write_b128 v17, v[132:135] offset:0
    ds_write_b128 v17, v[136:139] offset:64
    ds_write_b128 v17, v[140:143] offset:128
    ds_write_b128 v17, v[144:147] offset:192
    ds_write_b128 v17, v[148:151] offset:256
k_wd:
    s_sub_u32 s28, s19, 1
    s_and_b32 s28, s28, 3
    s_mul_i32 s28, s28, 15360
    s_add_u32 s30, s28, 69376
    s_sub_u32 s28, s19, 2
    s_and_b32 s28, s28, 3
    s_mul_i32 s28, s28, 15360
    s_add_u32 s31, s28, 74496
    s_sub_u32 s28, s19, 3
    s_and_b32 s28, s28, 3
    s_mul_i32 s28, s28, 15360
    s_add_u32 s34, s28, 79616
    s_mul_i32 s35, s19, 5120
    s_add_u32 s35, s35, 0
    v_add_u32 v23, 16, v6
    v_and_b32 v21, 3, v0
    v_lshlrev_b32 v21, 2, v21
    v_add_u32 v21, 163600, v21
    v_add_u32 v56, s22, v52
    v_xor_b32 v57, 16, v56
    v_add_u32 v58, s22, v53
    v_xor_b32 v59, 16, v58
    v_add_u32 v60, s22, v54
    v_xor_b32 v61, 16, v60
    ds_read_b128 v[152:155], v56
    ds_read_b128 v[156:159], v57
    ds_read_b128 v[160:163], v58
    ds_read_b128 v[164:167], v59
    ds_read_b128 v[168:171], v60
    ds_read_b128 v[172:175], v61
    v_lshlrev_b32 v72, 16, v40
    v_and_b32 v73, 0xffff0000, v40
    v_lshlrev_b32 v74, 16, v41
    v_and_b32 v75, 0xffff0000, v41
    v_lshlrev_b32 v76, 16, v42
    v_and_b32 v77, 0xffff0000, v42
    v_lshlrev_b32 v78, 16, v43
    v_and_b32 v79, 0xffff0000, v43
    v_lshlrev_b32 v80, 16, v44
    v_and_b32 v81, 0xffff0000, v44
    v_lshlrev_b32 v82, 16, v45
    v_and_b32 v83, 0xffff0000, v45
    v_lshlrev_b32 v84, 16, v46
    v_and_b32 v85, 0xffff0000, v46
    v_lshlrev_b32 v86, 16, v47
    v_and_b32 v87, 0xffff0000, v47
    v_lshlrev_b32 v88, 16, v48
    v_and_b32 v89, 0xffff0000, v48
    v_lshlrev_b32 v90, 16, v49
    v_and_b32 v91, 0xffff0000, v49
    v_lshlrev_b32 v92, 16, v50
    v_and_b32 v93, 0xffff0000, v50
    v_lshlrev_b32 v94, 16, v51
    v_and_b32 v95, 0xffff0000, v51
k_r1:
    ds_read_b32 v12, v21
    s_waitcnt lgkmcnt(0)
    v_cmp_gt_u32 vcc, 5, v12
    s_cbranch_vccz k_r1_out
    s_sub_u32 s97, s97, 1
    s_cmp_gt_i32 s97, 0
    s_cbranch_scc1 k_r1
k_r1_out:
    v_add_u32 v56, s30, v52
    v_xor_b32 v57, 16, v56
    v_add_u32 v58, s30, v53
    v_xor_b32 v59, 16, v58
    v_add_u32 v60, s30, v54
    v_xor_b32 v61, 16, v60
    ds_read_b128 v[176:179], v56
    ds_read_b128 v[180:183], v57
    ds_read_b128 v[184:187], v58
    ds_read_b128 v[188:191], v59
    ds_read_b128 v[192:195], v60
    ds_read_b128 v[196:199], v61
    v_add_u32 v56, s31, v52
    v_xor_b32 v57, 16, v56
    v_add_u32 v58, s31, v53
    v_xor_b32 v59, 16, v58
    v_add_u32 v60, s31, v54
    v_xor_b32 v61, 16, v60
    ds_read_b128 v[200:203], v56
    ds_read_b128 v[204:207], v57
    ds_read_b128 v[208:211], v58
    ds_read_b128 v[212:215], v59
    ds_read_b128 v[216:219], v60
    ds_read_b128 v[220:223], v61
    s_waitcnt lgkmcnt(6)
    v_add_u32 v56, s34, v52
    v_xor_b32 v57, 16, v56
    v_add_u32 v58, s34, v53
    v_xor_b32 v59, 16, v58
    v_add_u32 v60, s34, v54
    v_xor_b32 v61, 16, v60
    ds_read_b128 v[224:227], v56
    ds_read_b128 v[228:231], v57
    ds_read_b128 v[232:235], v58
    ds_read_b128 v[236:239], v59
    ds_read_b128 v[240:243], v60
    ds_read_b128 v[244:247], v61
    v_add_f32 v152, v152, v176
    v_add_f32 v153, v153, v177
    v_add_f32 v154, v154, v178
    v_add_f32 v155, v155, v179
    v_add_f32 v156, v156, v180
    v_add_f32 v157, v157, v181
    v_add_f32 v158, v158, v182
    v_add_f32 v159, v159, v183
    v_add_f32 v160, v160, v184
    v_add_f32 v161, v161, v185
    v_add_f32 v162, v162, v186
    v_add_f32 v163, v163, v187
    v_add_f32 v164, v164, v188
    v_add_f32 v165, v165, v189
    v_add_f32 v166, v166, v190
    v_add_f32 v167, v167, v191
    v_add_f32 v168, v168, v192
    v_add_f32 v169, v169, v193
    v_add_f32 v170, v170, v194
    v_add_f32 v171, v171, v195
    v_add_f32 v172, v172, v196
    v_add_f32 v173, v173, v197
    v_add_f32 v174, v174, v198
    v_add_f32 v175, v175, v199
    s_waitcnt lgkmcnt(6)
    v_add_f32 v152, v152, v200
    v_add_f32 v153, v153, v201
    v_add_f32 v154, v154, v202
    v_add_f32 v155, v155, v203
    v_add_f32 v156, v156, v204
    v_add_f32 v157, v157, v205
    v_add_f32 v158, v158, v206
    v_add_f32 v159, v159, v207
    v_add_f32 v160, v160, v208
    v_add_f32 v161, v161, v209
    v_add_f32 v162, v162, v210
    v_add_f32 v163, v163, v211
    v_add_f32 v164, v164, v212
    v_add_f32 v165, v165, v213
    v_add_f32 v166, v166, v214
    v_add_f32 v167, v167, v215
    v_add_f32 v168, v168, v216
    v_add_f32 v169, v169, v217
    v_add_f32 v170, v170, v218
    v_add_f32 v171, v171, v219
    v_add_f32 v172, v172, v220
    v_add_f32 v173, v173, v221
    v_add_f32 v174, v174, v222
    v_add_f32 v175, v175, v223
k_gw:
    ds_read_b32 v12, v23
    s_waitcnt lgkmcnt(0)
    v_cmp_eq_u32 vcc, 0, v12
    s_cbranch_vccz k_gwo
    s_sub_u32 s97, s97, 1
    s_cmp_gt_i32 s97, 0
    s_cbranch_scc1 k_gw
k_gwo:
    v_add_u32 v56, s35, v52
    v_xor_b32 v57, 16, v56
    v_add_u32 v58, s35, v53
    v_xor_b32 v59, 16, v58
    v_add_u32 v60, s35, v54
    v_xor_b32 v61, 16, v60
    ds_read_b128 v[96:99], v56
    ds_read_b128 v[100:103], v57
    ds_read_b128 v[104:107], v58
    ds_read_b128 v[108:111], v59
    ds_read_b128 v[112:115], v60
    ds_read_b128 v[116:119], v61
    v_add_f32 v152, v152, v224
    v_add_f32 v153, v153, v225
    v_add_f32 v154, v154, v226
    v_add_f32 v155, v155, v227
    v_add_f32 v156, v156, v228
    v_add_f32 v157, v157, v229
    v_add_f32 v158, v158, v230
    v_add_f32 v159, v159, v231
    v_add_f32 v160, v160, v232
    v_add_f32 v161, v161, v233
    v_add_f32 v162, v162, v234
    v_add_f32 v163, v163, v235
    v_add_f32 v164, v164, v236
    v_add_f32 v165, v165, v237
    v_add_f32 v166, v166, v238
    v_add_f32 v167, v167, v239
    v_add_f32 v168, v168, v240
    v_add_f32 v169, v169, v241
    v_add_f32 v170, v170, v242
    v_add_f32 v171, v171, v243
    v_add_f32 v172, v172, v244
    v_add_f32 v173, v173, v245
    v_add_f32 v174, v174, v246
    v_add_f32 v175, v175, v247
    s_waitcnt lgkmcnt(4)
    v_fmac_f32 v72, v152, v96
    v_fmac_f32 v73, v153, v97
    v_fmac_f32 v74, v154, v98
    v_fmac_f32 v75, v155, v99
    v_fmac_f32 v76, v156, v100
    v_fmac_f32 v77, v157, v101
    v_fmac_f32 v78, v158, v102
    v_fmac_f32 v79, v159, v103
    v_cvt_pk_bf16_f32 v40, v72, v73
    v_cvt_pk_bf16_f32 v41, v74, v75
    v_cvt_pk_bf16_f32 v42, v76, v77
    v_cvt_pk_bf16_f32 v43, v78, v79
    buffer_store_dwordx4 v[40:43], v8, s[8:11], s24 offen
    s_waitcnt lgkmcnt(2)
    v_fmac_f32 v80, v160, v104
    v_fmac_f32 v81, v161, v105
    v_fmac_f32 v82, v162, v106
    v_fmac_f32 v83, v163, v107
    v_fmac_f32 v84, v164, v108
    v_fmac_f32 v85, v165, v109
    v_fmac_f32 v86, v166, v110
    v_fmac_f32 v87, v167, v111
    v_cvt_pk_bf16_f32 v44, v80, v81
    v_cvt_pk_bf16_f32 v45, v82, v83
    v_cvt_pk_bf16_f32 v46, v84, v85
    v_cvt_pk_bf16_f32 v47, v86, v87
    buffer_store_dwordx4 v[44:47], v9, s[8:11], s24 offen
    s_waitcnt lgkmcnt(0)
    v_fmac_f32 v88, v168, v112
    v_fmac_f32 v89, v169, v113
    v_fmac_f32 v90, v170, v114
    v_fmac_f32 v91, v171, v115
    v_fmac_f32 v92, v172, v116
    v_fmac_f32 v93, v173, v117
    v_fmac_f32 v94, v174, v118
    v_fmac_f32 v95, v175, v119
    v_cvt_pk_bf16_f32 v48, v88, v89
    v_cvt_pk_bf16_f32 v49, v90, v91
    v_cvt_pk_bf16_f32 v50, v92, v93
    v_cvt_pk_bf16_f32 v51, v94, v95
    buffer_store_dwordx4 v[48:51], v10, s[8:11], s24 offen
    s_endpgm
k_h2:
    v_mov_b32 v88, 24
k_h2s:
    ds_read_b32 v91, v6
    s_waitcnt lgkmcnt(0)
    v_cmp_gt_u32 vcc, 1, v91
    s_cbranch_vccz k_h2s_out
    s_sleep 1
    s_sub_u32 s97, s97, 1
    s_cmp_gt_i32 s97, 0
    s_cbranch_scc1 k_h2s
k_h2s_out:
k_h2p:
    buffer_load_dword v90, v89, s[12:15], s27 offen sc1
    s_waitcnt vmcnt(0)
    v_cmp_eq_u32 vcc, v90, v88
    s_cmp_eq_u64 vcc, -1
    s_cbranch_scc1 k_h2p_ok
    s_sleep 1
    s_sub_u32 s97, s97, 1
    s_cmp_gt_i32 s97, 0
    s_cbranch_scc1 k_h2p
k_h2p_ok:
    s_branch k_h2b
k_pp:
    v_mov_b32 v88, 1
k_pp2:
    buffer_load_dword v90, v89, s[12:15], s35 offen sc1
    s_waitcnt vmcnt(0)
    v_cmp_eq_u32 vcc, v90, v88
    s_cmp_eq_u64 vcc, -1
    s_cbranch_scc1 k_pp2_ok
    s_sleep 1
    s_sub_u32 s97, s97, 1
    s_cmp_gt_i32 s97, 0
    s_cbranch_scc1 k_pp2
k_pp2_ok:
    buffer_load_dwordx4 v[96:99], v2, s[12:15], s29 offen offset:0
    buffer_load_dwordx4 v[100:103], v2, s[12:15], s29 offen offset:1024
    buffer_load_dwordx2 v[104:105], v94, s[12:15], s29 offen offset:2048
    s_branch k_pp_back
k_clr1:
    v_mov_b32 v41, 0
k_clr1s:
    global_load_dword v42, v41, s[56:57] offset:128 sc1
    s_waitcnt vmcnt(0)
    v_readfirstlane_b32 s28, v42
    s_cmp_lg_u32 s28, 0
    s_cbranch_scc1 k_clr1s_ok
    s_sleep 4
    s_sub_u32 s97, s97, 1
    s_cmp_gt_i32 s97, 0
    s_cbranch_scc1 k_clr1s
k_clr1s_ok:
    s_branch k_clr1_back
k_csq:
k_csqs:
    buffer_load_dword v42, v41, s[12:15], s27 offen sc1
    s_waitcnt vmcnt(0)
    v_cmp_eq_u32 vcc, v42, v43
    s_cmp_eq_u64 vcc, -1
    s_cbranch_scc1 k_csqs_ok
    s_sleep 2
    s_sub_u32 s97, s97, 1
    s_cmp_gt_i32 s97, 0
    s_cbranch_scc1 k_csqs
k_csqs_ok:
    s_branch k_csq_back
k_aux:
    s_cmp_lg_u32 s19, 0
    s_cbranch_scc1 k_aux_back
k_auxs:
    buffer_load_dword v42, v41, s[12:15], s29 offen sc1
    s_waitcnt vmcnt(0)
    v_cmp_eq_u32 vcc, v42, v43
    s_cmp_eq_u64 vcc, -1
    s_cbranch_scc1 k_auxs_ok
    s_sleep 4
    s_sub_u32 s97, s97, 1
    s_cmp_gt_i32 s97, 0
    s_cbranch_scc1 k_auxs
k_auxs_ok:
    s_branch k_aux_back
k_clr2:
    v_mov_b32 v45, 0
k_clr2s:
    global_load_dword v44, v45, s[56:57] offset:128 sc1
    s_waitcnt vmcnt(0)
    v_readfirstlane_b32 s28, v44
    s_cmp_lg_u32 s28, 0
    s_cbranch_scc1 k_clr2s_ok
    s_sleep 4
    s_sub_u32 s97, s97, 1
    s_cmp_gt_i32 s97, 0
    s_cbranch_scc1 k_clr2s
k_clr2s_ok:
    s_branch k_clr2_back
k_done:
    s_endpgm
.p2align 8
.type sf_tab,@object
sf_tab:
.quad 0x3f803f803f803f80,0x3f803f803f803f80,0x3f553f6d3f7b3f80,0xbf0ebec4be480000,0x3ec43f353f6d3f80,0xbec4bf35bf6dbf80,0xbe483ec43f553f80,0x3f7b3f6d3f0e0000
.quad 0xbf3500003f353f80,0xbf3500003f353f80,0xbf7bbec43f0e3f80,0xbe48bf6dbf550000,0xbf6dbf353ec43f80,0x3f6d3f35bec4bf80,0xbf0ebf6d3e483f80,0xbf553ec43f7b0000
.quad 0xbf8000003f80,0xbf8000003f80,0x3f0ebf6dbe483f80,0x3f553ec4bf7b0000,0x3f6dbf35bec43f80,0xbf6d3f353ec4bf80,0x3f7bbec4bf0e3f80,0x3e48bf6d3f550000
.quad 0x3f350000bf353f80,0x3f350000bf353f80,0x3e483ec4bf553f80,0xbf7b3f6dbf0e0000,0xbec43f35bf6d3f80,0x3ec4bf353f6dbf80,0xbf553f6dbf7b3f80,0x3f0ebec43e480000
.quad 0xbf803f80bf803f80,0xbf803f80bf803f80,0xbf553f6dbf7b3f80,0x3f0ebec43e480000,0xbec43f35bf6d3f80,0x3ec4bf353f6dbf80,0x3e483ec4bf553f80,0xbf7b3f6dbf0e0000
.quad 0x3f350000bf353f80,0x3f350000bf353f80,0x3f7bbec4bf0e3f80,0x3e48bf6d3f550000,0x3f6dbf35bec43f80,0xbf6d3f353ec4bf80,0x3f0ebf6dbe483f80,0x3f553ec4bf7b0000
.quad 0xbf8000003f80,0xbf8000003f80,0xbf0ebf6d3e483f80,0xbf553ec43f7b0000,0xbf6dbf353ec43f80,0x3f6d3f35bec4bf80,0xbf7bbec43f0e3f80,0xbe48bf6dbf550000
.quad 0xbf3500003f353f80,0xbf3500003f353f80,0xbe483ec43f553f80,0x3f7b3f6d3f0e0000,0x3ec43f353f6d3f80,0xbec4bf35bf6dbf80,0x3f553f6d3f7b3f80,0xbf0ebec4be480000
.quad 0x3f803f803f803f80,0x3f803f803f803f80,0x3e483ec43f0e3f35,0xbf7bbf6dbf55bf35,0xbf6dbf35bec40000,0x3f6d3f353ec40000,0xbf0ebf6dbf7bbf35,0xbf55bec43e483f35
.quad 0x3f350000bf35bf80,0x3f350000bf35bf80,0x3f553f6d3e48bf35,0xbf0e3ec43f7b3f35,0xbec43f353f6d0000,0x3ec4bf35bf6d0000,0xbf7bbec43f553f35,0xbe483f6d3f0ebf35
.quad 0xbf8000003f80,0xbf8000003f80,0x3f7bbec4bf553f35,0x3e483f6dbf0ebf35,0x3ec43f35bf6d0000,0xbec4bf353f6d0000,0xbf553f6dbe48bf35,0x3f0e3ec4bf7b3f35
.quad 0xbf3500003f35bf80,0xbf3500003f35bf80,0x3f0ebf6d3f7bbf35,0x3f55bec4be483f35,0x3f6dbf353ec40000,0xbf6d3f35bec40000,0xbe483ec4bf0e3f35,0x3f7bbf6d3f55bf35
.quad 0xbf803f80bf803f80,0xbf803f80bf803f80,0xbe483ec4bf0e3f35,0x3f7bbf6d3f55bf35,0x3f6dbf353ec40000,0xbf6d3f35bec40000,0x3f0ebf6d3f7bbf35,0x3f55bec4be483f35
.quad 0xbf3500003f35bf80,0xbf3500003f35bf80,0xbf553f6dbe48bf35,0x3f0e3ec4bf7b3f35,0x3ec43f35bf6d0000,0xbec4bf353f6d0000,0x3f7bbec4bf553f35,0x3e483f6dbf0ebf35
.quad 0xbf8000003f80,0xbf8000003f80,0xbf7bbec43f553f35,0xbe483f6d3f0ebf35,0xbec43f353f6d0000,0x3ec4bf35bf6d0000,0x3f553f6d3e48bf35,0xbf0e3ec43f7b3f35
.quad 0x3f350000bf35bf80,0x3f350000bf35bf80,0xbf0ebf6dbf7bbf35,0xbf55bec43e483f35,0xbf6dbf35bec40000,0x3f6d3f353ec40000,0x3e483ec43f0e3f35,0xbf7bbf6dbf55bf35
.quad 0,0,0x3f0e3ec43e480000,0x3f553f6d3f7b3f80,0x3f6d3f353ec40000,0xbf6dbf35bec40000,0x3f7b3f6d3f0e0000,0x3e48bec4bf55bf80
.quad 0x3f353f803f350000,0x3f353f803f350000,0x3e483f6d3f550000,0xbf7bbec43f0e3f80,0xbec43f353f6d0000,0x3ec4bf35bf6d0000,0xbf553ec43f7b0000,0x3f0e3f6dbe48bf80
.quad 0xbf8000003f800000,0xbf8000003f800000,0xbf55bec43f7b0000,0x3f0ebf6dbe483f80,0xbec4bf353f6d0000,0x3ec43f35bf6d0000,0x3e48bf6d3f550000,0xbf7b3ec43f0ebf80
.quad 0x3f35bf803f350000,0x3f35bf803f350000,0x3f7bbf6d3f0e0000,0x3e483ec4bf553f80,0x3f6dbf353ec40000,0xbf6d3f35bec40000,0x3f0ebec43e480000,0x3f55bf6d3f7bbf80
.quad 0,0,0xbf0e3ec4be480000,0xbf553f6dbf7b3f80,0xbf6d3f35bec40000,0x3f6dbf353ec40000,0xbf7b3f6dbf0e0000,0xbe48bec43f55bf80
.quad 0xbf353f80bf350000,0xbf353f80bf350000,0xbe483f6dbf550000,0x3f7bbec4bf0e3f80,0x3ec43f35bf6d0000,0xbec4bf353f6d0000,0x3f553ec4bf7b0000,0xbf0e3f6d3e48bf80
.quad 0x3f800000bf800000,0x3f800000bf800000,0x3f55bec4bf7b0000,0xbf0ebf6d3e483f80,0x3ec4bf35bf6d0000,0xbec43f353f6d0000,0xbe48bf6dbf550000,0x3f7b3ec4bf0ebf80
.quad 0xbf35bf80bf350000,0xbf35bf80bf350000,0xbf7bbf6dbf0e0000,0xbe483ec43f553f80,0xbf6dbf35bec40000,0x3f6d3f353ec40000,0xbf0ebec4be480000,0xbf55bf6dbf7bbf80
.quad 0,0,0x3f7b3f6d3f553f35,0x3e483ec43f0e3f35,0x3ec43f353f6d3f80,0xbec4bf35bf6dbf80,0xbf55bec43e483f35,0x3f0e3f6d3f7b3f35
.quad 0xbf35bf80bf350000,0xbf35bf80bf350000,0x3f0ebec4bf7bbf35,0x3f553f6d3e48bf35,0x3f6d3f35bec4bf80,0xbf6dbf353ec43f80,0xbe483f6d3f0ebf35,0x3f7b3ec4bf55bf35
.quad 0xbf8000003f800000,0xbf8000003f800000,0xbe48bf6d3f0e3f35,0x3f7bbec4bf553f35,0x3f6dbf35bec43f80,0xbf6d3f353ec4bf80,0x3f0e3ec4bf7b3f35,0x3f55bf6d3e483f35
.quad 0xbf353f80bf350000,0xbf353f80bf350000,0xbf553ec43e48bf35,0x3f0ebf6d3f7bbf35,0x3ec4bf353f6dbf80,0xbec43f35bf6d3f80,0x3f7bbf6d3f55bf35,0x3e48bec43f0ebf35
.quad 0,0,0xbf7b3f6dbf553f35,0xbe483ec4bf0e3f35,0xbec43f35bf6d3f80,0x3ec4bf353f6dbf80,0x3f55bec4be483f35,0xbf0e3f6dbf7b3f35
.quad 0x3f35bf803f350000,0x3f35bf803f350000,0xbf0ebec43f7bbf35,0xbf553f6dbe48bf35,0xbf6d3f353ec4bf80,0x3f6dbf35bec43f80,0x3e483f6dbf0ebf35,0xbf7b3ec43f55bf35
.quad 0x3f800000bf800000,0x3f800000bf800000,0x3e48bf6dbf0e3f35,0xbf7bbec43f553f35,0xbf6dbf353ec43f80,0x3f6d3f35bec4bf80,0xbf0e3ec43f7b3f35,0xbf55bf6dbe483f35
.quad 0x3f353f803f350000,0x3f353f803f350000,0x3f553ec4be48bf35,0xbf0ebf6dbf7bbf35,0xbec4bf35bf6dbf80,0x3ec43f353f6d3f80,0xbf7bbf6dbf55bf35,0xbe48bec4bf0ebf35
.quad 0,0,0xbf0ebec4be480000,0xbf55bf6dbf7bbf80,0xbf6dbf35bec40000,0x3f6d3f353ec40000,0xbf7bbf6dbf0e0000,0xbe483ec43f553f80
.quad 0xbf35bf80bf350000,0xbf35bf80bf350000,0xbe48bf6dbf550000,0x3f7b3ec4bf0ebf80,0x3ec4bf35bf6d0000,0xbec43f353f6d0000,0x3f55bec4bf7b0000,0xbf0ebf6d3e483f80
.quad 0x3f800000bf800000,0x3f800000bf800000,0x3f553ec4bf7b0000,0xbf0e3f6d3e48bf80,0x3ec43f35bf6d0000,0xbec4bf353f6d0000,0xbe483f6dbf550000,0x3f7bbec4bf0e3f80
.quad 0xbf353f80bf350000,0xbf353f80bf350000,0xbf7b3f6dbf0e0000,0xbe48bec43f55bf80,0xbf6d3f35bec40000,0x3f6dbf353ec40000,0xbf0e3ec4be480000,0xbf553f6dbf7b3f80
.quad 0,0,0x3f0ebec43e480000,0x3f55bf6d3f7bbf80,0x3f6dbf353ec40000,0xbf6d3f35bec40000,0x3f7bbf6d3f0e0000,0x3e483ec4bf553f80
.quad 0x3f35bf803f350000,0x3f35bf803f350000,0x3e48bf6d3f550000,0xbf7b3ec43f0ebf80,0xbec4bf353f6d0000,0x3ec43f35bf6d0000,0xbf55bec43f7b0000,0x3f0ebf6dbe483f80
.quad 0xbf8000003f800000,0xbf8000003f800000,0xbf553ec43f7b0000,0x3f0e3f6dbe48bf80,0xbec43f353f6d0000,0x3ec4bf35bf6d0000,0x3e483f6d3f550000,0xbf7bbec43f0e3f80
.quad 0x3f353f803f350000,0x3f353f803f350000,0x3f7b3f6d3f0e0000,0x3e48bec4bf55bf80,0x3f6d3f353ec40000,0xbf6dbf35bec40000,0x3f0e3ec43e480000,0x3f553f6d3f7b3f80
.quad 0,0,0xbf7bbf6dbf55bf35,0xbe48bec4bf0ebf35,0xbec4bf35bf6dbf80,0x3ec43f353f6d3f80,0x3f553ec4be48bf35,0xbf0ebf6dbf7bbf35
.quad 0x3f353f803f350000,0x3f353f803f350000,0xbf0e3ec43f7b3f35,0xbf55bf6dbe483f35,0xbf6dbf353ec43f80,0x3f6d3f35bec4bf80,0x3e48bf6dbf0e3f35,0xbf7bbec43f553f35
.quad 0x3f800000bf800000,0x3f800000bf800000,0x3e483f6dbf0ebf35,0xbf7b3ec43f55bf35,0xbf6d3f353ec4bf80,0x3f6dbf35bec43f80,0xbf0ebec43f7bbf35,0xbf553f6dbe48bf35
.quad 0x3f35bf803f350000,0x3f35bf803f350000,0x3f55bec4be483f35,0xbf0e3f6dbf7b3f35,0xbec43f35bf6d3f80,0x3ec4bf353f6dbf80,0xbf7b3f6dbf553f35,0xbe483ec4bf0e3f35
.quad 0,0,0x3f7bbf6d3f55bf35,0x3e48bec43f0ebf35,0x3ec4bf353f6dbf80,0xbec43f35bf6d3f80,0xbf553ec43e48bf35,0x3f0ebf6d3f7bbf35
.quad 0xbf353f80bf350000,0xbf353f80bf350000,0x3f0e3ec4bf7b3f35,0x3f55bf6d3e483f35,0x3f6dbf35bec43f80,0xbf6d3f353ec4bf80,0xbe48bf6d3f0e3f35,0x3f7bbec4bf553f35
.quad 0xbf8000003f800000,0xbf8000003f800000,0xbe483f6d3f0ebf35,0x3f7b3ec4bf55bf35,0x3f6d3f35bec4bf80,0xbf6dbf353ec43f80,0x3f0ebec4bf7bbf35,0x3f553f6d3e48bf35
.quad 0xbf35bf80bf350000,0xbf35bf80bf350000,0xbf55bec43e483f35,0x3f0e3f6d3f7b3f35,0x3ec43f353f6d3f80,0xbec4bf35bf6dbf80,0x3f7b3f6d3f553f35,0x3e483ec43f0e3f35
.quad 0x3f803f803f803f80,0x3f803f803f803f80,0xbf55bf6dbf7bbf80,0x3f0e3ec43e480000,0x3ec43f353f6d3f80,0xbec4bf35bf6dbf80,0x3e48bec4bf55bf80,0xbf7bbf6dbf0e0000
.quad 0xbf3500003f353f80,0xbf3500003f353f80,0x3f7b3ec4bf0ebf80,0x3e483f6d3f550000,0xbf6dbf353ec43f80,0x3f6d3f35bec4bf80,0x3f0e3f6dbe48bf80,0x3f55bec4bf7b0000
.quad 0xbf8000003f80,0xbf8000003f80,0xbf0e3f6d3e48bf80,0xbf55bec43f7b0000,0x3f6dbf35bec43f80,0xbf6d3f353ec4bf80,0xbf7b3ec43f0ebf80,0xbe483f6dbf550000
.quad 0x3f350000bf353f80,0x3f350000bf353f80,0xbe48bec43f55bf80,0x3f7bbf6d3f0e0000,0xbec43f35bf6d3f80,0x3ec4bf353f6dbf80,0x3f55bf6d3f7bbf80,0xbf0e3ec4be480000
.quad 0xbf803f80bf803f80,0xbf803f80bf803f80,0x3f55bf6d3f7bbf80,0xbf0e3ec4be480000,0xbec43f35bf6d3f80,0x3ec4bf353f6dbf80,0xbe48bec43f55bf80,0x3f7bbf6d3f0e0000
.quad 0x3f350000bf353f80,0x3f350000bf353f80,0xbf7b3ec43f0ebf80,0xbe483f6dbf550000,0x3f6dbf35bec43f80,0xbf6d3f353ec4bf80,0xbf0e3f6d3e48bf80,0xbf55bec43f7b0000
.quad 0xbf8000003f80,0xbf8000003f80,0x3f0e3f6dbe48bf80,0x3f55bec4bf7b0000,0xbf6dbf353ec43f80,0x3f6d3f35bec4bf80,0x3f7b3ec4bf0ebf80,0x3e483f6d3f550000
.quad 0xbf3500003f353f80,0xbf3500003f353f80,0x3e48bec4bf55bf80,0xbf7bbf6dbf0e0000,0x3ec43f353f6d3f80,0xbec4bf35bf6dbf80,0xbf55bf6dbf7bbf80,0x3f0e3ec43e480000
.quad 0x3f803f803f803f80,0x3f803f803f803f80,0xbe48bec4bf0ebf35,0x3f7b3f6d3f553f35,0xbf6dbf35bec40000,0x3f6d3f353ec40000,0x3f0e3f6d3f7b3f35,0x3f553ec4be48bf35
.quad 0x3f350000bf35bf80,0x3f350000bf35bf80,0xbf55bf6dbe483f35,0x3f0ebec4bf7bbf35,0xbec43f353f6d0000,0x3ec4bf35bf6d0000,0x3f7b3ec4bf55bf35,0x3e48bf6dbf0e3f35
.quad 0xbf8000003f80,0xbf8000003f80,0xbf7b3ec43f55bf35,0xbe48bf6d3f0e3f35,0x3ec43f35bf6d0000,0xbec4bf353f6d0000,0x3f55bf6d3e483f35,0xbf0ebec43f7bbf35
.quad 0xbf3500003f35bf80,0xbf3500003f35bf80,0xbf0e3f6dbf7b3f35,0xbf553ec43e48bf35,0x3f6dbf353ec40000,0xbf6d3f35bec40000,0x3e48bec43f0ebf35,0xbf7b3f6dbf553f35
.quad 0xbf803f80bf803f80,0xbf803f80bf803f80,0x3e48bec43f0ebf35,0xbf7b3f6dbf553f35,0x3f6dbf353ec40000,0xbf6d3f35bec40000,0xbf0e3f6dbf7b3f35,0xbf553ec43e48bf35
.quad 0xbf3500003f35bf80,0xbf3500003f35bf80,0x3f55bf6d3e483f35,0xbf0ebec43f7bbf35,0x3ec43f35bf6d0000,0xbec4bf353f6d0000,0xbf7b3ec43f55bf35,0xbe48bf6d3f0e3f35
.quad 0xbf8000003f80,0xbf8000003f80,0x3f7b3ec4bf55bf35,0x3e48bf6dbf0e3f35,0xbec43f353f6d0000,0x3ec4bf35bf6d0000,0xbf55bf6dbe483f35,0x3f0ebec4bf7bbf35
.quad 0x3f350000bf35bf80,0x3f350000bf35bf80,0x3f0e3f6d3f7b3f35,0x3f553ec4be48bf35,0xbf6dbf35bec40000,0x3f6d3f353ec40000,0xbe48bec4bf0ebf35,0x3f7b3f6d3f553f35
.quad 0,0,0xbf0ebec4be480000,0xbf55bf6dbf7bbf80,0x3f6d3f353ec40000,0xbf6dbf35bec40000,0xbf7bbf6dbf0e0000,0xbe483ec43f553f80
.quad 0x3f353f803f350000,0x3f353f803f350000,0xbe48bf6dbf550000,0x3f7b3ec4bf0ebf80,0xbec43f353f6d0000,0x3ec4bf35bf6d0000,0x3f55bec4bf7b0000,0xbf0ebf6d3e483f80
.quad 0xbf8000003f800000,0xbf8000003f800000,0x3f553ec4bf7b0000,0xbf0e3f6d3e48bf80,0xbec4bf353f6d0000,0x3ec43f35bf6d0000,0xbe483f6dbf550000,0x3f7bbec4bf0e3f80
.quad 0x3f35bf803f350000,0x3f35bf803f350000,0xbf7b3f6dbf0e0000,0xbe48bec43f55bf80,0x3f6dbf353ec40000,0xbf6d3f35bec40000,0xbf0e3ec4be480000,0xbf553f6dbf7b3f80
.quad 0,0,0x3f0ebec43e480000,0x3f55bf6d3f7bbf80,0xbf6d3f35bec40000,0x3f6dbf353ec40000,0x3f7bbf6d3f0e0000,0x3e483ec4bf553f80
.quad 0xbf353f80bf350000,0xbf353f80bf350000,0x3e48bf6d3f550000,0xbf7b3ec43f0ebf80,0x3ec43f35bf6d0000,0xbec4bf353f6d0000,0xbf55bec43f7b0000,0x3f0ebf6dbe483f80
.quad 0x3f800000bf800000,0x3f800000bf800000,0xbf553ec43f7b0000,0x3f0e3f6dbe48bf80,0x3ec4bf35bf6d0000,0xbec43f353f6d0000,0x3e483f6d3f550000,0xbf7bbec43f0e3f80
.quad 0xbf35bf80bf350000,0xbf35bf80bf350000,0x3f7b3f6d3f0e0000,0x3e48bec4bf55bf80,0xbf6dbf35bec40000,0x3f6d3f353ec40000,0x3f0e3ec43e480000,0x3f553f6d3f7b3f80
.quad 0,0,0xbf7bbf6dbf55bf35,0xbe48bec4bf0ebf35,0x3ec43f353f6d3f80,0xbec4bf35bf6dbf80,0x3f553ec4be48bf35,0xbf0ebf6dbf7bbf35
.quad 0xbf35bf80bf350000,0xbf35bf80bf350000,0xbf0e3ec43f7b3f35,0xbf55bf6dbe483f35,0x3f6d3f35bec4bf80,0xbf6dbf353ec43f80,0x3e48bf6dbf0e3f35,0xbf7bbec43f553f35
.quad 0xbf8000003f800000,0xbf8000003f800000,0x3e483f6dbf0ebf35,0xbf7b3ec43f55bf35,0x3f6dbf35bec43f80,0xbf6d3f353ec4bf80,0xbf0ebec43f7bbf35,0xbf553f6dbe48bf35
.quad 0xbf353f80bf350000,0xbf353f80bf350000,0x3f55bec4be483f35,0xbf0e3f6dbf7b3f35,0x3ec4bf353f6dbf80,0xbec43f35bf6d3f80,0xbf7b3f6dbf553f35,0xbe483ec4bf0e3f35
.quad 0,0,0x3f7bbf6d3f55bf35,0x3e48bec43f0ebf35,0xbec43f35bf6d3f80,0x3ec4bf353f6dbf80,0xbf553ec43e48bf35,0x3f0ebf6d3f7bbf35
.quad 0x3f35bf803f350000,0x3f35bf803f350000,0x3f0e3ec4bf7b3f35,0x3f55bf6d3e483f35,0xbf6d3f353ec4bf80,0x3f6dbf35bec43f80,0xbe48bf6d3f0e3f35,0x3f7bbec4bf553f35
.quad 0x3f800000bf800000,0x3f800000bf800000,0xbe483f6d3f0ebf35,0x3f7b3ec4bf55bf35,0xbf6dbf353ec43f80,0x3f6d3f35bec4bf80,0x3f0ebec4bf7bbf35,0x3f553f6d3e48bf35
.quad 0x3f353f803f350000,0x3f353f803f350000,0xbf55bec43e483f35,0x3f0e3f6d3f7b3f35,0xbec4bf35bf6dbf80,0x3ec43f353f6d3f80,0x3f7b3f6d3f553f35,0x3e483ec43f0e3f35
.quad 0,0,0x3f0e3ec43e480000,0x3f553f6d3f7b3f80,0xbf6dbf35bec40000,0x3f6d3f353ec40000,0x3f7b3f6d3f0e0000,0x3e48bec4bf55bf80
.quad 0xbf35bf80bf350000,0xbf35bf80bf350000,0x3e483f6d3f550000,0xbf7bbec43f0e3f80,0x3ec4bf35bf6d0000,0xbec43f353f6d0000,0xbf553ec43f7b0000,0x3f0e3f6dbe48bf80
.quad 0x3f800000bf800000,0x3f800000bf800000,0xbf55bec43f7b0000,0x3f0ebf6dbe483f80,0x3ec43f35bf6d0000,0xbec4bf353f6d0000,0x3e48bf6d3f550000,0xbf7b3ec43f0ebf80
.quad 0xbf353f80bf350000,0xbf353f80bf350000,0x3f7bbf6d3f0e0000,0x3e483ec4bf553f80,0xbf6d3f35bec40000,0x3f6dbf353ec40000,0x3f0ebec43e480000,0x3f55bf6d3f7bbf80
.quad 0,0,0xbf0e3ec4be480000,0xbf553f6dbf7b3f80,0x3f6dbf353ec40000,0xbf6d3f35bec40000,0xbf7b3f6dbf0e0000,0xbe48bec43f55bf80
.quad 0x3f35bf803f350000,0x3f35bf803f350000,0xbe483f6dbf550000,0x3f7bbec4bf0e3f80,0xbec4bf353f6d0000,0x3ec43f35bf6d0000,0x3f553ec4bf7b0000,0xbf0e3f6d3e48bf80
.quad 0xbf8000003f800000,0xbf8000003f800000,0x3f55bec4bf7b0000,0xbf0ebf6d3e483f80,0xbec43f353f6d0000,0x3ec4bf35bf6d0000,0xbe48bf6dbf550000,0x3f7b3ec4bf0ebf80
.quad 0x3f353f803f350000,0x3f353f803f350000,0xbf7bbf6dbf0e0000,0xbe483ec43f553f80,0x3f6d3f353ec40000,0xbf6dbf35bec40000,0xbf0ebec4be480000,0xbf55bf6dbf7bbf80
.quad 0,0,0x3f7b3f6d3f553f35,0x3e483ec43f0e3f35,0xbec4bf35bf6dbf80,0x3ec43f353f6d3f80,0xbf55bec43e483f35,0x3f0e3f6d3f7b3f35
.quad 0x3f353f803f350000,0x3f353f803f350000,0x3f0ebec4bf7bbf35,0x3f553f6d3e48bf35,0xbf6dbf353ec43f80,0x3f6d3f35bec4bf80,0xbe483f6d3f0ebf35,0x3f7b3ec4bf55bf35
.quad 0x3f800000bf800000,0x3f800000bf800000,0xbe48bf6d3f0e3f35,0x3f7bbec4bf553f35,0xbf6d3f353ec4bf80,0x3f6dbf35bec43f80,0x3f0e3ec4bf7b3f35,0x3f55bf6d3e483f35
.quad 0x3f35bf803f350000,0x3f35bf803f350000,0xbf553ec43e48bf35,0x3f0ebf6d3f7bbf35,0xbec43f35bf6d3f80,0x3ec4bf353f6dbf80,0x3f7bbf6d3f55bf35,0x3e48bec43f0ebf35
.quad 0,0,0xbf7b3f6dbf553f35,0xbe483ec4bf0e3f35,0x3ec4bf353f6dbf80,0xbec43f35bf6d3f80,0x3f55bec4be483f35,0xbf0e3f6dbf7b3f35
.quad 0xbf353f80bf350000,0xbf353f80bf350000,0xbf0ebec43f7bbf35,0xbf553f6dbe48bf35,0x3f6dbf35bec43f80,0xbf6d3f353ec4bf80,0x3e483f6dbf0ebf35,0xbf7b3ec43f55bf35
.quad 0xbf8000003f800000,0xbf8000003f800000,0x3e48bf6dbf0e3f35,0xbf7bbec43f553f35,0x3f6d3f35bec4bf80,0xbf6dbf353ec43f80,0xbf0e3ec43f7b3f35,0xbf55bf6dbe483f35
.quad 0xbf35bf80bf350000,0xbf35bf80bf350000,0x3f553ec4be48bf35,0xbf0ebf6dbf7bbf35,0x3ec43f353f6d3f80,0xbec4bf35bf6dbf80,0xbf7bbf6dbf55bf35,0xbe48bec4bf0ebf35
.quad 0x3f803f803f803f80,0x3f803f803f803f80,0x3f753f7b3f7f3f80,0x3ef13f0e3f223f35,0x3f553f6d3f7b3f80,0xbf0ebec4be480000,0x3f223f553f753f80,0xbf7fbf7bbf62bf35
.quad 0x3ec43f353f6d3f80,0xbec4bf35bf6dbf80,0x3dc93f0e3f623f80,0x3f223e48be95bf35,0xbe483ec43f553f80,0x3f7b3f6d3f0e0000,0xbef13e483f463f80,0x3e953f553f7f3f35
.quad 0xbf3500003f353f80,0xbf3500003f353f80,0xbf62be483f223f80,0xbf75bf55bdc93f35,0xbf7bbec43f0e3f80,0xbe48bf6dbf550000,0xbf7fbf0e3ef13f80,0x3f46be48bf75bf35
.quad 0xbf6dbf353ec43f80,0x3f6d3f35bec4bf80,0xbf46bf553e953f80,0x3dc93f7b3ef1bf35,0xbf0ebf6d3e483f80,0xbf553ec43f7b0000,0xbe95bf7b3dc93f80,0xbf62bf0e3f463f35
.quad 0xbf8000003f80,0xbf8000003f80,0x3e95bf7bbdc93f80,0x3f62bf0ebf463f35,0x3f0ebf6dbe483f80,0x3f553ec4bf7b0000,0x3f46bf55be953f80,0xbdc93f7bbef1bf35
.quad 0x3f6dbf35bec43f80,0xbf6d3f353ec4bf80,0x3f7fbf0ebef13f80,0xbf46be483f75bf35,0x3f7bbec4bf0e3f80,0x3e48bf6d3f550000,0x3f62be48bf223f80,0x3f75bf553dc93f35
.quad 0x3f350000bf353f80,0x3f350000bf353f80,0x3ef13e48bf463f80,0xbe953f55bf7f3f35,0x3e483ec4bf553f80,0xbf7b3f6dbf0e0000,0xbdc93f0ebf623f80,0xbf223e483e95bf35
.quad 0xbec43f35bf6d3f80,0x3ec4bf353f6dbf80,0xbf223f55bf753f80,0x3f7fbf7b3f62bf35,0xbf553f6dbf7b3f80,0x3f0ebec43e480000,0xbf753f7bbf7f3f80,0xbef13f0ebf223f35
.quad 0x3f803f803f803f80,0x3f803f803f803f80,0x3f463f553f623f6d,0x3dc93e483e953ec4,0x3e483ec43f0e3f35,0xbf7bbf6dbf55bf35,0xbef1be483dc93ec4,0xbe95bf0ebf46bf6d
.quad 0xbf6dbf35bec40000,0x3f6d3f353ec40000,0xbf75bf7bbf46bec4,0x3ef13f553f7f3f6d,0xbf0ebf6dbf7bbf35,0xbf55bec43e483f35,0x3dc9bf0ebf75bf6d,0xbf22bf7bbf62bec4
.quad 0x3f350000bf35bf80,0x3f350000bf35bf80,0x3f7f3f0ebe95bf6d,0x3f463f7b3ef1bec4,0x3f553f6d3e48bf35,0xbf0e3ec43f7b3f35,0x3e953f7b3f22bec4,0xbf62bf553dc93f6d
.quad 0xbec43f353f6d0000,0x3ec4bf35bf6d0000,0xbf623e483f7f3ec4,0x3f753f0ebf22bf6d,0xbf7bbec43f553f35,0xbe483f6d3f0ebf35,0xbf22bf553ef13f6d,0xbf7fbe483f753ec4
.quad 0xbf8000003f80,0xbf8000003f80,0x3f22bf55bef13f6d,0x3f7fbe48bf753ec4,0x3f7bbec4bf553f35,0x3e483f6dbf0ebf35,0x3f623e48bf7f3ec4,0xbf753f0e3f22bf6d
.quad 0x3ec43f35bf6d0000,0xbec4bf353f6d0000,0xbe953f7bbf22bec4,0x3f62bf55bdc93f6d,0xbf553f6dbe48bf35,0x3f0e3ec4bf7b3f35,0xbf7f3f0e3e95bf6d,0xbf463f7bbef1bec4
.quad 0xbf3500003f35bf80,0xbf3500003f35bf80,0xbdc9bf0e3f75bf6d,0x3f22bf7b3f62bec4,0x3f0ebf6d3f7bbf35,0x3f55bec4be483f35,0x3f75bf7b3f46bec4,0xbef13f55bf7f3f6d
.quad 0x3f6dbf353ec40000,0xbf6d3f35bec40000,0x3ef1be48bdc93ec4,0x3e95bf0e3f46bf6d,0xbe483ec4bf0e3f35,0x3f7bbf6d3f55bf35,0xbf463f55bf623f6d,0xbdc93e48be953ec4
.quad 0,0,0x3e953e483dc90000,0x3f623f553f463f35,0x3f0e3ec43e480000,0x3f553f6d3f7b3f80,0x3f463f0e3e950000,0xbdc93e483ef13f35
.quad 0x3f6d3f353ec40000,0xbf6dbf35bec40000,0x3f7f3f553ef10000,0xbf46bf7bbf75bf35,0x3f7b3f6d3f0e0000,0x3e48bec4bf55bf80,0x3f623f7b3f220000,0x3f753f0ebdc9bf35
.quad 0x3f353f803f350000,0x3f353f803f350000,0x3ef13f7b3f460000,0xbe953f0e3f7f3f35,0x3e483f6d3f550000,0xbf7bbec43f0e3f80,0xbdc93f553f620000,0xbf22bf7bbe953f35
.quad 0xbec43f353f6d0000,0x3ec4bf35bf6d0000,0xbf223f0e3f750000,0x3f7f3e48bf62bf35,0xbf553ec43f7b0000,0x3f0e3f6dbe48bf80,0xbf753e483f7f0000,0xbef13f553f22bf35
.quad 0xbf8000003f800000,0xbf8000003f800000,0xbf75be483f7f0000,0xbef1bf553f223f35,0xbf55bec43f7b0000,0x3f0ebf6dbe483f80,0xbf22bf0e3f750000,0x3f7fbe48bf623f35
.quad 0xbec4bf353f6d0000,0x3ec43f35bf6d0000,0xbdc9bf553f620000,0xbf223f7bbe95bf35,0x3e48bf6d3f550000,0xbf7b3ec43f0ebf80,0x3ef1bf7b3f460000,0xbe95bf0e3f7fbf35
.quad 0x3f35bf803f350000,0x3f35bf803f350000,0x3f62bf7b3f220000,0x3f75bf0ebdc93f35,0x3f7bbf6d3f0e0000,0x3e483ec4bf553f80,0x3f7fbf553ef10000,0xbf463f7bbf753f35
.quad 0x3f6dbf353ec40000,0xbf6d3f35bec40000,0x3f46bf0e3e950000,0xbdc9be483ef1bf35,0x3f0ebec43e480000,0x3f55bf6d3f7bbf80,0x3e95be483dc90000,0x3f62bf553f46bf35
.quad 0,0,0x3f223f0e3ef13ec4,0x3f7f3f7b3f753f6d,0x3f7b3f6d3f553f35,0x3e483ec43f0e3f35,0x3f623f7b3f7f3f6d,0xbf75bf55bf22bec4
.quad 0x3ec43f353f6d3f80,0xbec4bf35bf6dbf80,0xbe953e483f223f6d,0x3f623f0e3dc9bec4,0xbf55bec43e483f35,0x3f0e3f6d3f7b3f35,0xbf7fbf55be953ec4,0xbf46be483ef13f6d
.quad 0xbf35bf80bf350000,0xbf35bf80bf350000,0xbdc9bf55bf75bec4,0x3f22be48bf62bf6d,0x3f0ebec4bf7bbf35,0x3f553f6d3e48bf35,0x3f753e48bf46bf6d,0xbef13f0e3f7f3ec4
.quad 0x3f6d3f35bec4bf80,0xbf6dbf353ec43f80,0x3ef13f7b3dc9bf6d,0x3e95bf55bf463ec4,0xbe483f6d3f0ebf35,0x3f7b3ec4bf55bf35,0xbf463f0e3f62bec4,0xbdc93f7b3e95bf6d
.quad 0xbf8000003f800000,0xbf8000003f800000,0xbf46bf0e3f623ec4,0xbdc9bf7b3e953f6d,0xbe48bf6d3f0e3f35,0x3f7bbec4bf553f35,0x3ef1bf7b3dc93f6d,0x3e953f55bf46bec4
.quad 0x3f6dbf35bec43f80,0xbf6d3f353ec4bf80,0x3f75be48bf463f6d,0xbef1bf0e3f7fbec4,0x3f0e3ec4bf7b3f35,0x3f55bf6d3e483f35,0xbdc93f55bf753ec4,0x3f223e48bf623f6d
.quad 0xbf353f80bf350000,0xbf353f80bf350000,0xbf7f3f55be95bec4,0xbf463e483ef1bf6d,0xbf553ec43e48bf35,0x3f0ebf6d3f7bbf35,0xbe95be483f22bf6d,0x3f62bf0e3dc93ec4
.quad 0x3ec4bf353f6dbf80,0xbec43f35bf6d3f80,0x3f62bf7b3f7fbf6d,0xbf753f55bf223ec4,0x3f7bbf6d3f55bf35,0x3e48bec43f0ebf35,0x3f22bf0e3ef1bec4,0x3f7fbf7b3f75bf6d
.quad 0,0,0xbe95be48bdc90000,0xbf62bf55bf46bf35,0xbf0ebec4be480000,0xbf55bf6dbf7bbf80,0xbf46bf0ebe950000,0x3dc9be48bef1bf35
.quad 0xbf6dbf35bec40000,0x3f6d3f353ec40000,0xbf7fbf55bef10000,0x3f463f7b3f753f35,0xbf7bbf6dbf0e0000,0xbe483ec43f553f80,0xbf62bf7bbf220000,0xbf75bf0e3dc93f35
.quad 0xbf35bf80bf350000,0xbf35bf80bf350000,0xbef1bf7bbf460000,0x3e95bf0ebf7fbf35,0xbe48bf6dbf550000,0x3f7b3ec4bf0ebf80,0x3dc9bf55bf620000,0x3f223f7b3e95bf35
.quad 0x3ec4bf35bf6d0000,0xbec43f353f6d0000,0x3f22bf0ebf750000,0xbf7fbe483f623f35,0x3f55bec4bf7b0000,0xbf0ebf6d3e483f80,0x3f75be48bf7f0000,0x3ef1bf55bf223f35
.quad 0x3f800000bf800000,0x3f800000bf800000,0x3f753e48bf7f0000,0x3ef13f55bf22bf35,0x3f553ec4bf7b0000,0xbf0e3f6d3e48bf80,0x3f223f0ebf750000,0xbf7f3e483f62bf35
.quad 0x3ec43f35bf6d0000,0xbec4bf353f6d0000,0x3dc93f55bf620000,0x3f22bf7b3e953f35,0xbe483f6dbf550000,0x3f7bbec4bf0e3f80,0xbef13f7bbf460000,0x3e953f0ebf7f3f35
.quad 0xbf353f80bf350000,0xbf353f80bf350000,0xbf623f7bbf220000,0xbf753f0e3dc9bf35,0xbf7b3f6dbf0e0000,0xbe48bec43f55bf80,0xbf7f3f55bef10000,0x3f46bf7b3f75bf35
.quad 0xbf6d3f35bec40000,0x3f6dbf353ec40000,0xbf463f0ebe950000,0x3dc93e48bef13f35,0xbf0e3ec4be480000,0xbf553f6dbf7b3f80,0xbe953e48bdc90000,0xbf623f55bf463f35
.quad 0,0,0xbf22bf0ebef1bec4,0xbf7fbf7bbf75bf6d,0xbf7bbf6dbf55bf35,0xbe48bec4bf0ebf35,0xbf62bf7bbf7fbf6d,0x3f753f553f223ec4
.quad 0xbec4bf35bf6dbf80,0x3ec43f353f6d3f80,0x3e95be48bf22bf6d,0xbf62bf0ebdc93ec4,0x3f553ec4be48bf35,0xbf0ebf6dbf7bbf35,0x3f7f3f553e95bec4,0x3f463e48bef1bf6d
.quad 0x3f353f803f350000,0x3f353f803f350000,0x3dc93f553f753ec4,0xbf223e483f623f6d,0xbf0e3ec43f7b3f35,0xbf55bf6dbe483f35,0xbf75be483f463f6d,0x3ef1bf0ebf7fbec4
.quad 0xbf6dbf353ec43f80,0x3f6d3f35bec4bf80,0xbef1bf7bbdc93f6d,0xbe953f553f46bec4,0x3e48bf6dbf0e3f35,0xbf7bbec43f553f35,0x3f46bf0ebf623ec4,0x3dc9bf7bbe953f6d
.quad 0x3f800000bf800000,0x3f800000bf800000,0x3f463f0ebf62bec4,0x3dc93f7bbe95bf6d,0x3e483f6dbf0ebf35,0xbf7b3ec43f55bf35,0xbef13f7bbdc9bf6d,0xbe95bf553f463ec4
.quad 0xbf6d3f353ec4bf80,0x3f6dbf35bec43f80,0xbf753e483f46bf6d,0x3ef13f0ebf7f3ec4,0xbf0ebec43f7bbf35,0xbf553f6dbe48bf35,0x3dc9bf553f75bec4,0xbf22be483f62bf6d
.quad 0x3f35bf803f350000,0x3f35bf803f350000,0x3f7fbf553e953ec4,0x3f46be48bef13f6d,0x3f55bec4be483f35,0xbf0e3f6dbf7b3f35,0x3e953e48bf223f6d,0xbf623f0ebdc9bec4
.quad 0xbec43f35bf6d3f80,0x3ec4bf353f6dbf80,0xbf623f7bbf7f3f6d,0x3f75bf553f22bec4,0xbf7b3f6dbf553f35,0xbe483ec4bf0e3f35,0xbf223f0ebef13ec4,0xbf7f3f7bbf753f6d
.quad 0x3f803f803f803f80,0x3f803f803f803f80,0xbe95be48bdc90000,0xbf62bf55bf46bf35,0xbf55bf6dbf7bbf80,0x3f0e3ec43e480000,0x3f463f0e3e950000,0xbdc93e483ef13f35
.quad 0x3ec43f353f6d3f80,0xbec4bf35bf6dbf80,0xbf7fbf55bef10000,0x3f463f7b3f753f35,0x3e48bec4bf55bf80,0xbf7bbf6dbf0e0000,0x3f623f7b3f220000,0x3f753f0ebdc9bf35
.quad 0xbf3500003f353f80,0xbf3500003f353f80,0xbef1bf7bbf460000,0x3e95bf0ebf7fbf35,0x3f7b3ec4bf0ebf80,0x3e483f6d3f550000,0xbdc93f553f620000,0xbf22bf7bbe953f35
.quad 0xbf6dbf353ec43f80,0x3f6d3f35bec4bf80,0x3f22bf0ebf750000,0xbf7fbe483f623f35,0x3f0e3f6dbe48bf80,0x3f55bec4bf7b0000,0xbf753e483f7f0000,0xbef13f553f22bf35
.quad 0xbf8000003f80,0xbf8000003f80,0x3f753e48bf7f0000,0x3ef13f55bf22bf35,0xbf0e3f6d3e48bf80,0xbf55bec43f7b0000,0xbf22bf0e3f750000,0x3f7fbe48bf623f35
.quad 0x3f6dbf35bec43f80,0xbf6d3f353ec4bf80,0x3dc93f55bf620000,0x3f22bf7b3e953f35,0xbf7b3ec43f0ebf80,0xbe483f6dbf550000,0x3ef1bf7b3f460000,0xbe95bf0e3f7fbf35
.quad 0x3f350000bf353f80,0x3f350000bf353f80,0xbf623f7bbf220000,0xbf753f0e3dc9bf35,0xbe48bec43f55bf80,0x3f7bbf6d3f0e0000,0x3f7fbf553ef10000,0xbf463f7bbf753f35
.quad 0xbec43f35bf6d3f80,0x3ec4bf353f6dbf80,0xbf463f0ebe950000,0x3dc93e48bef13f35,0x3f55bf6d3f7bbf80,0xbf0e3ec4be480000,0x3e95be483dc90000,0x3f62bf553f46bf35
.quad 0x3f803f803f803f80,0x3f803f803f803f80,0xbf22bf0ebef1bec4,0xbf7fbf7bbf75bf6d,0xbe48bec4bf0ebf35,0x3f7b3f6d3f553f35,0x3f623f7b3f7f3f6d,0xbf75bf55bf22bec4
.quad 0xbf6dbf35bec40000,0x3f6d3f353ec40000,0x3e95be48bf22bf6d,0xbf62bf0ebdc93ec4,0x3f0e3f6d3f7b3f35,0x3f553ec4be48bf35,0xbf7fbf55be953ec4,0xbf46be483ef13f6d
.quad 0x3f350000bf35bf80,0x3f350000bf35bf80,0x3dc93f553f753ec4,0xbf223e483f623f6d,0xbf55bf6dbe483f35,0x3f0ebec4bf7bbf35,0x3f753e48bf46bf6d,0xbef13f0e3f7f3ec4
.quad 0xbec43f353f6d0000,0x3ec4bf35bf6d0000,0xbef1bf7bbdc93f6d,0xbe953f553f46bec4,0x3f7b3ec4bf55bf35,0x3e48bf6dbf0e3f35,0xbf463f0e3f62bec4,0xbdc93f7b3e95bf6d
.quad 0xbf8000003f80,0xbf8000003f80,0x3f463f0ebf62bec4,0x3dc93f7bbe95bf6d,0xbf7b3ec43f55bf35,0xbe48bf6d3f0e3f35,0x3ef1bf7b3dc93f6d,0x3e953f55bf46bec4
.quad 0x3ec43f35bf6d0000,0xbec4bf353f6d0000,0xbf753e483f46bf6d,0x3ef13f0ebf7f3ec4,0x3f55bf6d3e483f35,0xbf0ebec43f7bbf35,0xbdc93f55bf753ec4,0x3f223e48bf623f6d
.quad 0xbf3500003f35bf80,0xbf3500003f35bf80,0x3f7fbf553e953ec4,0x3f46be48bef13f6d,0xbf0e3f6dbf7b3f35,0xbf553ec43e48bf35,0xbe95be483f22bf6d,0x3f62bf0e3dc93ec4
.quad 0x3f6dbf353ec40000,0xbf6d3f35bec40000,0xbf623f7bbf7f3f6d,0x3f75bf553f22bec4,0x3e48bec43f0ebf35,0xbf7b3f6dbf553f35,0x3f22bf0e3ef1bec4,0x3f7fbf7b3f75bf6d
.quad 0,0,0x3f753f7b3f7f3f80,0x3ef13f0e3f223f35,0xbf0ebec4be480000,0xbf55bf6dbf7bbf80,0xbf22bf55bf75bf80,0x3f7f3f7b3f623f35
.quad 0x3f6d3f353ec40000,0xbf6dbf35bec40000,0x3dc93f0e3f623f80,0x3f223e48be95bf35,0xbf7bbf6dbf0e0000,0xbe483ec43f553f80,0x3ef1be48bf46bf80,0xbe95bf55bf7fbf35
.quad 0x3f353f803f350000,0x3f353f803f350000,0xbf62be483f223f80,0xbf75bf55bdc93f35,0xbe48bf6dbf550000,0x3f7b3ec4bf0ebf80,0x3f7f3f0ebef1bf80,0xbf463e483f753f35
.quad 0xbec43f353f6d0000,0x3ec4bf35bf6d0000,0xbf46bf553e953f80,0x3dc93f7b3ef1bf35,0x3f55bec4bf7b0000,0xbf0ebf6d3e483f80,0x3e953f7bbdc9bf80,0x3f623f0ebf46bf35
.quad 0xbf8000003f800000,0xbf8000003f800000,0x3e95bf7bbdc93f80,0x3f62bf0ebf463f35,0x3f553ec4bf7b0000,0xbf0e3f6d3e48bf80,0xbf463f553e95bf80,0x3dc9bf7b3ef13f35
.quad 0xbec4bf353f6d0000,0x3ec43f35bf6d0000,0x3f7fbf0ebef13f80,0xbf46be483f75bf35,0xbe483f6dbf550000,0x3f7bbec4bf0e3f80,0xbf623e483f22bf80,0xbf753f55bdc9bf35
.quad 0x3f35bf803f350000,0x3f35bf803f350000,0x3ef13e48bf463f80,0xbe953f55bf7f3f35,0xbf7b3f6dbf0e0000,0xbe48bec43f55bf80,0x3dc9bf0e3f62bf80,0x3f22be48be953f35
.quad 0x3f6dbf353ec40000,0xbf6d3f35bec40000,0xbf223f55bf753f80,0x3f7fbf7b3f62bf35,0xbf0e3ec4be480000,0xbf553f6dbf7b3f80,0x3f75bf7b3f7fbf80,0x3ef1bf0e3f22bf35
.quad 0,0,0x3f463f553f623f6d,0x3dc93e483e953ec4,0xbf7bbf6dbf55bf35,0xbe48bec4bf0ebf35,0x3ef13e48bdc9bec4,0x3e953f0e3f463f6d
.quad 0x3ec43f353f6d3f80,0xbec4bf35bf6dbf80,0xbf75bf7bbf46bec4,0x3ef13f553f7f3f6d,0x3f553ec4be48bf35,0xbf0ebf6dbf7bbf35,0xbdc93f0e3f753f6d,0x3f223f7b3f623ec4
.quad 0xbf35bf80bf350000,0xbf35bf80bf350000,0x3f7f3f0ebe95bf6d,0x3f463f7b3ef1bec4,0xbf0e3ec43f7b3f35,0xbf55bf6dbe483f35,0xbe95bf7bbf223ec4,0x3f623f55bdc9bf6d
.quad 0x3f6d3f35bec4bf80,0xbf6dbf353ec43f80,0xbf623e483f7f3ec4,0x3f753f0ebf22bf6d,0x3e48bf6dbf0e3f35,0xbf7bbec43f553f35,0x3f223f55bef1bf6d,0x3f7f3e48bf75bec4
.quad 0xbf8000003f800000,0xbf8000003f800000,0x3f22bf55bef13f6d,0x3f7fbe48bf753ec4,0x3e483f6dbf0ebf35,0xbf7b3ec43f55bf35,0xbf62be483f7fbec4,0x3f75bf0ebf223f6d
.quad 0x3f6dbf35bec43f80,0xbf6d3f353ec4bf80,0xbe953f7bbf22bec4,0x3f62bf55bdc93f6d,0xbf0ebec43f7bbf35,0xbf553f6dbe48bf35,0x3f7fbf0ebe953f6d,0x3f46bf7b3ef13ec4
.quad 0xbf353f80bf350000,0xbf353f80bf350000,0xbdc9bf0e3f75bf6d,0x3f22bf7b3f62bec4,0x3f55bec4be483f35,0xbf0e3f6dbf7b3f35,0xbf753f7bbf463ec4,0x3ef1bf553f7fbf6d
.quad 0x3ec4bf353f6dbf80,0xbec43f35bf6d3f80,0x3ef1be48bdc93ec4,0x3e95bf0e3f46bf6d,0xbf7b3f6dbf553f35,0xbe483ec4bf0e3f35,0x3f46bf553f62bf6d,0x3dc9be483e95bec4
.quad 0,0,0xbf75bf7bbf7fbf80,0xbef1bf0ebf22bf35,0x3f0e3ec43e480000,0x3f553f6d3f7b3f80,0x3f223f553f753f80,0xbf7fbf7bbf62bf35
.quad 0xbf6dbf35bec40000,0x3f6d3f353ec40000,0xbdc9bf0ebf62bf80,0xbf22be483e953f35,0x3f7b3f6d3f0e0000,0x3e48bec4bf55bf80,0xbef13e483f463f80,0x3e953f553f7f3f35
.quad 0xbf35bf80bf350000,0xbf35bf80bf350000,0x3f623e48bf22bf80,0x3f753f553dc9bf35,0x3e483f6d3f550000,0xbf7bbec43f0e3f80,0xbf7fbf0e3ef13f80,0x3f46be48bf75bf35
.quad 0x3ec4bf35bf6d0000,0xbec43f353f6d0000,0x3f463f55be95bf80,0xbdc9bf7bbef13f35,0xbf553ec43f7b0000,0x3f0e3f6dbe48bf80,0xbe95bf7b3dc93f80,0xbf62bf0e3f463f35
.quad 0x3f800000bf800000,0x3f800000bf800000,0xbe953f7b3dc9bf80,0xbf623f0e3f46bf35,0xbf55bec43f7b0000,0x3f0ebf6dbe483f80,0x3f46bf55be953f80,0xbdc93f7bbef1bf35
.quad 0x3ec43f35bf6d0000,0xbec4bf353f6d0000,0xbf7f3f0e3ef1bf80,0x3f463e48bf753f35,0x3e48bf6d3f550000,0xbf7b3ec43f0ebf80,0x3f62be48bf223f80,0x3f75bf553dc93f35
.quad 0xbf353f80bf350000,0xbf353f80bf350000,0xbef1be483f46bf80,0x3e95bf553f7fbf35,0x3f7bbf6d3f0e0000,0x3e483ec4bf553f80,0xbdc93f0ebf623f80,0xbf223e483e95bf35
.quad 0xbf6d3f35bec40000,0x3f6dbf353ec40000,0x3f22bf553f75bf80,0xbf7f3f7bbf623f35,0x3f0ebec43e480000,0x3f55bf6d3f7bbf80,0xbf753f7bbf7f3f80,0xbef13f0ebf223f35
.quad 0,0,0xbf46bf55bf62bf6d,0xbdc9be48be95bec4,0x3f7b3f6d3f553f35,0x3e483ec43f0e3f35,0xbef1be483dc93ec4,0xbe95bf0ebf46bf6d
.quad 0xbec4bf35bf6dbf80,0x3ec43f353f6d3f80,0x3f753f7b3f463ec4,0xbef1bf55bf7fbf6d,0xbf55bec43e483f35,0x3f0e3f6d3f7b3f35,0x3dc9bf0ebf75bf6d,0xbf22bf7bbf62bec4
.quad 0x3f353f803f350000,0x3f353f803f350000,0xbf7fbf0e3e953f6d,0xbf46bf7bbef13ec4,0x3f0ebec4bf7bbf35,0x3f553f6d3e48bf35,0x3e953f7b3f22bec4,0xbf62bf553dc93f6d
.quad 0xbf6dbf353ec43f80,0x3f6d3f35bec4bf80,0x3f62be48bf7fbec4,0xbf75bf0e3f223f6d,0xbe483f6d3f0ebf35,0x3f7b3ec4bf55bf35,0xbf22bf553ef13f6d,0xbf7fbe483f753ec4
.quad 0x3f800000bf800000,0x3f800000bf800000,0xbf223f553ef1bf6d,0xbf7f3e483f75bec4,0xbe48bf6d3f0e3f35,0x3f7bbec4bf553f35,0x3f623e48bf7f3ec4,0xbf753f0e3f22bf6d
.quad 0xbf6d3f353ec4bf80,0x3f6dbf35bec43f80,0x3e95bf7b3f223ec4,0xbf623f553dc9bf6d,0x3f0e3ec4bf7b3f35,0x3f55bf6d3e483f35,0xbf7f3f0e3e95bf6d,0xbf463f7bbef1bec4
.quad 0x3f35bf803f350000,0x3f35bf803f350000,0x3dc93f0ebf753f6d,0xbf223f7bbf623ec4,0xbf553ec43e48bf35,0x3f0ebf6d3f7bbf35,0x3f75bf7b3f46bec4,0xbef13f55bf7f3f6d
.quad 0xbec43f35bf6d3f80,0x3ec4bf353f6dbf80,0xbef13e483dc9bec4,0xbe953f0ebf463f6d,0x3f7bbf6d3f55bf35,0x3e48bec43f0ebf35,0xbf463f55bf623f6d,0xbdc93e48be953ec4
.quad 0x3f803f803f803f80,0x3f803f803f803f80,0xbf75bf7bbf7fbf80,0xbef1bf0ebf22bf35,0x3f553f6d3f7b3f80,0xbf0ebec4be480000,0xbf22bf55bf75bf80,0x3f7f3f7b3f623f35
.quad 0x3ec43f353f6d3f80,0xbec4bf35bf6dbf80,0xbdc9bf0ebf62bf80,0xbf22be483e953f35,0xbe483ec43f553f80,0x3f7b3f6d3f0e0000,0x3ef1be48bf46bf80,0xbe95bf55bf7fbf35
.quad 0xbf3500003f353f80,0xbf3500003f353f80,0x3f623e48bf22bf80,0x3f753f553dc9bf35,0xbf7bbec43f0e3f80,0xbe48bf6dbf550000,0x3f7f3f0ebef1bf80,0xbf463e483f753f35
.quad 0xbf6dbf353ec43f80,0x3f6d3f35bec4bf80,0x3f463f55be95bf80,0xbdc9bf7bbef13f35,0xbf0ebf6d3e483f80,0xbf553ec43f7b0000,0x3e953f7bbdc9bf80,0x3f623f0ebf46bf35
.quad 0xbf8000003f80,0xbf8000003f80,0xbe953f7b3dc9bf80,0xbf623f0e3f46bf35,0x3f0ebf6dbe483f80,0x3f553ec4bf7b0000,0xbf463f553e95bf80,0x3dc9bf7b3ef13f35
.quad 0x3f6dbf35bec43f80,0xbf6d3f353ec4bf80,0xbf7f3f0e3ef1bf80,0x3f463e48bf753f35,0x3f7bbec4bf0e3f80,0x3e48bf6d3f550000,0xbf623e483f22bf80,0xbf753f55bdc9bf35
.quad 0x3f350000bf353f80,0x3f350000bf353f80,0xbef1be483f46bf80,0x3e95bf553f7fbf35,0x3e483ec4bf553f80,0xbf7b3f6dbf0e0000,0x3dc9bf0e3f62bf80,0x3f22be48be953f35
.quad 0xbec43f35bf6d3f80,0x3ec4bf353f6dbf80,0x3f22bf553f75bf80,0xbf7f3f7bbf623f35,0xbf553f6dbf7b3f80,0x3f0ebec43e480000,0x3f75bf7b3f7fbf80,0x3ef1bf0e3f22bf35
.quad 0x3f803f803f803f80,0x3f803f803f803f80,0xbf46bf55bf62bf6d,0xbdc9be48be95bec4,0x3e483ec43f0e3f35,0xbf7bbf6dbf55bf35,0x3ef13e48bdc9bec4,0x3e953f0e3f463f6d
.quad 0xbf6dbf35bec40000,0x3f6d3f353ec40000,0x3f753f7b3f463ec4,0xbef1bf55bf7fbf6d,0xbf0ebf6dbf7bbf35,0xbf55bec43e483f35,0xbdc93f0e3f753f6d,0x3f223f7b3f623ec4
.quad 0x3f350000bf35bf80,0x3f350000bf35bf80,0xbf7fbf0e3e953f6d,0xbf46bf7bbef13ec4,0x3f553f6d3e48bf35,0xbf0e3ec43f7b3f35,0xbe95bf7bbf223ec4,0x3f623f55bdc9bf6d
.quad 0xbec43f353f6d0000,0x3ec4bf35bf6d0000,0x3f62be48bf7fbec4,0xbf75bf0e3f223f6d,0xbf7bbec43f553f35,0xbe483f6d3f0ebf35,0x3f223f55bef1bf6d,0x3f7f3e48bf75bec4
.quad 0xbf8000003f80,0xbf8000003f80,0xbf223f553ef1bf6d,0xbf7f3e483f75bec4,0x3f7bbec4bf553f35,0x3e483f6dbf0ebf35,0xbf62be483f7fbec4,0x3f75bf0ebf223f6d
.quad 0x3ec43f35bf6d0000,0xbec4bf353f6d0000,0x3e95bf7b3f223ec4,0xbf623f553dc9bf6d,0xbf553f6dbe48bf35,0x3f0e3ec4bf7b3f35,0x3f7fbf0ebe953f6d,0x3f46bf7b3ef13ec4
.quad 0xbf3500003f35bf80,0xbf3500003f35bf80,0x3dc93f0ebf753f6d,0xbf223f7bbf623ec4,0x3f0ebf6d3f7bbf35,0x3f55bec4be483f35,0xbf753f7bbf463ec4,0x3ef1bf553f7fbf6d
.quad 0x3f6dbf353ec40000,0xbf6d3f35bec40000,0xbef13e483dc9bec4,0xbe953f0ebf463f6d,0xbe483ec4bf0e3f35,0x3f7bbf6d3f55bf35,0x3f46bf553f62bf6d,0x3dc9be483e95bec4
.quad 0,0,0xbe95be48bdc90000,0xbf62bf55bf46bf35,0x3f0e3ec43e480000,0x3f553f6d3f7b3f80,0xbf46bf0ebe950000,0x3dc9be48bef1bf35
.quad 0x3f6d3f353ec40000,0xbf6dbf35bec40000,0xbf7fbf55bef10000,0x3f463f7b3f753f35,0x3f7b3f6d3f0e0000,0x3e48bec4bf55bf80,0xbf62bf7bbf220000,0xbf75bf0e3dc93f35
.quad 0x3f353f803f350000,0x3f353f803f350000,0xbef1bf7bbf460000,0x3e95bf0ebf7fbf35,0x3e483f6d3f550000,0xbf7bbec43f0e3f80,0x3dc9bf55bf620000,0x3f223f7b3e95bf35
.quad 0xbec43f353f6d0000,0x3ec4bf35bf6d0000,0x3f22bf0ebf750000,0xbf7fbe483f623f35,0xbf553ec43f7b0000,0x3f0e3f6dbe48bf80,0x3f75be48bf7f0000,0x3ef1bf55bf223f35
.quad 0xbf8000003f800000,0xbf8000003f800000,0x3f753e48bf7f0000,0x3ef13f55bf22bf35,0xbf55bec43f7b0000,0x3f0ebf6dbe483f80,0x3f223f0ebf750000,0xbf7f3e483f62bf35
.quad 0xbec4bf353f6d0000,0x3ec43f35bf6d0000,0x3dc93f55bf620000,0x3f22bf7b3e953f35,0x3e48bf6d3f550000,0xbf7b3ec43f0ebf80,0xbef13f7bbf460000,0x3e953f0ebf7f3f35
.quad 0x3f35bf803f350000,0x3f35bf803f350000,0xbf623f7bbf220000,0xbf753f0e3dc9bf35,0x3f7bbf6d3f0e0000,0x3e483ec4bf553f80,0xbf7f3f55bef10000,0x3f46bf7b3f75bf35
.quad 0x3f6dbf353ec40000,0xbf6d3f35bec40000,0xbf463f0ebe950000,0x3dc93e48bef13f35,0x3f0ebec43e480000,0x3f55bf6d3f7bbf80,0xbe953e48bdc90000,0xbf623f55bf463f35
.quad 0,0,0xbf22bf0ebef1bec4,0xbf7fbf7bbf75bf6d,0x3f7b3f6d3f553f35,0x3e483ec43f0e3f35,0xbf62bf7bbf7fbf6d,0x3f753f553f223ec4
.quad 0x3ec43f353f6d3f80,0xbec4bf35bf6dbf80,0x3e95be48bf22bf6d,0xbf62bf0ebdc93ec4,0xbf55bec43e483f35,0x3f0e3f6d3f7b3f35,0x3f7f3f553e95bec4,0x3f463e48bef1bf6d
.quad 0xbf35bf80bf350000,0xbf35bf80bf350000,0x3dc93f553f753ec4,0xbf223e483f623f6d,0x3f0ebec4bf7bbf35,0x3f553f6d3e48bf35,0xbf75be483f463f6d,0x3ef1bf0ebf7fbec4
.quad 0x3f6d3f35bec4bf80,0xbf6dbf353ec43f80,0xbef1bf7bbdc93f6d,0xbe953f553f46bec4,0xbe483f6d3f0ebf35,0x3f7b3ec4bf55bf35,0x3f46bf0ebf623ec4,0x3dc9bf7bbe953f6d
.quad 0xbf8000003f800000,0xbf8000003f800000,0x3f463f0ebf62bec4,0x3dc93f7bbe95bf6d,0xbe48bf6d3f0e3f35,0x3f7bbec4bf553f35,0xbef13f7bbdc9bf6d,0xbe95bf553f463ec4
.quad 0x3f6dbf35bec43f80,0xbf6d3f353ec4bf80,0xbf753e483f46bf6d,0x3ef13f0ebf7f3ec4,0x3f0e3ec4bf7b3f35,0x3f55bf6d3e483f35,0x3dc9bf553f75bec4,0xbf22be483f62bf6d
.quad 0xbf353f80bf350000,0xbf353f80bf350000,0x3f7fbf553e953ec4,0x3f46be48bef13f6d,0xbf553ec43e48bf35,0x3f0ebf6d3f7bbf35,0x3e953e48bf223f6d,0xbf623f0ebdc9bec4
.quad 0x3ec4bf353f6dbf80,0xbec43f35bf6d3f80,0xbf623f7bbf7f3f6d,0x3f75bf553f22bec4,0x3f7bbf6d3f55bf35,0x3e48bec43f0ebf35,0xbf223f0ebef13ec4,0xbf7f3f7bbf753f6d
.quad 0,0,0x3e953e483dc90000,0x3f623f553f463f35,0xbf0ebec4be480000,0xbf55bf6dbf7bbf80,0x3f463f0e3e950000,0xbdc93e483ef13f35
.quad 0xbf6dbf35bec40000,0x3f6d3f353ec40000,0x3f7f3f553ef10000,0xbf46bf7bbf75bf35,0xbf7bbf6dbf0e0000,0xbe483ec43f553f80,0x3f623f7b3f220000,0x3f753f0ebdc9bf35
.quad 0xbf35bf80bf350000,0xbf35bf80bf350000,0x3ef13f7b3f460000,0xbe953f0e3f7f3f35,0xbe48bf6dbf550000,0x3f7b3ec4bf0ebf80,0xbdc93f553f620000,0xbf22bf7bbe953f35
.quad 0x3ec4bf35bf6d0000,0xbec43f353f6d0000,0xbf223f0e3f750000,0x3f7f3e48bf62bf35,0x3f55bec4bf7b0000,0xbf0ebf6d3e483f80,0xbf753e483f7f0000,0xbef13f553f22bf35
.quad 0x3f800000bf800000,0x3f800000bf800000,0xbf75be483f7f0000,0xbef1bf553f223f35,0x3f553ec4bf7b0000,0xbf0e3f6d3e48bf80,0xbf22bf0e3f750000,0x3f7fbe48bf623f35
.quad 0x3ec43f35bf6d0000,0xbec4bf353f6d0000,0xbdc9bf553f620000,0xbf223f7bbe95bf35,0xbe483f6dbf550000,0x3f7bbec4bf0e3f80,0x3ef1bf7b3f460000,0xbe95bf0e3f7fbf35
.quad 0xbf353f80bf350000,0xbf353f80bf350000,0x3f62bf7b3f220000,0x3f75bf0ebdc93f35,0xbf7b3f6dbf0e0000,0xbe48bec43f55bf80,0x3f7fbf553ef10000,0xbf463f7bbf753f35
.quad 0xbf6d3f35bec40000,0x3f6dbf353ec40000,0x3f46bf0e3e950000,0xbdc9be483ef1bf35,0xbf0e3ec4be480000,0xbf553f6dbf7b3f80,0x3e95be483dc90000,0x3f62bf553f46bf35
.quad 0,0,0x3f223f0e3ef13ec4,0x3f7f3f7b3f753f6d,0xbf7bbf6dbf55bf35,0xbe48bec4bf0ebf35,0x3f623f7b3f7f3f6d,0xbf75bf55bf22bec4
.quad 0xbec4bf35bf6dbf80,0x3ec43f353f6d3f80,0xbe953e483f223f6d,0x3f623f0e3dc9bec4,0x3f553ec4be48bf35,0xbf0ebf6dbf7bbf35,0xbf7fbf55be953ec4,0xbf46be483ef13f6d
.quad 0x3f353f803f350000,0x3f353f803f350000,0xbdc9bf55bf75bec4,0x3f22be48bf62bf6d,0xbf0e3ec43f7b3f35,0xbf55bf6dbe483f35,0x3f753e48bf46bf6d,0xbef13f0e3f7f3ec4
.quad 0xbf6dbf353ec43f80,0x3f6d3f35bec4bf80,0x3ef13f7b3dc9bf6d,0x3e95bf55bf463ec4,0x3e48bf6dbf0e3f35,0xbf7bbec43f553f35,0xbf463f0e3f62bec4,0xbdc93f7b3e95bf6d
.quad 0x3f800000bf800000,0x3f800000bf800000,0xbf46bf0e3f623ec4,0xbdc9bf7b3e953f6d,0x3e483f6dbf0ebf35,0xbf7b3ec43f55bf35,0x3ef1bf7b3dc93f6d,0x3e953f55bf46bec4
.quad 0xbf6d3f353ec4bf80,0x3f6dbf35bec43f80,0x3f75be48bf463f6d,0xbef1bf0e3f7fbec4,0xbf0ebec43f7bbf35,0xbf553f6dbe48bf35,0xbdc93f55bf753ec4,0x3f223e48bf623f6d
.quad 0x3f35bf803f350000,0x3f35bf803f350000,0xbf7f3f55be95bec4,0xbf463e483ef1bf6d,0x3f55bec4be483f35,0xbf0e3f6dbf7b3f35,0xbe95be483f22bf6d,0x3f62bf0e3dc93ec4
.quad 0xbec43f35bf6d3f80,0x3ec4bf353f6dbf80,0x3f62bf7b3f7fbf6d,0xbf753f55bf223ec4,0xbf7b3f6dbf553f35,0xbe483ec4bf0e3f35,0x3f22bf0e3ef1bec4,0x3f7fbf7b3f75bf6d
.quad 0x3f803f803f803f80,0x3f803f803f803f80,0x3e953e483dc90000,0x3f623f553f463f35,0xbf55bf6dbf7bbf80,0x3f0e3ec43e480000,0xbf46bf0ebe950000,0x3dc9be48bef1bf35
.quad 0x3ec43f353f6d3f80,0xbec4bf35bf6dbf80,0x3f7f3f553ef10000,0xbf46bf7bbf75bf35,0x3e48bec4bf55bf80,0xbf7bbf6dbf0e0000,0xbf62bf7bbf220000,0xbf75bf0e3dc93f35
.quad 0xbf3500003f353f80,0xbf3500003f353f80,0x3ef13f7b3f460000,0xbe953f0e3f7f3f35,0x3f7b3ec4bf0ebf80,0x3e483f6d3f550000,0x3dc9bf55bf620000,0x3f223f7b3e95bf35
.quad 0xbf6dbf353ec43f80,0x3f6d3f35bec4bf80,0xbf223f0e3f750000,0x3f7f3e48bf62bf35,0x3f0e3f6dbe48bf80,0x3f55bec4bf7b0000,0x3f75be48bf7f0000,0x3ef1bf55bf223f35
.quad 0xbf8000003f80,0xbf8000003f80,0xbf75be483f7f0000,0xbef1bf553f223f35,0xbf0e3f6d3e48bf80,0xbf55bec43f7b0000,0x3f223f0ebf750000,0xbf7f3e483f62bf35
.quad 0x3f6dbf35bec43f80,0xbf6d3f353ec4bf80,0xbdc9bf553f620000,0xbf223f7bbe95bf35,0xbf7b3ec43f0ebf80,0xbe483f6dbf550000,0xbef13f7bbf460000,0x3e953f0ebf7f3f35
.quad 0x3f350000bf353f80,0x3f350000bf353f80,0x3f62bf7b3f220000,0x3f75bf0ebdc93f35,0xbe48bec43f55bf80,0x3f7bbf6d3f0e0000,0xbf7f3f55bef10000,0x3f46bf7b3f75bf35
.quad 0xbec43f35bf6d3f80,0x3ec4bf353f6dbf80,0x3f46bf0e3e950000,0xbdc9be483ef1bf35,0x3f55bf6d3f7bbf80,0xbf0e3ec4be480000,0xbe953e48bdc90000,0xbf623f55bf463f35
.quad 0x3f803f803f803f80,0x3f803f803f803f80,0x3f223f0e3ef13ec4,0x3f7f3f7b3f753f6d,0xbe48bec4bf0ebf35,0x3f7b3f6d3f553f35,0xbf62bf7bbf7fbf6d,0x3f753f553f223ec4
.quad 0xbf6dbf35bec40000,0x3f6d3f353ec40000,0xbe953e483f223f6d,0x3f623f0e3dc9bec4,0x3f0e3f6d3f7b3f35,0x3f553ec4be48bf35,0x3f7f3f553e95bec4,0x3f463e48bef1bf6d
.quad 0x3f350000bf35bf80,0x3f350000bf35bf80,0xbdc9bf55bf75bec4,0x3f22be48bf62bf6d,0xbf55bf6dbe483f35,0x3f0ebec4bf7bbf35,0xbf75be483f463f6d,0x3ef1bf0ebf7fbec4
.quad 0xbec43f353f6d0000,0x3ec4bf35bf6d0000,0x3ef13f7b3dc9bf6d,0x3e95bf55bf463ec4,0x3f7b3ec4bf55bf35,0x3e48bf6dbf0e3f35,0x3f46bf0ebf623ec4,0x3dc9bf7bbe953f6d
.quad 0xbf8000003f80,0xbf8000003f80,0xbf46bf0e3f623ec4,0xbdc9bf7b3e953f6d,0xbf7b3ec43f55bf35,0xbe48bf6d3f0e3f35,0xbef13f7bbdc9bf6d,0xbe95bf553f463ec4
.quad 0x3ec43f35bf6d0000,0xbec4bf353f6d0000,0x3f75be48bf463f6d,0xbef1bf0e3f7fbec4,0x3f55bf6d3e483f35,0xbf0ebec43f7bbf35,0x3dc9bf553f75bec4,0xbf22be483f62bf6d
.quad 0xbf3500003f35bf80,0xbf3500003f35bf80,0xbf7f3f55be95bec4,0xbf463e483ef1bf6d,0xbf0e3f6dbf7b3f35,0xbf553ec43e48bf35,0x3e953e48bf223f6d,0xbf623f0ebdc9bec4
.quad 0x3f6dbf353ec40000,0xbf6d3f35bec40000,0x3f62bf7b3f7fbf6d,0xbf753f55bf223ec4,0x3e48bec43f0ebf35,0xbf7b3f6dbf553f35,0xbf223f0ebef13ec4,0xbf7f3f7bbf753f6d
.quad 0,0,0xbf75bf7bbf7fbf80,0xbef1bf0ebf22bf35,0xbf0ebec4be480000,0xbf55bf6dbf7bbf80,0x3f223f553f753f80,0xbf7fbf7bbf62bf35
.quad 0x3f6d3f353ec40000,0xbf6dbf35bec40000,0xbdc9bf0ebf62bf80,0xbf22be483e953f35,0xbf7bbf6dbf0e0000,0xbe483ec43f553f80,0xbef13e483f463f80,0x3e953f553f7f3f35
.quad 0x3f353f803f350000,0x3f353f803f350000,0x3f623e48bf22bf80,0x3f753f553dc9bf35,0xbe48bf6dbf550000,0x3f7b3ec4bf0ebf80,0xbf7fbf0e3ef13f80,0x3f46be48bf75bf35
.quad 0xbec43f353f6d0000,0x3ec4bf35bf6d0000,0x3f463f55be95bf80,0xbdc9bf7bbef13f35,0x3f55bec4bf7b0000,0xbf0ebf6d3e483f80,0xbe95bf7b3dc93f80,0xbf62bf0e3f463f35
.quad 0xbf8000003f800000,0xbf8000003f800000,0xbe953f7b3dc9bf80,0xbf623f0e3f46bf35,0x3f553ec4bf7b0000,0xbf0e3f6d3e48bf80,0x3f46bf55be953f80,0xbdc93f7bbef1bf35
.quad 0xbec4bf353f6d0000,0x3ec43f35bf6d0000,0xbf7f3f0e3ef1bf80,0x3f463e48bf753f35,0xbe483f6dbf550000,0x3f7bbec4bf0e3f80,0x3f62be48bf223f80,0x3f75bf553dc93f35
.quad 0x3f35bf803f350000,0x3f35bf803f350000,0xbef1be483f46bf80,0x3e95bf553f7fbf35,0xbf7b3f6dbf0e0000,0xbe48bec43f55bf80,0xbdc93f0ebf623f80,0xbf223e483e95bf35
.quad 0x3f6dbf353ec40000,0xbf6d3f35bec40000,0x3f22bf553f75bf80,0xbf7f3f7bbf623f35,0xbf0e3ec4be480000,0xbf553f6dbf7b3f80,0xbf753f7bbf7f3f80,0xbef13f0ebf223f35
.quad 0,0,0xbf46bf55bf62bf6d,0xbdc9be48be95bec4,0xbf7bbf6dbf55bf35,0xbe48bec4bf0ebf35,0xbef1be483dc93ec4,0xbe95bf0ebf46bf6d
.quad 0x3ec43f353f6d3f80,0xbec4bf35bf6dbf80,0x3f753f7b3f463ec4,0xbef1bf55bf7fbf6d,0x3f553ec4be48bf35,0xbf0ebf6dbf7bbf35,0x3dc9bf0ebf75bf6d,0xbf22bf7bbf62bec4
.quad 0xbf35bf80bf350000,0xbf35bf80bf350000,0xbf7fbf0e3e953f6d,0xbf46bf7bbef13ec4,0xbf0e3ec43f7b3f35,0xbf55bf6dbe483f35,0x3e953f7b3f22bec4,0xbf62bf553dc93f6d
.quad 0x3f6d3f35bec4bf80,0xbf6dbf353ec43f80,0x3f62be48bf7fbec4,0xbf75bf0e3f223f6d,0x3e48bf6dbf0e3f35,0xbf7bbec43f553f35,0xbf22bf553ef13f6d,0xbf7fbe483f753ec4
.quad 0xbf8000003f800000,0xbf8000003f800000,0xbf223f553ef1bf6d,0xbf7f3e483f75bec4,0x3e483f6dbf0ebf35,0xbf7b3ec43f55bf35,0x3f623e48bf7f3ec4,0xbf753f0e3f22bf6d
.quad 0x3f6dbf35bec43f80,0xbf6d3f353ec4bf80,0x3e95bf7b3f223ec4,0xbf623f553dc9bf6d,0xbf0ebec43f7bbf35,0xbf553f6dbe48bf35,0xbf7f3f0e3e95bf6d,0xbf463f7bbef1bec4
.quad 0xbf353f80bf350000,0xbf353f80bf350000,0x3dc93f0ebf753f6d,0xbf223f7bbf623ec4,0x3f55bec4be483f35,0xbf0e3f6dbf7b3f35,0x3f75bf7b3f46bec4,0xbef13f55bf7f3f6d
.quad 0x3ec4bf353f6dbf80,0xbec43f35bf6d3f80,0xbef13e483dc9bec4,0xbe953f0ebf463f6d,0xbf7b3f6dbf553f35,0xbe483ec4bf0e3f35,0xbf463f55bf623f6d,0xbdc93e48be953ec4
.quad 0,0,0x3f753f7b3f7f3f80,0x3ef13f0e3f223f35,0x3f0e3ec43e480000,0x3f553f6d3f7b3f80,0xbf22bf55bf75bf80,0x3f7f3f7b3f623f35
.quad 0xbf6dbf35bec40000,0x3f6d3f353ec40000,0x3dc93f0e3f623f80,0x3f223e48be95bf35,0x3f7b3f6d3f0e0000,0x3e48bec4bf55bf80,0x3ef1be48bf46bf80,0xbe95bf55bf7fbf35
.quad 0xbf35bf80bf350000,0xbf35bf80bf350000,0xbf62be483f223f80,0xbf75bf55bdc93f35,0x3e483f6d3f550000,0xbf7bbec43f0e3f80,0x3f7f3f0ebef1bf80,0xbf463e483f753f35
.quad 0x3ec4bf35bf6d0000,0xbec43f353f6d0000,0xbf46bf553e953f80,0x3dc93f7b3ef1bf35,0xbf553ec43f7b0000,0x3f0e3f6dbe48bf80,0x3e953f7bbdc9bf80,0x3f623f0ebf46bf35
.quad 0x3f800000bf800000,0x3f800000bf800000,0x3e95bf7bbdc93f80,0x3f62bf0ebf463f35,0xbf55bec43f7b0000,0x3f0ebf6dbe483f80,0xbf463f553e95bf80,0x3dc9bf7b3ef13f35
.quad 0x3ec43f35bf6d0000,0xbec4bf353f6d0000,0x3f7fbf0ebef13f80,0xbf46be483f75bf35,0x3e48bf6d3f550000,0xbf7b3ec43f0ebf80,0xbf623e483f22bf80,0xbf753f55bdc9bf35
.quad 0xbf353f80bf350000,0xbf353f80bf350000,0x3ef13e48bf463f80,0xbe953f55bf7f3f35,0x3f7bbf6d3f0e0000,0x3e483ec4bf553f80,0x3dc9bf0e3f62bf80,0x3f22be48be953f35
.quad 0xbf6d3f35bec40000,0x3f6dbf353ec40000,0xbf223f55bf753f80,0x3f7fbf7b3f62bf35,0x3f0ebec43e480000,0x3f55bf6d3f7bbf80,0x3f75bf7b3f7fbf80,0x3ef1bf0e3f22bf35
.quad 0,0,0x3f463f553f623f6d,0x3dc93e483e953ec4,0x3f7b3f6d3f553f35,0x3e483ec43f0e3f35,0x3ef13e48bdc9bec4,0x3e953f0e3f463f6d
.quad 0xbec4bf35bf6dbf80,0x3ec43f353f6d3f80,0xbf75bf7bbf46bec4,0x3ef13f553f7f3f6d,0xbf55bec43e483f35,0x3f0e3f6d3f7b3f35,0xbdc93f0e3f753f6d,0x3f223f7b3f623ec4
.quad 0x3f353f803f350000,0x3f353f803f350000,0x3f7f3f0ebe95bf6d,0x3f463f7b3ef1bec4,0x3f0ebec4bf7bbf35,0x3f553f6d3e48bf35,0xbe95bf7bbf223ec4,0x3f623f55bdc9bf6d
.quad 0xbf6dbf353ec43f80,0x3f6d3f35bec4bf80,0xbf623e483f7f3ec4,0x3f753f0ebf22bf6d,0xbe483f6d3f0ebf35,0x3f7b3ec4bf55bf35,0x3f223f55bef1bf6d,0x3f7f3e48bf75bec4
.quad 0x3f800000bf800000,0x3f800000bf800000,0x3f22bf55bef13f6d,0x3f7fbe48bf753ec4,0xbe48bf6d3f0e3f35,0x3f7bbec4bf553f35,0xbf62be483f7fbec4,0x3f75bf0ebf223f6d
.quad 0xbf6d3f353ec4bf80,0x3f6dbf35bec43f80,0xbe953f7bbf22bec4,0x3f62bf55bdc93f6d,0x3f0e3ec4bf7b3f35,0x3f55bf6d3e483f35,0x3f7fbf0ebe953f6d,0x3f46bf7b3ef13ec4
.quad 0x3f35bf803f350000,0x3f35bf803f350000,0xbdc9bf0e3f75bf6d,0x3f22bf7b3f62bec4,0xbf553ec43e48bf35,0x3f0ebf6d3f7bbf35,0xbf753f7bbf463ec4,0x3ef1bf553f7fbf6d
.quad 0xbec43f35bf6d3f80,0x3ec4bf353f6dbf80,0x3ef1be48bdc93ec4,0x3e95bf0e3f46bf6d,0x3f7bbf6d3f55bf35,0x3e48bec43f0ebf35,0x3f46bf553f62bf6d,0x3dc9be483e95bec4
.quad 0xbf803f80bf803f80,0xbf803f80bf803f80,0xbf753f7bbf7f3f80,0xbef13f0ebf223f35,0xbf553f6dbf7b3f80,0x3f0ebec43e480000,0xbf223f55bf753f80,0x3f7fbf7b3f62bf35
.quad 0xbec43f35bf6d3f80,0x3ec4bf353f6dbf80,0xbdc93f0ebf623f80,0xbf223e483e95bf35,0x3e483ec4bf553f80,0xbf7b3f6dbf0e0000,0x3ef13e48bf463f80,0xbe953f55bf7f3f35
.quad 0x3f350000bf353f80,0x3f350000bf353f80,0x3f62be48bf223f80,0x3f75bf553dc93f35,0x3f7bbec4bf0e3f80,0x3e48bf6d3f550000,0x3f7fbf0ebef13f80,0xbf46be483f75bf35
.quad 0x3f6dbf35bec43f80,0xbf6d3f353ec4bf80,0x3f46bf55be953f80,0xbdc93f7bbef1bf35,0x3f0ebf6dbe483f80,0x3f553ec4bf7b0000,0x3e95bf7bbdc93f80,0x3f62bf0ebf463f35
.quad 0xbf8000003f80,0xbf8000003f80,0xbe95bf7b3dc93f80,0xbf62bf0e3f463f35,0xbf0ebf6d3e483f80,0xbf553ec43f7b0000,0xbf46bf553e953f80,0x3dc93f7b3ef1bf35
.quad 0xbf6dbf353ec43f80,0x3f6d3f35bec4bf80,0xbf7fbf0e3ef13f80,0x3f46be48bf75bf35,0xbf7bbec43f0e3f80,0xbe48bf6dbf550000,0xbf62be483f223f80,0xbf75bf55bdc93f35
.quad 0xbf3500003f353f80,0xbf3500003f353f80,0xbef13e483f463f80,0x3e953f553f7f3f35,0xbe483ec43f553f80,0x3f7b3f6d3f0e0000,0x3dc93f0e3f623f80,0x3f223e48be95bf35
.quad 0x3ec43f353f6d3f80,0xbec4bf35bf6dbf80,0x3f223f553f753f80,0xbf7fbf7bbf62bf35,0x3f553f6d3f7b3f80,0xbf0ebec4be480000,0x3f753f7b3f7f3f80,0x3ef13f0e3f223f35
.quad 0xbf803f80bf803f80,0xbf803f80bf803f80,0xbf463f55bf623f6d,0xbdc93e48be953ec4,0xbe483ec4bf0e3f35,0x3f7bbf6d3f55bf35,0x3ef1be48bdc93ec4,0x3e95bf0e3f46bf6d
.quad 0x3f6dbf353ec40000,0xbf6d3f35bec40000,0x3f75bf7b3f46bec4,0xbef13f55bf7f3f6d,0x3f0ebf6d3f7bbf35,0x3f55bec4be483f35,0xbdc9bf0e3f75bf6d,0x3f22bf7b3f62bec4
.quad 0xbf3500003f35bf80,0xbf3500003f35bf80,0xbf7f3f0e3e95bf6d,0xbf463f7bbef1bec4,0xbf553f6dbe48bf35,0x3f0e3ec4bf7b3f35,0xbe953f7bbf22bec4,0x3f62bf55bdc93f6d
.quad 0x3ec43f35bf6d0000,0xbec4bf353f6d0000,0x3f623e48bf7f3ec4,0xbf753f0e3f22bf6d,0x3f7bbec4bf553f35,0x3e483f6dbf0ebf35,0x3f22bf55bef13f6d,0x3f7fbe48bf753ec4
.quad 0xbf8000003f80,0xbf8000003f80,0xbf22bf553ef13f6d,0xbf7fbe483f753ec4,0xbf7bbec43f553f35,0xbe483f6d3f0ebf35,0xbf623e483f7f3ec4,0x3f753f0ebf22bf6d
.quad 0xbec43f353f6d0000,0x3ec4bf35bf6d0000,0x3e953f7b3f22bec4,0xbf62bf553dc93f6d,0x3f553f6d3e48bf35,0xbf0e3ec43f7b3f35,0x3f7f3f0ebe95bf6d,0x3f463f7b3ef1bec4
.quad 0x3f350000bf35bf80,0x3f350000bf35bf80,0x3dc9bf0ebf75bf6d,0xbf22bf7bbf62bec4,0xbf0ebf6dbf7bbf35,0xbf55bec43e483f35,0xbf75bf7bbf46bec4,0x3ef13f553f7f3f6d
.quad 0xbf6dbf35bec40000,0x3f6d3f353ec40000,0xbef1be483dc93ec4,0xbe95bf0ebf46bf6d,0x3e483ec43f0e3f35,0xbf7bbf6dbf55bf35,0x3f463f553f623f6d,0x3dc93e483e953ec4
.quad 0,0,0xbe953e48bdc90000,0xbf623f55bf463f35,0xbf0e3ec4be480000,0xbf553f6dbf7b3f80,0xbf463f0ebe950000,0x3dc93e48bef13f35
.quad 0xbf6d3f35bec40000,0x3f6dbf353ec40000,0xbf7f3f55bef10000,0x3f46bf7b3f75bf35,0xbf7b3f6dbf0e0000,0xbe48bec43f55bf80,0xbf623f7bbf220000,0xbf753f0e3dc9bf35
.quad 0xbf353f80bf350000,0xbf353f80bf350000,0xbef13f7bbf460000,0x3e953f0ebf7f3f35,0xbe483f6dbf550000,0x3f7bbec4bf0e3f80,0x3dc93f55bf620000,0x3f22bf7b3e953f35
.quad 0x3ec43f35bf6d0000,0xbec4bf353f6d0000,0x3f223f0ebf750000,0xbf7f3e483f62bf35,0x3f553ec4bf7b0000,0xbf0e3f6d3e48bf80,0x3f753e48bf7f0000,0x3ef13f55bf22bf35
.quad 0x3f800000bf800000,0x3f800000bf800000,0x3f75be48bf7f0000,0x3ef1bf55bf223f35,0x3f55bec4bf7b0000,0xbf0ebf6d3e483f80,0x3f22bf0ebf750000,0xbf7fbe483f623f35
.quad 0x3ec4bf35bf6d0000,0xbec43f353f6d0000,0x3dc9bf55bf620000,0x3f223f7b3e95bf35,0xbe48bf6dbf550000,0x3f7b3ec4bf0ebf80,0xbef1bf7bbf460000,0x3e95bf0ebf7fbf35
.quad 0xbf35bf80bf350000,0xbf35bf80bf350000,0xbf62bf7bbf220000,0xbf75bf0e3dc93f35,0xbf7bbf6dbf0e0000,0xbe483ec43f553f80,0xbf7fbf55bef10000,0x3f463f7b3f753f35
.quad 0xbf6dbf35bec40000,0x3f6d3f353ec40000,0xbf46bf0ebe950000,0x3dc9be48bef1bf35,0xbf0ebec4be480000,0xbf55bf6dbf7bbf80,0xbe95be48bdc90000,0xbf62bf55bf46bf35
.quad 0,0,0xbf223f0ebef13ec4,0xbf7f3f7bbf753f6d,0xbf7b3f6dbf553f35,0xbe483ec4bf0e3f35,0xbf623f7bbf7f3f6d,0x3f75bf553f22bec4
.quad 0xbec43f35bf6d3f80,0x3ec4bf353f6dbf80,0x3e953e48bf223f6d,0xbf623f0ebdc9bec4,0x3f55bec4be483f35,0xbf0e3f6dbf7b3f35,0x3f7fbf553e953ec4,0x3f46be48bef13f6d
.quad 0x3f35bf803f350000,0x3f35bf803f350000,0x3dc9bf553f75bec4,0xbf22be483f62bf6d,0xbf0ebec43f7bbf35,0xbf553f6dbe48bf35,0xbf753e483f46bf6d,0x3ef13f0ebf7f3ec4
.quad 0xbf6d3f353ec4bf80,0x3f6dbf35bec43f80,0xbef13f7bbdc9bf6d,0xbe95bf553f463ec4,0x3e483f6dbf0ebf35,0xbf7b3ec43f55bf35,0x3f463f0ebf62bec4,0x3dc93f7bbe95bf6d
.quad 0x3f800000bf800000,0x3f800000bf800000,0x3f46bf0ebf623ec4,0x3dc9bf7bbe953f6d,0x3e48bf6dbf0e3f35,0xbf7bbec43f553f35,0xbef1bf7bbdc93f6d,0xbe953f553f46bec4
.quad 0xbf6dbf353ec43f80,0x3f6d3f35bec4bf80,0xbf75be483f463f6d,0x3ef1bf0ebf7fbec4,0xbf0e3ec43f7b3f35,0xbf55bf6dbe483f35,0x3dc93f553f753ec4,0xbf223e483f623f6d
.quad 0x3f353f803f350000,0x3f353f803f350000,0x3f7f3f553e95bec4,0x3f463e48bef1bf6d,0x3f553ec4be48bf35,0xbf0ebf6dbf7bbf35,0x3e95be48bf22bf6d,0xbf62bf0ebdc93ec4
.quad 0xbec4bf35bf6dbf80,0x3ec43f353f6d3f80,0xbf62bf7bbf7fbf6d,0x3f753f553f223ec4,0xbf7bbf6dbf55bf35,0xbe48bec4bf0ebf35,0xbf22bf0ebef1bec4,0xbf7fbf7bbf75bf6d
.quad 0,0,0x3e95be483dc90000,0x3f62bf553f46bf35,0x3f0ebec43e480000,0x3f55bf6d3f7bbf80,0x3f46bf0e3e950000,0xbdc9be483ef1bf35
.quad 0x3f6dbf353ec40000,0xbf6d3f35bec40000,0x3f7fbf553ef10000,0xbf463f7bbf753f35,0x3f7bbf6d3f0e0000,0x3e483ec4bf553f80,0x3f62bf7b3f220000,0x3f75bf0ebdc93f35
.quad 0x3f35bf803f350000,0x3f35bf803f350000,0x3ef1bf7b3f460000,0xbe95bf0e3f7fbf35,0x3e48bf6d3f550000,0xbf7b3ec43f0ebf80,0xbdc9bf553f620000,0xbf223f7bbe95bf35
.quad 0xbec4bf353f6d0000,0x3ec43f35bf6d0000,0xbf22bf0e3f750000,0x3f7fbe48bf623f35,0xbf55bec43f7b0000,0x3f0ebf6dbe483f80,0xbf75be483f7f0000,0xbef1bf553f223f35
.quad 0xbf8000003f800000,0xbf8000003f800000,0xbf753e483f7f0000,0xbef13f553f22bf35,0xbf553ec43f7b0000,0x3f0e3f6dbe48bf80,0xbf223f0e3f750000,0x3f7f3e48bf62bf35
.quad 0xbec43f353f6d0000,0x3ec4bf35bf6d0000,0xbdc93f553f620000,0xbf22bf7bbe953f35,0x3e483f6d3f550000,0xbf7bbec43f0e3f80,0x3ef13f7b3f460000,0xbe953f0e3f7f3f35
.quad 0x3f353f803f350000,0x3f353f803f350000,0x3f623f7b3f220000,0x3f753f0ebdc9bf35,0x3f7b3f6d3f0e0000,0x3e48bec4bf55bf80,0x3f7f3f553ef10000,0xbf46bf7bbf75bf35
.quad 0x3f6d3f353ec40000,0xbf6dbf35bec40000,0x3f463f0e3e950000,0xbdc93e483ef13f35,0x3f0e3ec43e480000,0x3f553f6d3f7b3f80,0x3e953e483dc90000,0x3f623f553f463f35
.quad 0,0,0x3f22bf0e3ef1bec4,0x3f7fbf7b3f75bf6d,0x3f7bbf6d3f55bf35,0x3e48bec43f0ebf35,0x3f62bf7b3f7fbf6d,0xbf753f55bf223ec4
.quad 0x3ec4bf353f6dbf80,0xbec43f35bf6d3f80,0xbe95be483f22bf6d,0x3f62bf0e3dc93ec4,0xbf553ec43e48bf35,0x3f0ebf6d3f7bbf35,0xbf7f3f55be95bec4,0xbf463e483ef1bf6d
.quad 0xbf353f80bf350000,0xbf353f80bf350000,0xbdc93f55bf753ec4,0x3f223e48bf623f6d,0x3f0e3ec4bf7b3f35,0x3f55bf6d3e483f35,0x3f75be48bf463f6d,0xbef1bf0e3f7fbec4
.quad 0x3f6dbf35bec43f80,0xbf6d3f353ec4bf80,0x3ef1bf7b3dc93f6d,0x3e953f55bf46bec4,0xbe48bf6d3f0e3f35,0x3f7bbec4bf553f35,0xbf46bf0e3f623ec4,0xbdc9bf7b3e953f6d
.quad 0xbf8000003f800000,0xbf8000003f800000,0xbf463f0e3f62bec4,0xbdc93f7b3e95bf6d,0xbe483f6d3f0ebf35,0x3f7b3ec4bf55bf35,0x3ef13f7b3dc9bf6d,0x3e95bf55bf463ec4
.quad 0x3f6d3f35bec4bf80,0xbf6dbf353ec43f80,0x3f753e48bf46bf6d,0xbef13f0e3f7f3ec4,0x3f0ebec4bf7bbf35,0x3f553f6d3e48bf35,0xbdc9bf55bf75bec4,0x3f22be48bf62bf6d
.quad 0xbf35bf80bf350000,0xbf35bf80bf350000,0xbf7fbf55be953ec4,0xbf46be483ef13f6d,0xbf55bec43e483f35,0x3f0e3f6d3f7b3f35,0xbe953e483f223f6d,0x3f623f0e3dc9bec4
.quad 0x3ec43f353f6d3f80,0xbec4bf35bf6dbf80,0x3f623f7b3f7f3f6d,0xbf75bf55bf22bec4,0x3f7b3f6d3f553f35,0x3e483ec43f0e3f35,0x3f223f0e3ef13ec4,0x3f7f3f7b3f753f6d
.quad 0xbf803f80bf803f80,0xbf803f80bf803f80,0x3e95be483dc90000,0x3f62bf553f46bf35,0x3f55bf6d3f7bbf80,0xbf0e3ec4be480000,0xbf463f0ebe950000,0x3dc93e48bef13f35
.quad 0xbec43f35bf6d3f80,0x3ec4bf353f6dbf80,0x3f7fbf553ef10000,0xbf463f7bbf753f35,0xbe48bec43f55bf80,0x3f7bbf6d3f0e0000,0xbf623f7bbf220000,0xbf753f0e3dc9bf35
.quad 0x3f350000bf353f80,0x3f350000bf353f80,0x3ef1bf7b3f460000,0xbe95bf0e3f7fbf35,0xbf7b3ec43f0ebf80,0xbe483f6dbf550000,0x3dc93f55bf620000,0x3f22bf7b3e953f35
.quad 0x3f6dbf35bec43f80,0xbf6d3f353ec4bf80,0xbf22bf0e3f750000,0x3f7fbe48bf623f35,0xbf0e3f6d3e48bf80,0xbf55bec43f7b0000,0x3f753e48bf7f0000,0x3ef13f55bf22bf35
.quad 0xbf8000003f80,0xbf8000003f80,0xbf753e483f7f0000,0xbef13f553f22bf35,0x3f0e3f6dbe48bf80,0x3f55bec4bf7b0000,0x3f22bf0ebf750000,0xbf7fbe483f623f35
.quad 0xbf6dbf353ec43f80,0x3f6d3f35bec4bf80,0xbdc93f553f620000,0xbf22bf7bbe953f35,0x3f7b3ec4bf0ebf80,0x3e483f6d3f550000,0xbef1bf7bbf460000,0x3e95bf0ebf7fbf35
.quad 0xbf3500003f353f80,0xbf3500003f353f80,0x3f623f7b3f220000,0x3f753f0ebdc9bf35,0x3e48bec4bf55bf80,0xbf7bbf6dbf0e0000,0xbf7fbf55bef10000,0x3f463f7b3f753f35
.quad 0x3ec43f353f6d3f80,0xbec4bf35bf6dbf80,0x3f463f0e3e950000,0xbdc93e483ef13f35,0xbf55bf6dbf7bbf80,0x3f0e3ec43e480000,0xbe95be48bdc90000,0xbf62bf55bf46bf35
.quad 0xbf803f80bf803f80,0xbf803f80bf803f80,0x3f22bf0e3ef1bec4,0x3f7fbf7b3f75bf6d,0x3e48bec43f0ebf35,0xbf7b3f6dbf553f35,0xbf623f7bbf7f3f6d,0x3f75bf553f22bec4
.quad 0x3f6dbf353ec40000,0xbf6d3f35bec40000,0xbe95be483f22bf6d,0x3f62bf0e3dc93ec4,0xbf0e3f6dbf7b3f35,0xbf553ec43e48bf35,0x3f7fbf553e953ec4,0x3f46be48bef13f6d
.quad 0xbf3500003f35bf80,0xbf3500003f35bf80,0xbdc93f55bf753ec4,0x3f223e48bf623f6d,0x3f55bf6d3e483f35,0xbf0ebec43f7bbf35,0xbf753e483f46bf6d,0x3ef13f0ebf7f3ec4
.quad 0x3ec43f35bf6d0000,0xbec4bf353f6d0000,0x3ef1bf7b3dc93f6d,0x3e953f55bf46bec4,0xbf7b3ec43f55bf35,0xbe48bf6d3f0e3f35,0x3f463f0ebf62bec4,0x3dc93f7bbe95bf6d
.quad 0xbf8000003f80,0xbf8000003f80,0xbf463f0e3f62bec4,0xbdc93f7b3e95bf6d,0x3f7b3ec4bf55bf35,0x3e48bf6dbf0e3f35,0xbef1bf7bbdc93f6d,0xbe953f553f46bec4
.quad 0xbec43f353f6d0000,0x3ec4bf35bf6d0000,0x3f753e48bf46bf6d,0xbef13f0e3f7f3ec4,0xbf55bf6dbe483f35,0x3f0ebec4bf7bbf35,0x3dc93f553f753ec4,0xbf223e483f623f6d
.quad 0x3f350000bf35bf80,0x3f350000bf35bf80,0xbf7fbf55be953ec4,0xbf46be483ef13f6d,0x3f0e3f6d3f7b3f35,0x3f553ec4be48bf35,0x3e95be48bf22bf6d,0xbf62bf0ebdc93ec4
.quad 0xbf6dbf35bec40000,0x3f6d3f353ec40000,0x3f623f7b3f7f3f6d,0xbf75bf55bf22bec4,0xbe48bec4bf0ebf35,0x3f7b3f6d3f553f35,0xbf22bf0ebef1bec4,0xbf7fbf7bbf75bf6d
.quad 0,0,0xbf753f7bbf7f3f80,0xbef13f0ebf223f35,0x3f0ebec43e480000,0x3f55bf6d3f7bbf80,0x3f22bf553f75bf80,0xbf7f3f7bbf623f35
.quad 0xbf6d3f35bec40000,0x3f6dbf353ec40000,0xbdc93f0ebf623f80,0xbf223e483e95bf35,0x3f7bbf6d3f0e0000,0x3e483ec4bf553f80,0xbef1be483f46bf80,0x3e95bf553f7fbf35
.quad 0xbf353f80bf350000,0xbf353f80bf350000,0x3f62be48bf223f80,0x3f75bf553dc93f35,0x3e48bf6d3f550000,0xbf7b3ec43f0ebf80,0xbf7f3f0e3ef1bf80,0x3f463e48bf753f35
.quad 0x3ec43f35bf6d0000,0xbec4bf353f6d0000,0x3f46bf55be953f80,0xbdc93f7bbef1bf35,0xbf55bec43f7b0000,0x3f0ebf6dbe483f80,0xbe953f7b3dc9bf80,0xbf623f0e3f46bf35
.quad 0x3f800000bf800000,0x3f800000bf800000,0xbe95bf7b3dc93f80,0xbf62bf0e3f463f35,0xbf553ec43f7b0000,0x3f0e3f6dbe48bf80,0x3f463f55be95bf80,0xbdc9bf7bbef13f35
.quad 0x3ec4bf35bf6d0000,0xbec43f353f6d0000,0xbf7fbf0e3ef13f80,0x3f46be48bf75bf35,0x3e483f6d3f550000,0xbf7bbec43f0e3f80,0x3f623e48bf22bf80,0x3f753f553dc9bf35
.quad 0xbf35bf80bf350000,0xbf35bf80bf350000,0xbef13e483f463f80,0x3e953f553f7f3f35,0x3f7b3f6d3f0e0000,0x3e48bec4bf55bf80,0xbdc9bf0ebf62bf80,0xbf22be483e953f35
.quad 0xbf6dbf35bec40000,0x3f6d3f353ec40000,0x3f223f553f753f80,0xbf7fbf7bbf62bf35,0x3f0e3ec43e480000,0x3f553f6d3f7b3f80,0xbf75bf7bbf7fbf80,0xbef1bf0ebf22bf35
.quad 0,0,0xbf463f55bf623f6d,0xbdc93e48be953ec4,0x3f7bbf6d3f55bf35,0x3e48bec43f0ebf35,0xbef13e483dc9bec4,0xbe953f0ebf463f6d
.quad 0xbec43f35bf6d3f80,0x3ec4bf353f6dbf80,0x3f75bf7b3f46bec4,0xbef13f55bf7f3f6d,0xbf553ec43e48bf35,0x3f0ebf6d3f7bbf35,0x3dc93f0ebf753f6d,0xbf223f7bbf623ec4
.quad 0x3f35bf803f350000,0x3f35bf803f350000,0xbf7f3f0e3e95bf6d,0xbf463f7bbef1bec4,0x3f0e3ec4bf7b3f35,0x3f55bf6d3e483f35,0x3e95bf7b3f223ec4,0xbf623f553dc9bf6d
.quad 0xbf6d3f353ec4bf80,0x3f6dbf35bec43f80,0x3f623e48bf7f3ec4,0xbf753f0e3f22bf6d,0xbe48bf6d3f0e3f35,0x3f7bbec4bf553f35,0xbf223f553ef1bf6d,0xbf7f3e483f75bec4
.quad 0x3f800000bf800000,0x3f800000bf800000,0xbf22bf553ef13f6d,0xbf7fbe483f753ec4,0xbe483f6d3f0ebf35,0x3f7b3ec4bf55bf35,0x3f62be48bf7fbec4,0xbf75bf0e3f223f6d
.quad 0xbf6dbf353ec43f80,0x3f6d3f35bec4bf80,0x3e953f7b3f22bec4,0xbf62bf553dc93f6d,0x3f0ebec4bf7bbf35,0x3f553f6d3e48bf35,0xbf7fbf0e3e953f6d,0xbf46bf7bbef13ec4
.quad 0x3f353f803f350000,0x3f353f803f350000,0x3dc9bf0ebf75bf6d,0xbf22bf7bbf62bec4,0xbf55bec43e483f35,0x3f0e3f6d3f7b3f35,0x3f753f7b3f463ec4,0xbef1bf55bf7fbf6d
.quad 0xbec4bf35bf6dbf80,0x3ec43f353f6d3f80,0xbef1be483dc93ec4,0xbe95bf0ebf46bf6d,0x3f7b3f6d3f553f35,0x3e483ec43f0e3f35,0xbf46bf55bf62bf6d,0xbdc9be48be95bec4
.quad 0,0,0x3f75bf7b3f7fbf80,0x3ef1bf0e3f22bf35,0xbf0e3ec4be480000,0xbf553f6dbf7b3f80,0xbf223f55bf753f80,0x3f7fbf7b3f62bf35
.quad 0x3f6dbf353ec40000,0xbf6d3f35bec40000,0x3dc9bf0e3f62bf80,0x3f22be48be953f35,0xbf7b3f6dbf0e0000,0xbe48bec43f55bf80,0x3ef13e48bf463f80,0xbe953f55bf7f3f35
.quad 0x3f35bf803f350000,0x3f35bf803f350000,0xbf623e483f22bf80,0xbf753f55bdc9bf35,0xbe483f6dbf550000,0x3f7bbec4bf0e3f80,0x3f7fbf0ebef13f80,0xbf46be483f75bf35
.quad 0xbec4bf353f6d0000,0x3ec43f35bf6d0000,0xbf463f553e95bf80,0x3dc9bf7b3ef13f35,0x3f553ec4bf7b0000,0xbf0e3f6d3e48bf80,0x3e95bf7bbdc93f80,0x3f62bf0ebf463f35
.quad 0xbf8000003f800000,0xbf8000003f800000,0x3e953f7bbdc9bf80,0x3f623f0ebf46bf35,0x3f55bec4bf7b0000,0xbf0ebf6d3e483f80,0xbf46bf553e953f80,0x3dc93f7b3ef1bf35
.quad 0xbec43f353f6d0000,0x3ec4bf35bf6d0000,0x3f7f3f0ebef1bf80,0xbf463e483f753f35,0xbe48bf6dbf550000,0x3f7b3ec4bf0ebf80,0xbf62be483f223f80,0xbf75bf55bdc93f35
.quad 0x3f353f803f350000,0x3f353f803f350000,0x3ef1be48bf46bf80,0xbe95bf55bf7fbf35,0xbf7bbf6dbf0e0000,0xbe483ec43f553f80,0x3dc93f0e3f623f80,0x3f223e48be95bf35
.quad 0x3f6d3f353ec40000,0xbf6dbf35bec40000,0xbf22bf55bf75bf80,0x3f7f3f7b3f623f35,0xbf0ebec4be480000,0xbf55bf6dbf7bbf80,0x3f753f7b3f7f3f80,0x3ef13f0e3f223f35
.quad 0,0,0x3f46bf553f62bf6d,0x3dc9be483e95bec4,0xbf7b3f6dbf553f35,0xbe483ec4bf0e3f35,0x3ef1be48bdc93ec4,0x3e95bf0e3f46bf6d
.quad 0x3ec4bf353f6dbf80,0xbec43f35bf6d3f80,0xbf753f7bbf463ec4,0x3ef1bf553f7fbf6d,0x3f55bec4be483f35,0xbf0e3f6dbf7b3f35,0xbdc9bf0e3f75bf6d,0x3f22bf7b3f62bec4
.quad 0xbf353f80bf350000,0xbf353f80bf350000,0x3f7fbf0ebe953f6d,0x3f46bf7b3ef13ec4,0xbf0ebec43f7bbf35,0xbf553f6dbe48bf35,0xbe953f7bbf22bec4,0x3f62bf55bdc93f6d
.quad 0x3f6dbf35bec43f80,0xbf6d3f353ec4bf80,0xbf62be483f7fbec4,0x3f75bf0ebf223f6d,0x3e483f6dbf0ebf35,0xbf7b3ec43f55bf35,0x3f22bf55bef13f6d,0x3f7fbe48bf753ec4
.quad 0xbf8000003f800000,0xbf8000003f800000,0x3f223f55bef1bf6d,0x3f7f3e48bf75bec4,0x3e48bf6dbf0e3f35,0xbf7bbec43f553f35,0xbf623e483f7f3ec4,0x3f753f0ebf22bf6d
.quad 0x3f6d3f35bec4bf80,0xbf6dbf353ec43f80,0xbe95bf7bbf223ec4,0x3f623f55bdc9bf6d,0xbf0e3ec43f7b3f35,0xbf55bf6dbe483f35,0x3f7f3f0ebe95bf6d,0x3f463f7b3ef1bec4
.quad 0xbf35bf80bf350000,0xbf35bf80bf350000,0xbdc93f0e3f753f6d,0x3f223f7b3f623ec4,0x3f553ec4be48bf35,0xbf0ebf6dbf7bbf35,0xbf75bf7bbf46bec4,0x3ef13f553f7f3f6d
.quad 0x3ec43f353f6d3f80,0xbec4bf35bf6dbf80,0x3ef13e48bdc9bec4,0x3e953f0e3f463f6d,0xbf7bbf6dbf55bf35,0xbe48bec4bf0ebf35,0x3f463f553f623f6d,0x3dc93e483e953ec4
.quad 0xbf803f80bf803f80,0xbf803f80bf803f80,0x3f75bf7b3f7fbf80,0x3ef1bf0e3f22bf35,0xbf553f6dbf7b3f80,0x3f0ebec43e480000,0x3f22bf553f75bf80,0xbf7f3f7bbf623f35
.quad 0xbec43f35bf6d3f80,0x3ec4bf353f6dbf80,0x3dc9bf0e3f62bf80,0x3f22be48be953f35,0x3e483ec4bf553f80,0xbf7b3f6dbf0e0000,0xbef1be483f46bf80,0x3e95bf553f7fbf35
.quad 0x3f350000bf353f80,0x3f350000bf353f80,0xbf623e483f22bf80,0xbf753f55bdc9bf35,0x3f7bbec4bf0e3f80,0x3e48bf6d3f550000,0xbf7f3f0e3ef1bf80,0x3f463e48bf753f35
.quad 0x3f6dbf35bec43f80,0xbf6d3f353ec4bf80,0xbf463f553e95bf80,0x3dc9bf7b3ef13f35,0x3f0ebf6dbe483f80,0x3f553ec4bf7b0000,0xbe953f7b3dc9bf80,0xbf623f0e3f46bf35
.quad 0xbf8000003f80,0xbf8000003f80,0x3e953f7bbdc9bf80,0x3f623f0ebf46bf35,0xbf0ebf6d3e483f80,0xbf553ec43f7b0000,0x3f463f55be95bf80,0xbdc9bf7bbef13f35
.quad 0xbf6dbf353ec43f80,0x3f6d3f35bec4bf80,0x3f7f3f0ebef1bf80,0xbf463e483f753f35,0xbf7bbec43f0e3f80,0xbe48bf6dbf550000,0x3f623e48bf22bf80,0x3f753f553dc9bf35
.quad 0xbf3500003f353f80,0xbf3500003f353f80,0x3ef1be48bf46bf80,0xbe95bf55bf7fbf35,0xbe483ec43f553f80,0x3f7b3f6d3f0e0000,0xbdc9bf0ebf62bf80,0xbf22be483e953f35
.quad 0x3ec43f353f6d3f80,0xbec4bf35bf6dbf80,0xbf22bf55bf75bf80,0x3f7f3f7b3f623f35,0x3f553f6d3f7b3f80,0xbf0ebec4be480000,0xbf75bf7bbf7fbf80,0xbef1bf0ebf22bf35
.quad 0xbf803f80bf803f80,0xbf803f80bf803f80,0x3f46bf553f62bf6d,0x3dc9be483e95bec4,0xbe483ec4bf0e3f35,0x3f7bbf6d3f55bf35,0xbef13e483dc9bec4,0xbe953f0ebf463f6d
.quad 0x3f6dbf353ec40000,0xbf6d3f35bec40000,0xbf753f7bbf463ec4,0x3ef1bf553f7fbf6d,0x3f0ebf6d3f7bbf35,0x3f55bec4be483f35,0x3dc93f0ebf753f6d,0xbf223f7bbf623ec4
.quad 0xbf3500003f35bf80,0xbf3500003f35bf80,0x3f7fbf0ebe953f6d,0x3f46bf7b3ef13ec4,0xbf553f6dbe48bf35,0x3f0e3ec4bf7b3f35,0x3e95bf7b3f223ec4,0xbf623f553dc9bf6d
.quad 0x3ec43f35bf6d0000,0xbec4bf353f6d0000,0xbf62be483f7fbec4,0x3f75bf0ebf223f6d,0x3f7bbec4bf553f35,0x3e483f6dbf0ebf35,0xbf223f553ef1bf6d,0xbf7f3e483f75bec4
.quad 0xbf8000003f80,0xbf8000003f80,0x3f223f55bef1bf6d,0x3f7f3e48bf75bec4,0xbf7bbec43f553f35,0xbe483f6d3f0ebf35,0x3f62be48bf7fbec4,0xbf75bf0e3f223f6d
.quad 0xbec43f353f6d0000,0x3ec4bf35bf6d0000,0xbe95bf7bbf223ec4,0x3f623f55bdc9bf6d,0x3f553f6d3e48bf35,0xbf0e3ec43f7b3f35,0xbf7fbf0e3e953f6d,0xbf46bf7bbef13ec4
.quad 0x3f350000bf35bf80,0x3f350000bf35bf80,0xbdc93f0e3f753f6d,0x3f223f7b3f623ec4,0xbf0ebf6dbf7bbf35,0xbf55bec43e483f35,0x3f753f7b3f463ec4,0xbef1bf55bf7fbf6d
.quad 0xbf6dbf35bec40000,0x3f6d3f353ec40000,0x3ef13e48bdc9bec4,0x3e953f0e3f463f6d,0x3e483ec43f0e3f35,0xbf7bbf6dbf55bf35,0xbf46bf55bf62bf6d,0xbdc9be48be95bec4
.quad 0,0,0x3e95be483dc90000,0x3f62bf553f46bf35,0xbf0e3ec4be480000,0xbf553f6dbf7b3f80,0x3f46bf0e3e950000,0xbdc9be483ef1bf35
.quad 0xbf6d3f35bec40000,0x3f6dbf353ec40000,0x3f7fbf553ef10000,0xbf463f7bbf753f35,0xbf7b3f6dbf0e0000,0xbe48bec43f55bf80,0x3f62bf7b3f220000,0x3f75bf0ebdc93f35
.quad 0xbf353f80bf350000,0xbf353f80bf350000,0x3ef1bf7b3f460000,0xbe95bf0e3f7fbf35,0xbe483f6dbf550000,0x3f7bbec4bf0e3f80,0xbdc9bf553f620000,0xbf223f7bbe95bf35
.quad 0x3ec43f35bf6d0000,0xbec4bf353f6d0000,0xbf22bf0e3f750000,0x3f7fbe48bf623f35,0x3f553ec4bf7b0000,0xbf0e3f6d3e48bf80,0xbf75be483f7f0000,0xbef1bf553f223f35
.quad 0x3f800000bf800000,0x3f800000bf800000,0xbf753e483f7f0000,0xbef13f553f22bf35,0x3f55bec4bf7b0000,0xbf0ebf6d3e483f80,0xbf223f0e3f750000,0x3f7f3e48bf62bf35
.quad 0x3ec4bf35bf6d0000,0xbec43f353f6d0000,0xbdc93f553f620000,0xbf22bf7bbe953f35,0xbe48bf6dbf550000,0x3f7b3ec4bf0ebf80,0x3ef13f7b3f460000,0xbe953f0e3f7f3f35
.quad 0xbf35bf80bf350000,0xbf35bf80bf350000,0x3f623f7b3f220000,0x3f753f0ebdc9bf35,0xbf7bbf6dbf0e0000,0xbe483ec43f553f80,0x3f7f3f553ef10000,0xbf46bf7bbf75bf35
.quad 0xbf6dbf35bec40000,0x3f6d3f353ec40000,0x3f463f0e3e950000,0xbdc93e483ef13f35,0xbf0ebec4be480000,0xbf55bf6dbf7bbf80,0x3e953e483dc90000,0x3f623f553f463f35
.quad 0,0,0x3f22bf0e3ef1bec4,0x3f7fbf7b3f75bf6d,0xbf7b3f6dbf553f35,0xbe483ec4bf0e3f35,0x3f62bf7b3f7fbf6d,0xbf753f55bf223ec4
.quad 0xbec43f35bf6d3f80,0x3ec4bf353f6dbf80,0xbe95be483f22bf6d,0x3f62bf0e3dc93ec4,0x3f55bec4be483f35,0xbf0e3f6dbf7b3f35,0xbf7f3f55be95bec4,0xbf463e483ef1bf6d
.quad 0x3f35bf803f350000,0x3f35bf803f350000,0xbdc93f55bf753ec4,0x3f223e48bf623f6d,0xbf0ebec43f7bbf35,0xbf553f6dbe48bf35,0x3f75be48bf463f6d,0xbef1bf0e3f7fbec4
.quad 0xbf6d3f353ec4bf80,0x3f6dbf35bec43f80,0x3ef1bf7b3dc93f6d,0x3e953f55bf46bec4,0x3e483f6dbf0ebf35,0xbf7b3ec43f55bf35,0xbf46bf0e3f623ec4,0xbdc9bf7b3e953f6d
.quad 0x3f800000bf800000,0x3f800000bf800000,0xbf463f0e3f62bec4,0xbdc93f7b3e95bf6d,0x3e48bf6dbf0e3f35,0xbf7bbec43f553f35,0x3ef13f7b3dc9bf6d,0x3e95bf55bf463ec4
.quad 0xbf6dbf353ec43f80,0x3f6d3f35bec4bf80,0x3f753e48bf46bf6d,0xbef13f0e3f7f3ec4,0xbf0e3ec43f7b3f35,0xbf55bf6dbe483f35,0xbdc9bf55bf75bec4,0x3f22be48bf62bf6d
.quad 0x3f353f803f350000,0x3f353f803f350000,0xbf7fbf55be953ec4,0xbf46be483ef13f6d,0x3f553ec4be48bf35,0xbf0ebf6dbf7bbf35,0xbe953e483f223f6d,0x3f623f0e3dc9bec4
.quad 0xbec4bf35bf6dbf80,0x3ec43f353f6d3f80,0x3f623f7b3f7f3f6d,0xbf75bf55bf22bec4,0xbf7bbf6dbf55bf35,0xbe48bec4bf0ebf35,0x3f223f0e3ef13ec4,0x3f7f3f7b3f753f6d
.quad 0,0,0xbe953e48bdc90000,0xbf623f55bf463f35,0x3f0ebec43e480000,0x3f55bf6d3f7bbf80,0xbf463f0ebe950000,0x3dc93e48bef13f35
.quad 0x3f6dbf353ec40000,0xbf6d3f35bec40000,0xbf7f3f55bef10000,0x3f46bf7b3f75bf35,0x3f7bbf6d3f0e0000,0x3e483ec4bf553f80,0xbf623f7bbf220000,0xbf753f0e3dc9bf35
.quad 0x3f35bf803f350000,0x3f35bf803f350000,0xbef13f7bbf460000,0x3e953f0ebf7f3f35,0x3e48bf6d3f550000,0xbf7b3ec43f0ebf80,0x3dc93f55bf620000,0x3f22bf7b3e953f35
.quad 0xbec4bf353f6d0000,0x3ec43f35bf6d0000,0x3f223f0ebf750000,0xbf7f3e483f62bf35,0xbf55bec43f7b0000,0x3f0ebf6dbe483f80,0x3f753e48bf7f0000,0x3ef13f55bf22bf35
.quad 0xbf8000003f800000,0xbf8000003f800000,0x3f75be48bf7f0000,0x3ef1bf55bf223f35,0xbf553ec43f7b0000,0x3f0e3f6dbe48bf80,0x3f22bf0ebf750000,0xbf7fbe483f623f35
.quad 0xbec43f353f6d0000,0x3ec4bf35bf6d0000,0x3dc9bf55bf620000,0x3f223f7b3e95bf35,0x3e483f6d3f550000,0xbf7bbec43f0e3f80,0xbef1bf7bbf460000,0x3e95bf0ebf7fbf35
.quad 0x3f353f803f350000,0x3f353f803f350000,0xbf62bf7bbf220000,0xbf75bf0e3dc93f35,0x3f7b3f6d3f0e0000,0x3e48bec4bf55bf80,0xbf7fbf55bef10000,0x3f463f7b3f753f35
.quad 0x3f6d3f353ec40000,0xbf6dbf35bec40000,0xbf46bf0ebe950000,0x3dc9be48bef1bf35,0x3f0e3ec43e480000,0x3f553f6d3f7b3f80,0xbe95be48bdc90000,0xbf62bf55bf46bf35
.quad 0,0,0xbf223f0ebef13ec4,0xbf7f3f7bbf753f6d,0x3f7bbf6d3f55bf35,0x3e48bec43f0ebf35,0xbf623f7bbf7f3f6d,0x3f75bf553f22bec4
.quad 0x3ec4bf353f6dbf80,0xbec43f35bf6d3f80,0x3e953e48bf223f6d,0xbf623f0ebdc9bec4,0xbf553ec43e48bf35,0x3f0ebf6d3f7bbf35,0x3f7fbf553e953ec4,0x3f46be48bef13f6d
.quad 0xbf353f80bf350000,0xbf353f80bf350000,0x3dc9bf553f75bec4,0xbf22be483f62bf6d,0x3f0e3ec4bf7b3f35,0x3f55bf6d3e483f35,0xbf753e483f46bf6d,0x3ef13f0ebf7f3ec4
.quad 0x3f6dbf35bec43f80,0xbf6d3f353ec4bf80,0xbef13f7bbdc9bf6d,0xbe95bf553f463ec4,0xbe48bf6d3f0e3f35,0x3f7bbec4bf553f35,0x3f463f0ebf62bec4,0x3dc93f7bbe95bf6d
.quad 0xbf8000003f800000,0xbf8000003f800000,0x3f46bf0ebf623ec4,0x3dc9bf7bbe953f6d,0xbe483f6d3f0ebf35,0x3f7b3ec4bf55bf35,0xbef1bf7bbdc93f6d,0xbe953f553f46bec4
.quad 0x3f6d3f35bec4bf80,0xbf6dbf353ec43f80,0xbf75be483f463f6d,0x3ef1bf0ebf7fbec4,0x3f0ebec4bf7bbf35,0x3f553f6d3e48bf35,0x3dc93f553f753ec4,0xbf223e483f623f6d
.quad 0xbf35bf80bf350000,0xbf35bf80bf350000,0x3f7f3f553e95bec4,0x3f463e48bef1bf6d,0xbf55bec43e483f35,0x3f0e3f6d3f7b3f35,0x3e95be48bf22bf6d,0xbf62bf0ebdc93ec4
.quad 0x3ec43f353f6d3f80,0xbec4bf35bf6dbf80,0xbf62bf7bbf7fbf6d,0x3f753f553f223ec4,0x3f7b3f6d3f553f35,0x3e483ec43f0e3f35,0xbf22bf0ebef1bec4,0xbf7fbf7bbf75bf6d
.quad 0xbf803f80bf803f80,0xbf803f80bf803f80,0xbe953e48bdc90000,0xbf623f55bf463f35,0x3f55bf6d3f7bbf80,0xbf0e3ec4be480000,0x3f46bf0e3e950000,0xbdc9be483ef1bf35
.quad 0xbec43f35bf6d3f80,0x3ec4bf353f6dbf80,0xbf7f3f55bef10000,0x3f46bf7b3f75bf35,0xbe48bec43f55bf80,0x3f7bbf6d3f0e0000,0x3f62bf7b3f220000,0x3f75bf0ebdc93f35
.quad 0x3f350000bf353f80,0x3f350000bf353f80,0xbef13f7bbf460000,0x3e953f0ebf7f3f35,0xbf7b3ec43f0ebf80,0xbe483f6dbf550000,0xbdc9bf553f620000,0xbf223f7bbe95bf35
.quad 0x3f6dbf35bec43f80,0xbf6d3f353ec4bf80,0x3f223f0ebf750000,0xbf7f3e483f62bf35,0xbf0e3f6d3e48bf80,0xbf55bec43f7b0000,0xbf75be483f7f0000,0xbef1bf553f223f35
.quad 0xbf8000003f80,0xbf8000003f80,0x3f75be48bf7f0000,0x3ef1bf55bf223f35,0x3f0e3f6dbe48bf80,0x3f55bec4bf7b0000,0xbf223f0e3f750000,0x3f7f3e48bf62bf35
.quad 0xbf6dbf353ec43f80,0x3f6d3f35bec4bf80,0x3dc9bf55bf620000,0x3f223f7b3e95bf35,0x3f7b3ec4bf0ebf80,0x3e483f6d3f550000,0x3ef13f7b3f460000,0xbe953f0e3f7f3f35
.quad 0xbf3500003f353f80,0xbf3500003f353f80,0xbf62bf7bbf220000,0xbf75bf0e3dc93f35,0x3e48bec4bf55bf80,0xbf7bbf6dbf0e0000,0x3f7f3f553ef10000,0xbf46bf7bbf75bf35
.quad 0x3ec43f353f6d3f80,0xbec4bf35bf6dbf80,0xbf46bf0ebe950000,0x3dc9be48bef1bf35,0xbf55bf6dbf7bbf80,0x3f0e3ec43e480000,0x3e953e483dc90000,0x3f623f553f463f35
.quad 0xbf803f80bf803f80,0xbf803f80bf803f80,0xbf223f0ebef13ec4,0xbf7f3f7bbf753f6d,0x3e48bec43f0ebf35,0xbf7b3f6dbf553f35,0x3f62bf7b3f7fbf6d,0xbf753f55bf223ec4
.quad 0x3f6dbf353ec40000,0xbf6d3f35bec40000,0x3e953e48bf223f6d,0xbf623f0ebdc9bec4,0xbf0e3f6dbf7b3f35,0xbf553ec43e48bf35,0xbf7f3f55be95bec4,0xbf463e483ef1bf6d
.quad 0xbf3500003f35bf80,0xbf3500003f35bf80,0x3dc9bf553f75bec4,0xbf22be483f62bf6d,0x3f55bf6d3e483f35,0xbf0ebec43f7bbf35,0x3f75be48bf463f6d,0xbef1bf0e3f7fbec4
.quad 0x3ec43f35bf6d0000,0xbec4bf353f6d0000,0xbef13f7bbdc9bf6d,0xbe95bf553f463ec4,0xbf7b3ec43f55bf35,0xbe48bf6d3f0e3f35,0xbf46bf0e3f623ec4,0xbdc9bf7b3e953f6d
.quad 0xbf8000003f80,0xbf8000003f80,0x3f46bf0ebf623ec4,0x3dc9bf7bbe953f6d,0x3f7b3ec4bf55bf35,0x3e48bf6dbf0e3f35,0x3ef13f7b3dc9bf6d,0x3e95bf55bf463ec4
.quad 0xbec43f353f6d0000,0x3ec4bf35bf6d0000,0xbf75be483f463f6d,0x3ef1bf0ebf7fbec4,0xbf55bf6dbe483f35,0x3f0ebec4bf7bbf35,0xbdc9bf55bf75bec4,0x3f22be48bf62bf6d
.quad 0x3f350000bf35bf80,0x3f350000bf35bf80,0x3f7f3f553e95bec4,0x3f463e48bef1bf6d,0x3f0e3f6d3f7b3f35,0x3f553ec4be48bf35,0xbe953e483f223f6d,0x3f623f0e3dc9bec4
.quad 0xbf6dbf35bec40000,0x3f6d3f353ec40000,0xbf62bf7bbf7fbf6d,0x3f753f553f223ec4,0xbe48bec4bf0ebf35,0x3f7b3f6d3f553f35,0x3f223f0e3ef13ec4,0x3f7f3f7b3f753f6d
.quad 0,0,0x3f75bf7b3f7fbf80,0x3ef1bf0e3f22bf35,0x3f0ebec43e480000,0x3f55bf6d3f7bbf80,0xbf223f55bf753f80,0x3f7fbf7b3f62bf35
.quad 0xbf6d3f35bec40000,0x3f6dbf353ec40000,0x3dc9bf0e3f62bf80,0x3f22be48be953f35,0x3f7bbf6d3f0e0000,0x3e483ec4bf553f80,0x3ef13e48bf463f80,0xbe953f55bf7f3f35
.quad 0xbf353f80bf350000,0xbf353f80bf350000,0xbf623e483f22bf80,0xbf753f55bdc9bf35,0x3e48bf6d3f550000,0xbf7b3ec43f0ebf80,0x3f7fbf0ebef13f80,0xbf46be483f75bf35
.quad 0x3ec43f35bf6d0000,0xbec4bf353f6d0000,0xbf463f553e95bf80,0x3dc9bf7b3ef13f35,0xbf55bec43f7b0000,0x3f0ebf6dbe483f80,0x3e95bf7bbdc93f80,0x3f62bf0ebf463f35
.quad 0x3f800000bf800000,0x3f800000bf800000,0x3e953f7bbdc9bf80,0x3f623f0ebf46bf35,0xbf553ec43f7b0000,0x3f0e3f6dbe48bf80,0xbf46bf553e953f80,0x3dc93f7b3ef1bf35
.quad 0x3ec4bf35bf6d0000,0xbec43f353f6d0000,0x3f7f3f0ebef1bf80,0xbf463e483f753f35,0x3e483f6d3f550000,0xbf7bbec43f0e3f80,0xbf62be483f223f80,0xbf75bf55bdc93f35
.quad 0xbf35bf80bf350000,0xbf35bf80bf350000,0x3ef1be48bf46bf80,0xbe95bf55bf7fbf35,0x3f7b3f6d3f0e0000,0x3e48bec4bf55bf80,0x3dc93f0e3f623f80,0x3f223e48be95bf35
.quad 0xbf6dbf35bec40000,0x3f6d3f353ec40000,0xbf22bf55bf75bf80,0x3f7f3f7b3f623f35,0x3f0e3ec43e480000,0x3f553f6d3f7b3f80,0x3f753f7b3f7f3f80,0x3ef13f0e3f223f35
.quad 0,0,0x3f46bf553f62bf6d,0x3dc9be483e95bec4,0x3f7bbf6d3f55bf35,0x3e48bec43f0ebf35,0x3ef1be48bdc93ec4,0x3e95bf0e3f46bf6d
.quad 0xbec43f35bf6d3f80,0x3ec4bf353f6dbf80,0xbf753f7bbf463ec4,0x3ef1bf553f7fbf6d,0xbf553ec43e48bf35,0x3f0ebf6d3f7bbf35,0xbdc9bf0e3f75bf6d,0x3f22bf7b3f62bec4
.quad 0x3f35bf803f350000,0x3f35bf803f350000,0x3f7fbf0ebe953f6d,0x3f46bf7b3ef13ec4,0x3f0e3ec4bf7b3f35,0x3f55bf6d3e483f35,0xbe953f7bbf22bec4,0x3f62bf55bdc93f6d
.quad 0xbf6d3f353ec4bf80,0x3f6dbf35bec43f80,0xbf62be483f7fbec4,0x3f75bf0ebf223f6d,0xbe48bf6d3f0e3f35,0x3f7bbec4bf553f35,0x3f22bf55bef13f6d,0x3f7fbe48bf753ec4
.quad 0x3f800000bf800000,0x3f800000bf800000,0x3f223f55bef1bf6d,0x3f7f3e48bf75bec4,0xbe483f6d3f0ebf35,0x3f7b3ec4bf55bf35,0xbf623e483f7f3ec4,0x3f753f0ebf22bf6d
.quad 0xbf6dbf353ec43f80,0x3f6d3f35bec4bf80,0xbe95bf7bbf223ec4,0x3f623f55bdc9bf6d,0x3f0ebec4bf7bbf35,0x3f553f6d3e48bf35,0x3f7f3f0ebe95bf6d,0x3f463f7b3ef1bec4
.quad 0x3f353f803f350000,0x3f353f803f350000,0xbdc93f0e3f753f6d,0x3f223f7b3f623ec4,0xbf55bec43e483f35,0x3f0e3f6d3f7b3f35,0xbf75bf7bbf46bec4,0x3ef13f553f7f3f6d
.quad 0xbec4bf35bf6dbf80,0x3ec43f353f6d3f80,0x3ef13e48bdc9bec4,0x3e953f0e3f463f6d,0x3f7b3f6d3f553f35,0x3e483ec43f0e3f35,0x3f463f553f623f6d,0x3dc93e483e953ec4
.quad 0,0,0xbf753f7bbf7f3f80,0xbef13f0ebf223f35,0xbf0e3ec4be480000,0xbf553f6dbf7b3f80,0x3f22bf553f75bf80,0xbf7f3f7bbf623f35
.quad 0x3f6dbf353ec40000,0xbf6d3f35bec40000,0xbdc93f0ebf623f80,0xbf223e483e95bf35,0xbf7b3f6dbf0e0000,0xbe48bec43f55bf80,0xbef1be483f46bf80,0x3e95bf553f7fbf35
.quad 0x3f35bf803f350000,0x3f35bf803f350000,0x3f62be48bf223f80,0x3f75bf553dc93f35,0xbe483f6dbf550000,0x3f7bbec4bf0e3f80,0xbf7f3f0e3ef1bf80,0x3f463e48bf753f35
.quad 0xbec4bf353f6d0000,0x3ec43f35bf6d0000,0x3f46bf55be953f80,0xbdc93f7bbef1bf35,0x3f553ec4bf7b0000,0xbf0e3f6d3e48bf80,0xbe953f7b3dc9bf80,0xbf623f0e3f46bf35
.quad 0xbf8000003f800000,0xbf8000003f800000,0xbe95bf7b3dc93f80,0xbf62bf0e3f463f35,0x3f55bec4bf7b0000,0xbf0ebf6d3e483f80,0x3f463f55be95bf80,0xbdc9bf7bbef13f35
.quad 0xbec43f353f6d0000,0x3ec4bf35bf6d0000,0xbf7fbf0e3ef13f80,0x3f46be48bf75bf35,0xbe48bf6dbf550000,0x3f7b3ec4bf0ebf80,0x3f623e48bf22bf80,0x3f753f553dc9bf35
.quad 0x3f353f803f350000,0x3f353f803f350000,0xbef13e483f463f80,0x3e953f553f7f3f35,0xbf7bbf6dbf0e0000,0xbe483ec43f553f80,0xbdc9bf0ebf62bf80,0xbf22be483e953f35
.quad 0x3f6d3f353ec40000,0xbf6dbf35bec40000,0x3f223f553f753f80,0xbf7fbf7bbf62bf35,0xbf0ebec4be480000,0xbf55bf6dbf7bbf80,0xbf75bf7bbf7fbf80,0xbef1bf0ebf22bf35
.quad 0,0,0xbf463f55bf623f6d,0xbdc93e48be953ec4,0xbf7b3f6dbf553f35,0xbe483ec4bf0e3f35,0xbef13e483dc9bec4,0xbe953f0ebf463f6d
.quad 0x3ec4bf353f6dbf80,0xbec43f35bf6d3f80,0x3f75bf7b3f46bec4,0xbef13f55bf7f3f6d,0x3f55bec4be483f35,0xbf0e3f6dbf7b3f35,0x3dc93f0ebf753f6d,0xbf223f7bbf623ec4
.quad 0xbf353f80bf350000,0xbf353f80bf350000,0xbf7f3f0e3e95bf6d,0xbf463f7bbef1bec4,0xbf0ebec43f7bbf35,0xbf553f6dbe48bf35,0x3e95bf7b3f223ec4,0xbf623f553dc9bf6d
.quad 0x3f6dbf35bec43f80,0xbf6d3f353ec4bf80,0x3f623e48bf7f3ec4,0xbf753f0e3f22bf6d,0x3e483f6dbf0ebf35,0xbf7b3ec43f55bf35,0xbf223f553ef1bf6d,0xbf7f3e483f75bec4
.quad 0xbf8000003f800000,0xbf8000003f800000,0xbf22bf553ef13f6d,0xbf7fbe483f753ec4,0x3e48bf6dbf0e3f35,0xbf7bbec43f553f35,0x3f62be48bf7fbec4,0xbf75bf0e3f223f6d
.quad 0x3f6d3f35bec4bf80,0xbf6dbf353ec43f80,0x3e953f7b3f22bec4,0xbf62bf553dc93f6d,0xbf0e3ec43f7b3f35,0xbf55bf6dbe483f35,0xbf7fbf0e3e953f6d,0xbf46bf7bbef13ec4
.quad 0xbf35bf80bf350000,0xbf35bf80bf350000,0x3dc9bf0ebf75bf6d,0xbf22bf7bbf62bec4,0x3f553ec4be48bf35,0xbf0ebf6dbf7bbf35,0x3f753f7b3f463ec4,0xbef1bf55bf7fbf6d
.quad 0x3ec43f353f6d3f80,0xbec4bf35bf6dbf80,0xbef1be483dc93ec4,0xbe95bf0ebf46bf6d,0xbf7bbf6dbf55bf35,0xbe48bec4bf0ebf35,0xbf46bf55bf62bf6d,0xbdc9be48be95bec4
.quad 0x3f8000003f800000,0x3f8000003f800000,0x3f7fffb13f800000,0x3f7ffd393f7ffec4,0x3f7ffec43f800000,0x3f7ff4e63f7ffb11,0x3f7ffd393f800000,0x3f7fe7053f7ff4e6
.quad 0x3f7ffb113f800000,0x3f7fd3973f7fec43,0x3f7ff84a3f800000,0x3f7fba9e3f7fe129,0x3f7ff4e63f800000,0x3f7f9c183f7fd397,0x3f7ff0e33f800000,0x3f7f78083f7fc38f
.quad 0x3f7fec433f800000,0x3f7f4e6d3f7fb10f,0x3f7fe7053f800000,0x3f7f1f493f7f9c18,0x3f7fe1293f800000,0x3f7eea9d3f7f84ab,0x3f7fdaaf3f800000,0x3f7eb0693f7f6ac7
.quad 0x3f7fd3973f800000,0x3f7e70b03f7f4e6d,0x3f7fcbe23f800000,0x3f7e2b723f7f2f9d,0x3f7fc38f3f800000,0x3f7de0b13f7f0e58,0x3f7fba9e3f800000,0x3f7d906e3f7eea9d
.quad 0x3f7fb10f3f800000,0x3f7d3aac3f7ec46d,0x3f7fa6e33f800000,0x3f7cdf6c3f7e9bc9,0x3f7f9c183f800000,0x3f7c7eb03f7e70b0,0x3f7f90b13f800000,0x3f7c187a3f7e4323
.quad 0x3f7f84ab3f800000,0x3f7baccd3f7e1324,0x3f7f78083f800000,0x3f7b3bab3f7de0b1,0x3f7f6ac73f800000,0x3f7ac5163f7dabcc,0x3f7f5ce93f800000,0x3f7a49103f7d7474
.quad 0x3f7f4e6d3f800000,0x3f79c79d3f7d3aac,0x3f7f3f543f800000,0x3f7940c03f7cfe73,0x3f7f2f9d3f800000,0x3f78b47b3f7cbfc9,0x3f7f1f493f800000,0x3f7822d13f7c7eb0
.quad 0x3f7f0e583f800000,0x3f778bc53f7c3b28,0x3f7efcc93f800000,0x3f76ef5b3f7bf531,0x3f7eea9d3f800000,0x3f764d973f7baccd,0x3f7ed7d43f800000,0x3f75a67b3f7b61fc
.quad 0x3f8000003f800000,0x3f8000003f800000,0x3f7ff84a3f7ffb11,0x3f7ff0e33f7ff4e6,0x3f7fe1293f7fec43,0x3f7fc38f3f7fd397,0x3f7fba9e3f7fd397,0x3f7f78083f7f9c18
.quad 0x3f7f84ab3f7fb10f,0x3f7f0e583f7f4e6d,0x3f7f3f543f7f84ab,0x3f7e868b3f7eea9d,0x3f7eea9d3f7f4e6d,0x3f7de0b13f7e70b0,0x3f7e868b3f7f0e58,0x3f7d1cdd3f7de0b1
.quad 0x3f7e13243f7ec46d,0x3f7c3b283f7d3aac,0x3f7d906e3f7e70b0,0x3f7b3bab3f7c7eb0,0x3f7cfe733f7e1324,0x3f7a1e843f7baccd,0x3f7c5d3a3f7dabcc,0x3f78e3d63f7ac516
.quad 0x3f7baccd3f7d3aac,0x3f778bc53f79c79d,0x3f7aed373f7cbfc9,0x3f76167a3f78b47b,0x3f7a1e843f7c3b28,0x3f7484223f778bc5,0x3f7940c03f7baccd,0x3f72d4eb3f764d97
.quad 0x3f7853f83f7b14be,0x3f7109083f74fa0b,0x3f77583a3f7a7302,0x3f6f20b03f73913f,0x3f764d973f79c79d,0x3f6d1c1d3f721352,0x3f75341d3f791298,0x3f6afb8c3f708066
.quad 0x3f740bdd3f7853f8,0x3f68bf3c3f6ed89e,0x3f72d4eb3f778bc5,0x3f6667713f6d1c1d,0x3f718f573f76ba07,0x3f63f4733f6b4b0c,0x3f703b373f75dec6,0x3f61668a3f696591
.quad 0x3f6ed89e3f74fa0b,0x3f5ebe053f676bd8,0x3f6d67a13f740bdd,0x3f5bfb343f655e0b,0x3f6be8583f731447,0x3f591e6a3f633c5a,0x3f6a5ad93f721352,0x3f5627fe3f6106f2
.quad 0x3f68bf3c3f710908,0x3f5318493f5ebe05,0x3f6715993f6ff573,0x3f4fefa83f5c61c7,0x3f655e0b3f6ed89e,0x3f4cae793f59f26a,0x3f6398ac3f6db293,0x3f4955213f577026
.quad 0,0,0x3b490fc600000000,0x3c16cb583bc90f88,0x3bc90f8800000000,0x3c96c9b63c490e90,0x3c16cb5800000000,0x3ce22a7a3c96c9b6
.quad 0x3c490e9000000000,0x3d16c32c3cc90ab0,0x3c7b514b00000000,0x3d3c6dd53cfb49ba,0x3c96c9b600000000,0x3d6214693d16c32c,0x3cafea6900000000,0x3d83db0a3d2fe007
.quad 0x3cc90ab000000000,0x3d96a9053d48fb30,0x3ce22a7a00000000,0x3da973ba3d621469,0x3cfb49ba00000000,0x3dbc3ac33d7b2b74,0x3d0a342f00000000,0x3dcefdb73d8a200a
.quad 0x3d16c32c00000000,0x3de1bc2e3d96a905,0x3d2351cb00000000,0x3df475c03da3308c,0x3d2fe00700000000,0x3e0395023dafb680,0x3d3c6dd500000000,0x3e0cec4a3dbc3ac3
.quad 0x3d48fb3000000000,0x3e1640833dc8bd36,0x3d55880e00000000,0x3e1f917b3dd53db9,0x3d62146900000000,0x3e28defc3de1bc2e,0x3d6ea03800000000,0x3e3228d43dee3876
.quad 0x3d7b2b7400000000,0x3e3b6ecf3dfab273,0x3d83db0a00000000,0x3e44b0b93e039502,0x3d8a200a00000000,0x3e4dee603e09cf86,0x3d9064b400000000,0x3e57278f3e1008b7
.quad 0x3d96a90500000000,0x3e605c133e164083,0x3d9cecf900000000,0x3e698bba3e1c76de,0x3da3308c00000000,0x3e72b6513e22abb6,0x3da973ba00000000,0x3e7bdba43e28defc
.quad 0x3dafb68000000000,0x3e827dc03e2f10a2,0x3db5f8da00000000,0x3e870ada3e354098,0x3dbc3ac300000000,0x3e8b95073e3b6ecf,0x3dc27c3900000000,0x3e901c2c3e419b37
.quad 0,0,0x3c7b514b3c490e90,0x3cafea693c96c9b6,0x3cfb49ba3cc90ab0,0x3d2fe0073d16c32c,0x3d3c6dd53d16c32c,0x3d83db0a3d621469
.quad 0x3d7b2b743d48fb30,0x3dafb6803d96a905,0x3d9cecf93d7b2b74,0x3ddb7d373dbc3ac3,0x3dbc3ac33d96a905,0x3e0395023de1bc2e,0x3ddb7d373dafb680,0x3e195be03e039502
.quad 0x3dfab2733dc8bd36,0x3e2f10a23e164083,0x3e0cec4a3de1bc2e,0x3e44b0b93e28defc,0x3e1c76de3dfab273,0x3e5a39973e3b6ecf,0x3e2bf8043e09cf86,0x3e6fa8b23e4dee60
.quad 0x3e3b6ecf3e164083,0x3e827dc03e605c13,0x3e4ada4f3e22abb6,0x3e8d17c03e72b651,0x3e5a39973e2f10a2,0x3e97a1173e827dc0,0x3e698bba3e3b6ecf,0x3ea218873e8b9507
.quad 0x3e78cfcc3e47c5c2,0x3eac7cd43e94a031,0x3e8402703e541501,0x3eb6ccc33e9d9e78,0x3e8b95073e605c13,0x3ec1071e3ea68f12,0x3e931f353e6c9a7f,0x3ecb2aae3eaf713a
.quad 0x3e9aa0863e78cfcc,0x3ed536413eb8442a,0x3ea218873e827dc0,0x3edf28a93ec1071e,0x3ea986c43e888e93,0x3ee900b73ec9b953,0x3eb0eacb3e8e9a22,0x3ef2bd433ed25a09
.quad 0x3eb8442a3e94a031,0x3efc5d273edae880,0x3ebf926f3e9aa086,0x3f02ef9f3ee363fa,0x3ec6d5293ea09ae5,0x3f07a1363eebcbbb,0x3ece0bea3ea68f12,0x3f0c42c93ef41f07
.quad 0x3ed536413eac7cd4,0x3f10d3cd3efc5d27,0x3edc53c13eb263ef,0x3f1553b73f0242b1,0x3ee363fa3eb8442a,0x3f19c2003f064b82,0x3eea66813ebe1d4a,0x3f1e1e223f0a48ad
.quad 0x3f8000003f800000,0x3f8000003f800000,0x3f7fe7053f7fec43,0x3f7fdaaf3f7fe129,0x3f7f9c183f7fb10f,0x3f7f6ac73f7f84ab,0x3f7f1f493f7f4e6d,0x3f7eb0693f7eea9d
.quad 0x3f7e70b03f7ec46d,0x3f7dabcc3f7e1324,0x3f7d906e3f7e1324,0x3f7c5d3a3f7cfe73,0x3f7c7eb03f7d3aac,0x3f7ac5163f7baccd,0x3f7b3bab3f7c3b28,0x3f78e3d63f7a1e84
.quad 0x3f79c79d3f7b14be,0x3f76ba073f7853f8,0x3f7822d13f79c79d,0x3f74484b3f764d97,0x3f764d973f7853f8,0x3f718f573f740bdd,0x3f74484b3f76ba07,0x3f6e8ff83f718f57
.quad 0x3f7213523f74fa0b,0x3f6b4b0c3f6ed89e,0x3f6faf1b3f731447,0x3f67c1873f6be858,0x3f6d1c1d3f710908,0x3f63f4733f68bf3c,0x3f6a5ad93f6ed89e,0x3f5fe4e93f655e0b
.quad 0x3f676bd83f6c835e,0x3f5b941a3f61c598,0x3f644fac3f6a09a7,0x3f5703483f5df6be,0x3f6106f23f676bd8,0x3f5233c63f59f26a,0x3f5d924d3f64aa59,0x3f4d26fd3f55b993
.quad 0x3f59f26a3f61c598,0x3f47de653f514d3d,0x3f5627fe3f5ebe05,0x3f425b893f4cae79,0x3f5233c63f5b941a,0x3f3ca0033f47de65,0x3f4e16893f584853,0x3f36ad7f3f42de29
.quad 0x3f49d1123f54db31,0x3f3085bb3f3daef9,0x3f4564393f514d3d,0x3f2a2a803f385216,0x3f40d0da3f4d9f02,0x3f239da93f32c8c9,0x3f3c17d93f49d112,0x3f1ce11f3f2d1469
.quad 0x3f373a233f45e403,0x3f15f6d93f273656,0x3f3238aa3f41d870,0x3f0ee0db3f212ff9,0x3f2d14693f3daef9,0x3f07a1363f1b02c6,0x3f27ce613f396842,0x3f003a063f14b039
.quad 0x3f8000003f800000,0x3f8000003f800000,0x3f7fcbe23f7fd397,0x3f7fba9e3f7fc38f,0x3f7f2f9d3f7f4e6d,0x3f7eea9d3f7f0e58,0x3f7e2b723f7e70b0,0x3f7d906e3f7de0b1
.quad 0x3f7cbfc93f7d3aac,0x3f7baccd3f7c3b28,0x3f7aed373f7baccd,0x3f7940c03f7a1e84,0x3f78b47b3f79c79d,0x3f764d973f778bc5,0x3f76167a3f778bc5,0x3f72d4eb3f748422
.quad 0x3f7314473f74fa0b,0x3f6ed89e3f710908,0x3f6faf1b3f721352,0x3f6a5ad93f6d1c1d,0x3f6be8583f6ed89e,0x3f655e0b3f68bf3c,0x3f67c1873f6b4b0c,0x3f5fe4e93f63f473
.quad 0x3f633c5a3f676bd8,0x3f59f26a3f5ebe05,0x3f5e5aa63f633c5a,0x3f5389c73f591e6a,0x3f591e6a3f5ebe05,0x3f4cae793f531849,0x3f5389c73f59f26a,0x3f4564393f4cae79
.quad 0x3f4d9f023f54db31,0x3f3daef93f45e403,0x3f4760853f4f7a1f,0x3f3592e73f3ebc1b,0x3f40d0da3f49d112,0x3f2d14693f373a23,0x3f39f2ac3f43e200,0x3f24381a3f2f61a5
.quad 0x3f32c8c93f3daef9,0x3f1b02c63f273656,0x3f2b561b3f373a23,0x3f11796b3f1ebc12,0x3f239da93f3085bb,0x3f07a1363f15f6d9,0x3f1ba2993f299415,0x3efafef73f0cead0
.quad 0x3f13682a3f226799,0x3ee633753f039c3d,0x3f0af1b73f1b02c6,0x3ed0eb2a3ef41f07,0x3f0242b13f13682a,0x3ebb31a03ee0924f,0x3ef2bd433f0b9a6b,0x3ea5129f3ecc9b8b
.quad 0x3ee0924f3f039c3d,0x3e8e9a223eb8442a,0x3ece0bea3ef6e0cb,0x3e6fa8b23ea395c5,0x3ebb31a03ee63375,0x3e419b373e8e9a22,0x3ea80b1f3ed53641,0x3e1324ca3e72b651
.quad 0,0,0x3ce22a7a3cc90ab0,0x3d0a342f3cfb49ba,0x3d6214693d48fb30,0x3d8a200a3d7b2b74,0x3da973ba3d96a905,0x3dcefdb73dbc3ac3
.quad 0x3de1bc2e3dc8bd36,0x3e09cf863dfab273,0x3e0cec4a3dfab273,0x3e2bf8043e1c76de,0x3e28defc3e164083,0x3e4dee603e3b6ecf,0x3e44b0b93e2f10a2,0x3e6fa8b23e5a3997
.quad 0x3e605c133e47c5c2,0x3e888e933e78cfcc,0x3e7bdba43e605c13,0x3e9920fe3e8b9507,0x3e8b95073e78cfcc,0x3ea986c43e9aa086,0x3e9920fe3e888e93,0x3eb9bb1e3ea986c4
.quad 0x3ea68f123e94a031,0x3ec9b9533eb8442a,0x3eb3dca53ea09ae5,0x3ed97cb93ec6d529,0x3ec1071e3eac7cd4,0x3ee900b73ed53641,0x3ece0bea3eb8442a,0x3ef840c83ee363fa
.quad 0x3edae8803ec3ef15,0x3f039c3d3ef15aea,0x3ee79a5d3ecf7bca,0x3f0af1b73eff17b2,0x3ef41f073edae880,0x3f121eb03f064b82,0x3f003a063ee63375,0x3f19210f3f0cead0
.quad 0x3f064b823ef15aea,0x3f1ff6cb3f13682a,0x3f0c42c93efc5d27,0x3f269de33f19c200,0x3f121eb03f039c3d,0x3f2d14693f1ff6cb,0x3f17de123f08f59b,0x3f33587a3f26050a
.quad 0x3f1d7fd13f0e39da,0x3f3968423f2beb4a,0x3f2302d33f13682a,0x3f3f41fc3f31a81d,0x3f2866053f187fc0,0x3f44e3f53f373a23,0x3f2da8593f1d7fd1,0x3f4a4c873f3ca003
.quad 0x3f32c8c93f226799,0x3f4f7a1f3f41d870,0x3f37c6553f273656,0x3f546b3b3f46e22a,0x3f3ca0033f2beb4a,0x3f591e6a3f4bbbf8,0x3f4154e13f3085bb,0x3f5d924d3f5064af
.quad 0,0,0x3d2351cb3d16c32c,0x3d3c6dd53d2fe007,0x3da3308c3d96a905,0x3dbc3ac33dafb680,0x3df475c03de1bc2e,0x3e0cec4a3e039502
.quad 0x3e22abb63e164083,0x3e3b6ecf3e2f10a2,0x3e4ada4f3e3b6ecf,0x3e698bba3e5a3997,0x3e72b6513e605c13,0x3e8b95073e827dc0,0x3e8d17c03e827dc0,0x3ea218873e97a117
.quad 0x3ea09ae53e94a031,0x3eb8442a3eac7cd4,0x3eb3dca53ea68f12,0x3ece0bea3ec1071e,0x3ec6d5293eb8442a,0x3ee363fa3ed53641,0x3ed97cb93ec9b953,0x3ef840c83ee900b7
.quad 0x3eebcbbb3edae880,0x3f064b823efc5d27,0x3efdbabb3eebcbbb,0x3f102dd53f07a136,0x3f07a1363efc5d27,0x3f19c2003f10d3cd,0x3f102dd53f064b82,0x3f2302d33f19c200
.quad 0x3f187fc03f0e39da,0x3f2beb4a3f226799,0x3f2093933f15f6d9,0x3f34768f3f2ac082,0x3f2866053f1d7fd1,0x3f3ca0033f32c8c9,0x3f2ff3e63f24d225,0x3f4463373f3a7ca4
.quad 0x3f373a233f2beb4a,0x3f4bbbf83f41d870,0x3f3e35c53f32c8c9,0x3f52a6493f48d8b3,0x3f44e3f53f396842,0x3f591e6a3f4f7a1f,0x3f4b41fa3f3fc767,0x3f5f20db3f55b993
.quad 0x3f514d3d3f45e403,0x3f64aa593f5b941a,0x3f5703483f4bbbf8,0x3f69b7e43f6106f2,0x3f5c61c73f514d3d,0x3f6e46be3f660f88,0x3f61668a3f5695e5,0x3f7254703f6aab7b
.quad 0x3f660f883f5b941a,0x3f75dec63f6ed89e,0x3f6a5ad93f604621,0x3f78e3d63f7294f8,0x3f6e46be3f64aa59,0x3f7b61fc3f75dec6,0x3f71d19f3f68bf3c,0x3f7d57de3f78b47b
.quad 0x3f8000003f800000,0x3f8000003f800000,0x3f7fa6e33f7fb10f,0x3f7f90b13f7f9c18,0x3f7e9bc93f7ec46d,0x3f7e43233f7e70b0,0x3f7cdf6c3f7d3aac,0x3f7c187a3f7c7eb0
.quad 0x3f7a73023f7b14be,0x3f7912983f79c79d,0x3f77583a3f7853f8,0x3f75341d3f764d97,0x3f73913f3f74fa0b,0x3f7080663f721352,0x3f6f20b03f710908,0x3f6afb8c3f6d1c1d
.quad 0x3f6a09a73f6c835e,0x3f64aa593f676bd8,0x3f644fac3f676bd8,0x3f5d924d3f6106f2,0x3f5df6be3f61c598,0x3f55b9933f59f26a,0x3f5703483f5b941a,0x3f4d26fd3f5233c6
.quad 0x3f4f7a1f3f54db31,0x3f43e2003f49d112,0x3f4760853f4d9f02,0x3f39f2ac3f40d0da,0x3f3ebc1b3f45e403,0x3f2f61a53f373a23,0x3f3592e73f3daef9,0x3f24381a3f2d1469
.quad 0x3f2beb4a3f3504f3,0x3f187fc03f226799,0x3f21cbfb3f2beb4a,0x3f0c42c93f173c07,0x3f173c073f226799,0x3eff17b23f0b9a6b,0x3f0c42c93f187fc0,0x3ee4cbfe3eff17b2
.quad 0x3f00e7e43f0e39da,0x3ec9b9533ee63375,0x3eea66813f039c3d,0x3eadf73c3ecc9b8b,0x3ed25a093ef15aea,0x3e919ddd3eb263ef,0x3eb9bb1e3edae880,0x3e698bba3e97a117
.quad 0x3ea09ae53ec3ef15,0x3e2f10a23e78cfcc,0x3e870ada3eac7cd4,0x3de7fa9a3e419b37,0x3e5a39973e94a031,0x3d6214693e09cf86,0x3e25c58c3e78cfcc,0xbb490fc63da3308c
.quad 0x3de1bc2e3e47c5c2,0xbd7b2b743cc90ab0,0x3d6ea0383e164083,0xbdf475c0bcfb49ba,0x3bc90f883dc8bd36,0xbe354098bdafb680,0xbd3c6dd53d48fb30,0xbe6fa8b2be1008b7
.quad 0x3f8000003f800000,0x3f8000003f800000,0x3f7f78083f7f84ab,0x3f7f5ce93f7f6ac7,0x3f7de0b13f7e1324,0x3f7d74743f7dabcc,0x3f7b3bab3f7baccd,0x3f7a49103f7ac516
.quad 0x3f778bc53f7853f8,0x3f75dec63f76ba07,0x3f72d4eb3f740bdd,0x3f703b373f718f57,0x3f6d1c1d3f6ed89e,0x3f6965913f6b4b0c,0x3f6667713f68bf3c,0x3f61668a3f63f473
.quad 0x3f5ebe053f61c598,0x3f5848533f5b941a,0x3f5627fe3f59f26a,0x3f4e16893f5233c6,0x3f4cae793f514d3d,0x3f42de293f47de65,0x3f425b893f47de65,0x3f36ad7f3f3ca003
.quad 0x3f373a233f3daef9,0x3f2994153f3085bb,0x3f2b561b3f32c8c9,0x3f1ba2993f239da9,0x3f1ebc123f273656,0x3f0cead03f15f6d9,0x3f11796b3f1b02c6,0x3efafef73f07a136
.quad 0x3f039c3d3f0e39da,0x3edae8803ef15aea,0x3eea66813f00e7e4,0x3eb9bb1e3ed25a09,0x3ecc9b8b3ee63375,0x3e97a1173eb263ef,0x3eadf73c3ec9b953,0x3e698bba3e919ddd
.quad 0x3e8e9a223eac7cd4,0x3e22abb63e605c13,0x3e5d4b1a3e8e9a22,0x3db5f8da3e1c76de,0x3e1c76de3e605c13,0x3c96c9b63dafb680,0x3db5f8da3e22abb6,0xbd55880e3c96c9b6
.quad 0x3cc90ab03dc8bd36,0xbdfab273bd48fb30,0xbd2351cb3d16c32c,0xbe44b0b9bdee3876,0xbdd53db9bcc90ab0,0xbe8586cebe3b6ecf,0xbe2bf804bdafb680,0xbea80b1fbe7ee6e1
.quad 0xbe6c9a7fbe164083,0xbec9b953bea09ae5,0xbe9620d2be541501,0xbeea6681bec1071e,0xbeb554ecbe888e93,0xbf04f484bee0924f,0xbed3c867bea68f12,0xbf140c5fbeff17b2
.quad 0,0,0x3d55880e3d48fb30,0x3d6ea0383d621469,0x3dd53db93dc8bd36,0x3dee38763de1bc2e,0x3e1f917b3e164083,0x3e3228d43e28defc
.quad 0x3e5415013e47c5c2,0x3e6c9a7f3e605c13,0x3e8402703e78cfcc,0x3e931f353e8b9507,0x3e9d9e783e94a031,0x3eaf713a3ea68f12,0x3eb6ccc33eac7cd4,0x3ecb2aae3ec1071e
.quad 0x3ecf7bca3ec3ef15,0x3ee633753edae880,0x3ee79a5d3edae880,0x3f003a063ef41f07,0x3eff17b23ef15aea,0x3f0cead03f064b82,0x3f0af1b73f039c3d,0x3f19210f3f121eb0
.quad 0x3f15f6d93f0e39da,0x3f24d2253f1d7fd1,0x3f2093933f187fc0,0x3f2ff3e63f286605,0x3f2ac0823f226799,0x3f3a7ca43f32c8c9,0x3f34768f3f2beb4a,0x3f4463373f3ca003
.quad 0x3f3daef93f3504f3,0x3f4d9f023f45e403,0x3f4663543f3daef9,0x3f5627fe3f4e8d90,0x3f4e8d903f45e403,0x3f5df6be3f5695e5,0x3f5627fe3f4d9f02,0x3f6504793f5df6be
.quad 0x3f5d2d533f54db31,0x3f6b4b0c3f64aa59,0x3f6398ac3f5b941a,0x3f70c5013f6aab7b,0x3f6965913f61c598,0x3f756d973f6ff573,0x3f6e8ff83f676bd8,0x3f7940c03f748422
.quad 0x3f7314473f6c835e,0x3f7c3b283f7853f8,0x3f76ef5b3f710908,0x3f7e5a383f7b61fc,0x3f7a1e843f74fa0b,0x3f7f9c183f7dabcc,0x3f7c9f8a3f7853f8,0x3f7fffb13f7f2f9d
.quad 0x3f7e70b03f7b14be,0x3f7f84ab3f7fec43,0x3f7f90b13f7d3aac,0x3f7e2b723f7fe129,0x3f7ffec43f7ec46d,0x3f7bf5313f7f0e58,0x3f7fba9e3f7fb10f,0x3f78e3d63f7d7474
.quad 0,0,0x3d83db0a3d7b2b74,0x3d9064b43d8a200a,0x3e0395023dfab273,0x3e1008b73e09cf86,0x3e44b0b93e3b6ecf,0x3e57278f3e4dee60
.quad 0x3e827dc03e78cfcc,0x3e8e9a223e888e93,0x3ea218873e9aa086,0x3eb0eacb3ea986c4,0x3ec1071e3eb8442a,0x3ed25a093ec9b953,0x3edf28a93ed53641,0x3ef2bd433ee900b7
.quad 0x3efc5d273ef15aea,0x3f08f59b3f039c3d,0x3f0c42c93f064b82,0x3f17de123f121eb0,0x3f19c2003f13682a,0x3f26050a3f1ff6cb,0x3f269de33f1ff6cb,0x3f33587a3f2d1469
.quad 0x3f32c8c93f2beb4a,0x3f3fc7673f396842,0x3f3e35c53f373a23,0x3f4b41fa3f44e3f5,0x3f48d8b33f41d870,0x3f55b9933f4f7a1f,0x3f52a6493f4bbbf8,0x3f5f20db3f591e6a
.quad 0x3f5b941a3f54db31,0x3f676bd83f61c598,0x3f6398ac3f5d2d53,0x3f6e8ff83f696591,0x3f6aab7b3f64aa59,0x3f7484223f6ff573,0x3f70c5013f6b4b0c,0x3f7940c03f756d97
.quad 0x3f75dec63f710908,0x3f7cbfc93f79c79d,0x3f79f35e3f75dec6,0x3f7efcc93f7cfe73,0x3f7cfe733f79c79d,0x3f7ff4e63f7f0e58,0x3f7efcc93f7cbfc9,0x3f7fa6e33f7ff4e6
.quad 0x3f7fec433f7ec46d,0x3f7e13243f7fb10f,0x3f7fcbe23f7fd397,0x3f7b3bab3f7e4323,0x3f7e9bc93f7fec43,0x3f7724173f7baccd,0x3f7c5d3a3f7f0e58,0x3f71d19f3f77f110
.quad 0x3f7912983f7d3aac,0x3f6b4b0c3f731447,0x3f74bf623f7a7302,0x3f6398ac3f6d1c1d,0x3f6f68303f76ba07,0x3f5ac4503f660f88,0x3f6912ae3f721352,0x3f50d9373f5df6be
.quad 0x3f8000003f800000,0x3f8000003f800000,0x3f7f3f543f7f4e6d,0x3f7f1f493f7f2f9d,0x3f7cfe733f7d3aac,0x3f7c7eb03f7cbfc9,0x3f7940c03f79c79d,0x3f7822d13f78b47b
.quad 0x3f740bdd3f74fa0b,0x3f7213523f731447,0x3f6d67a13f6ed89e,0x3f6a5ad93f6be858,0x3f655e0b3f676bd8,0x3f6106f23f633c5a,0x3f5bfb343f5ebe05,0x3f5627fe3f591e6a
.quad 0x3f514d3d3f54db31,0x3f49d1123f4d9f02,0x3f4564393f49d112,0x3f3c17d93f40d0da,0x3f3852163f3daef9,0x3f2d14693f32c8c9,0x3f2a2a803f3085bb,0x3f1ce11f3f239da9
.quad 0x3f1b02c63f226799,0x3f0b9a6b3f13682a,0x3f0af1b73f13682a,0x3ef2bd433f0242b1,0x3ef41f073f039c3d,0x3ecc9b8b3ee0924f,0x3ed0eb2a3ee63375,0x3ea5129f3ebb31a0
.quad 0x3eac7cd43ec3ef15,0x3e78cfcc3e94a031,0x3e870ada3ea09ae5,0x3e25c58c3e5a3997,0x3e419b373e78cfcc,0x3da3308c3e09cf86,0x3de7fa9a3e2f10a2,0xbb490fc63d621469
.quad 0x3d16c32c3dc8bd36,0xbdafb680bcc90ab0,0xbd2351cb3cc90ab0,0xbe2bf804bdd53db9,0xbdee3876bd48fb30,0xbe7ee6e1be3b6ecf,0xbe44b0b9bdfab273,0xbea80b1fbe8586ce
.quad 0xbe888e93be47c5c2,0xbecf7bcabeac7cd4,0xbeadf73cbe888e93,0xbef58035bed25a09,0xbed25a09beac7cd4,0xbf0cead0bef6e0cb,0xbef58035becf7bca,0xbf1e1e22bf0cead0
.quad 0xbf0b9a6bbef15aea,0xbf2e3bdebf1d7fd1,0xbf1ba299bf08f59b,0xbf3d27b8bf2d1469,0xbf2ac082bf187fc0,0xbf4ac77fbf3b8f3b,0xbf38dd65bf273656,0xbf570348bf48d8b3
.quad 0x3f8000003f800000,0x3f8000003f800000,0x3f7efcc93f7f0e58,0x3f7ed7d43f7eea9d,0x3f7bf5313f7c3b28,0x3f7b61fc3f7baccd,0x3f76ef5b3f778bc5,0x3f75a67b3f764d97
.quad 0x3f6ff5733f710908,0x3f6db2933f6ed89e,0x3f6715993f68bf3c,0x3f6398ac3f655e0b,0x3f5c61c73f5ebe05,0x3f5770263f59f26a,0x3f4fefa83f531849,0x3f4955213f4cae79
.quad 0x3f41d8703f45e403,0x3f3968423f3daef9,0x3f3238aa3f373a23,0x3f27ce613f2d1469,0x3f212ff93f273656,0x3f14b0393f1b02c6,0x3f0ee0db3f15f6d9,0x3f003a063f07a136
.quad 0x3ef6e0cb3f039c3d,0x3ed536413ee63375,0x3ece0bea3ee0924f,0x3ea80b1f3ebb31a0,0x3ea395c53eb8442a,0x3e72b6513e8e9a22,0x3e6fa8b23e8e9a22,0x3e1324ca3e419b37
.quad 0x3e1640833e47c5c2,0x3d48fb303dc8bd36,0x3d6ea0383de1bc2e,0xbd3c6dd53bc90f88,0xbcfb49ba3cc90ab0,0xbe1008b7bdafb680,0xbdf475c0bd7b2b74,0xbe6fa8b2be354098
.quad 0xbe541501be164083,0xbea68f12be888e93,0xbe9620d2be6c9a7f,0xbed3c867beb554ec,0xbec1071ebea09ae5,0xbeff17b2bee0924f,0xbeea6681bec9b953,0xbf140c5fbf04f484
.quad 0xbf08f59bbef15aea,0xbf273656bf187fc0,0xbf1ba299bf0b9a6b,0xbf38dd65bf2ac082,0xbf2d1469bf1d7fd1,0xbf48d8b3bf3b8f3b,0xbf3d27b8bf2e3bde,0xbf570348bf4ac77f
.quad 0xbf4bbbf8bf3daef9,0xbf633c5abf584853,0xbf58b3a1bf4bbbf8,0xbf6d67a1bf63f473,0xbf63f473bf584853,0xbf756d97bf6db293,0xbf6d67a1bf633c5a,0xbf7b3babbf756d97
.quad 0,0,0x3d9cecf93d96a905,0x3da973ba3da3308c,0x3e1c76de3e164083,0x3e28defc3e22abb6,0x3e698bba3e605c13,0x3e7bdba43e72b651
.quad 0x3e9aa0863e94a031,0x3ea68f123ea09ae5,0x3ebf926f3eb8442a,0x3ece0bea3ec6d529,0x3ee363fa3edae880,0x3ef41f073eebcbbb,0x3f02ef9f3efc5d27,0x3f0c42c93f07a136
.quad 0x3f13682a3f0e39da,0x3f1d7fd13f187fc0,0x3f2302d33f1d7fd1,0x3f2da8593f286605,0x3f31a81d3f2beb4a,0x3f3ca0033f373a23,0x3f3f41fc3f396842,0x3f4a4c873f44e3f5
.quad 0x3f4bbbf83f45e403,0x3f5695e53f514d3d,0x3f5703483f514d3d,0x3f61668a3f5c61c7,0x3f6106f23f5b941a,0x3f6aab7b3f660f88,0x3f69b7e43f64aa59,0x3f7254703f6e46be
.quad 0x3f7109083f6c835e,0x3f7853f83f74fa0b,0x3f76ef5b3f731447,0x3f7c9f8a3f7a1e84,0x3f7b61fc3f7853f8,0x3f7f2f9d3f7dabcc,0x3f7e5a383f7c3b28,0x3f7fffb13f7f9c18
.quad 0x3f7fd3973f7ec46d,0x3f7f0e583f7fec43,0x3f7fcbe23f7fec43,0x3f7c5d3a3f7e9bc9,0x3f7e43233f7fb10f,0x3f77f1103f7baccd,0x3f7b3bab3f7e1324,0x3f71d19f3f772417
.quad 0x3f76ba073f7b14be,0x3f6a09a73f710908,0x3f70c5013f76ba07,0x3f60a6cf3f696591,0x3f6965913f710908,0x3f55b9933f604621,0x3f60a6cf3f6a09a7,0x3f4955213f55b993
.quad 0x3f5695e53f61c598,0x3f3b8f3b3f49d112,0x3f4b41fa3f584853,0x3f2c800f3f3ca003,0x3f3ebc1b3f4d9f02,0x3f1c420c3f2e3bde,0x3f3117223f41d870,0x3f0af1b73f1ebc12
.quad 0,0,0x3db5f8da3dafb680,0x3dc27c393dbc3ac3,0x3e3540983e2f10a2,0x3e419b373e3b6ecf,0x3e870ada3e827dc0,0x3e901c2c3e8b9507
.quad 0x3eb263ef3eac7cd4,0x3ebe1d4a3eb8442a,0x3edc53c13ed53641,0x3eea66813ee363fa,0x3f0242b13efc5d27,0x3f0a48ad3f064b82,0x3f1553b73f10d3cd,0x3f1e1e223f19c200
.quad 0x3f2736563f226799,0x3f3085bb3f2beb4a,0x3f37c6553f32c8c9,0x3f4154e13f3ca003,0x3f46e22a3f41d870,0x3f5064af3f4bbbf8,0x3f546b3b3f4f7a1f,0x3f5d924d3f591e6a
.quad 0x3f6046213f5b941a,0x3f68bf3c3f64aa59,0x3f6a5ad93f660f88,0x3f71d19f3f6e46be,0x3f7294f83f6ed89e,0x3f78b47b3f75dec6,0x3f78e3d63f75dec6,0x3f7d57de3f7b61fc
.quad 0x3f7d3aac3f7b14be,0x3f7fb10f3f7ec46d,0x3f7f90b13f7e70b0,0x3f7fba9e3f7ffec4,0x3f7fe1293f7fec43,0x3f7d74743f7f0e58,0x3f7e2b723f7f84ab,0x3f78e3d63f7bf531
.quad 0x3f7a73023f7d3aac,0x3f7213523f76ba07,0x3f74bf623f791298,0x3f6912ae3f6f6830,0x3f6d1c1d3f731447,0x3f5df6be3f660f88,0x3f6398ac3f6b4b0c,0x3f50d9373f5ac450
.quad 0x3f5848533f61c598,0x3f41d8703f4d9f02,0x3f4b41fa3f5695e5,0x3f3117223f3ebc1b,0x3f3ca0033f49d112,0x3f1ebc123f2e3bde,0x3f2c800f3f3b8f3b,0x3f0af1b73f1c420c
.quad 0x3f1b02c63f2beb4a,0x3eebcbbb3f08f59b,0x3f084b923f1b02c6,0x3ebf926f3ee900b7,0x3ee900b73f08f59b,0x3e919ddd3ebe1d4a,0x3ebf926f3eebcbbb,0x3e44b0b93e919ddd
.quad 0x3f8000003f800000,0x3f8000003f800000,0x3f7eb0693f7ec46d,0x3f7e868b3f7e9bc9,0x3f7ac5163f7b14be,0x3f7a1e843f7a7302,0x3f74484b3f74fa0b,0x3f72d4eb3f73913f
.quad 0x3f6b4b0c3f6c835e,0x3f68bf3c3f6a09a7,0x3f5fe4e93f61c598,0x3f5bfb343f5df6be,0x3f5233c63f54db31,0x3f4cae793f4f7a1f,0x3f425b893f45e403,0x3f3b06293f3ebc1b
.quad 0x3f3085bb3f3504f3,0x3f2736563f2beb4a,0x3f1ce11f3f226799,0x3f11796b3f173c07,0x3f07a1363f0e39da,0x3ef41f073f00e7e4,0x3ee1fb6a3ef15aea,0x3ec27b553ed25a09
.quad 0x3eb263ef3ec3ef15,0x3e8e9a223ea09ae5,0x3e80f8c03e94a031,0x3e3228d43e5a3997,0x3e1c76de3e47c5c2,0x3d8a200a3de1bc2e,0x3d55880e3dc8bd36,0xbd2351cb3bc90f88
.quad 0xbd48fb30248d3132,0xbe164083bdc8bd36,0xbe195be0bdc8bd36,0xbe80f8c0be4dee60,0xbe7ee6e1be47c5c2,0xbeb554ecbe9aa086,0xbeb0eacbbe94a031,0xbee79a5dbecc9b8b
.quad 0xbee0924fbec3ef15,0xbf0b9a6bbefc5d27,0xbf06f686bef15aea,0xbf21cbfbbf14b039,0xbf1c420cbf0e39da,0xbf36206cbf299415,0xbf2ff3e6bf226799,0xbf485bcabf3ca003
.quad 0xbf41d870bf3504f3,0xbf584853bf4d9f02,0xbf51c0c2bf45e403,0xbf65b710bf5c61c7,0xbf5f8327bf54db31,0xbf708066bf68bf3c,0xbf6afb8cbf61c598,0xbf788486bf7294f8
.quad 0xbf740bddbf6c835e,0xbf7dabccbf79c79d,0xbf7a9c59bf74fa0b,0xbf7fe705bf7e4323,0xbf7e9bc9bf7b14be,0xbf7f2f9dbf7ffb11,0xbf7fffb1bf7ec46d,0xbf7b87b2bf7eea9d
.quad 0x3f8000003f800000,0x3f8000003f800000,0x3f7e5a383f7e70b0,0x3f7e2b723f7e4323,0x3f796e4e3f79c79d,0x3f78b47b3f791298,0x3f714c7a3f721352,0x3f6faf1b3f708066
.quad 0x3f660f883f676bd8,0x3f633c5a3f64aa59,0x3f57dc7f3f59f26a,0x3f5389c73f55b993,0x3f46e22a3f49d112,0x3f40d0da3f43e200,0x3f33587a3f373a23,0x3f2b561b3f2f61a5
.quad 0x3f1d7fd13f226799,0x3f13682a3f187fc0,0x3f05a02c3f0b9a6b,0x3ef2bd433eff17b2,0x3ed8106b3ee63375,0x3ebb31a03ec9b953,0x3ea218873eb263ef,0x3e80f8c03e919ddd
.quad 0x3e5415013e78cfcc,0x3e09cf863e2f10a2,0x3dc27c393e09cf86,0x3c7b514b3d621469,0xbc96c9b63cc90ab0,0xbdd53db9bd7b2b74,0xbe06b26ebdafb680,0xbe636c83be354098
.quad 0xbe78cfccbe47c5c2,0xbeac7cd4be94a031,0xbeb3dca5be9aa086,0xbee4cbfebecc9b8b,0xbee900b7becf7bca,0xbf0cead0bf00e7e4,0xbf0d9281bf00e7e4,0xbf256bcbbf19c200
.quad 0xbf24d225bf187fc0,0xbf3b8f3bbf3085bb,0xbf39f2acbf2e3bde,0xbf4f0417bf44e3f5,0xbf4cae79bf41d870,0xbf5f8327bf5695e5,0xbf5cc7d1bf531849,0xbf6cd007bf655e0b
.quad 0xbf6a09a7bf61c598,0xbf76ba07bf710908,0xbf74484bbf6db293,0xbf7d1cddbf796e4e,0xbf7b61fcbf76ba07,0xbf7fe129bf7e70b0,0xbf7f3f54bf7cbfc9,0xbf7efcc9bf7ffec4
.quad 0xbf7fd397bf7fb10f,0xbf7a7302bf7e1324,0xbf7d1cddbf7f84ab,0xbf725470bf78b47b,0xbf772417bf7c3b28,0xbf66beccbf6ff573,0xbf6dfcf2bf75dec6,0xbf57dc7fbf63f473
.quad 0,0,0x3dcefdb73dc8bd36,0x3ddb7d373dd53db9,0x3e4dee603e47c5c2,0x3e5a39973e541501,0x3e9920fe3e94a031,0x3ea218873e9d9e78
.quad 0x3ec9b9533ec3ef15,0x3ed536413ecf7bca,0x3ef840c83ef15aea,0x3f02ef9f3eff17b2,0x3f121eb03f0e39da,0x3f19c2003f15f6d9,0x3f269de33f226799,0x3f2ecef73f2ac082
.quad 0x3f3968423f3504f3,0x3f41d8703f3daef9,0x3f4a4c873f45e403,0x3f52a6493f4e8d90,0x3f591e6a3f54db31,0x3f6106f23f5d2d53,0x3f65b7103f61c598,0x3f6cd0073f696591
.quad 0x3f6ff5733f6c835e,0x3f75dec63f731447,0x3f77beb73f74fa0b,0x3f7c187a3f7a1e84,0x3f7cfe733f7b14be,0x3f7f6ac73f7e70b0,0x3f7fa6e33f7ec46d,0x3f7fcbe23f7ffec4
.quad 0x3f7fb10f3f800000,0x3f7d3aac3f7ec46d,0x3f7d1cdd3f7ec46d,0x3f77beb73f7ac516,0x3f77f1103f7b14be,0x3f6f68303f740bdd,0x3f703b373f74fa0b,0x3f644fac3f6aab7b
.quad 0x3f660f883f6c835e,0x3f5695e53f5ebe05,0x3f5988ad3f61c598,0x3f4663543f5064af,0x3f4ac77f3f54db31,0x3f33e7bc3f3fc767,0x3f39f2ac3f45e403,0x3f1f599f3f2d1469
.quad 0x3f2736563f3504f3,0x3f08f59b3f187fc0,0x3f12c39a3f226799,0x3ee1fb6a3f0242b1,0x3ef9a02d3f0e39da,0x3eaf713a3ed53641,0x3ecb2aae3ef15aea,0x3e75c35a3ea395c5
.quad 0x3e9aa0863ec3ef15,0x3e09cf863e605c13,0x3e5101f13e94a031,0x3ce22a7a3dee3876,0x3dd53db93e47c5c2,0xbda3308c3c490e90,0x3b490fc63dc8bd36,0xbe3e853ebdbc3ac3
.quad 0,0,0x3de7fa9a3de1bc2e,0x3df475c03dee3876,0x3e667c663e605c13,0x3e72b6513e6c9a7f,0x3eab02013ea68f12,0x3eb3dca53eaf713a
.quad 0x3ee0924f3edae880,0x3eebcbbb3ee63375,0x3f099f4e3f064b82,0x3f102dd53f0cead0,0x3f212ff93f1d7fd1,0x3f2866053f24d225,0x3f36ad7f3f32c8c9,0x3f3e35c53f3a7ca4
.quad 0x3f49d1123f45e403,0x3f514d3d3f4d9f02,0x3f5a5ba03f5695e5,0x3f61668a3f5df6be,0x3f6816a83f64aa59,0x3f6e46be3f6b4b0c,0x3f72d4eb3f6ff573,0x3f77beb73f756d97
.quad 0x3f7a73023f7853f8,0x3f7dabcc3f7c3b28,0x3f7ed7d43f7dabcc,0x3f7ff84a3f7f9c18,0x3f7ff4e63f7fec43,0x3f7e9bc93f7f84ab,0x3f7dc68c3f7f0e58,0x3f799b433f7bf531
.quad 0x3f7853f83f7b14be,0x3f7109083f74fa0b,0x3f6faf1b3f740bdd,0x3f6504793f6aab7b,0x3f63f4733f6a09a7,0x3f55b9933f5d2d53,0x3f554aa43f5d2d53,0x3f4360513f4cae79
.quad 0x3f43e2003f4d9f02,0x3f2e3bde3f396842,0x3f2ff3e63f3b8f3b,0x3f16999f3f239da9,0x3f19c2003f273656,0x3ef9a02d3f0b9a6b,0x3f0195733f10d3cd,0x3ec27b553ee363fa
.quad 0x3ecf7bca3ef15aea,0x3e888e933eac7cd4,0x3e9920fe3ebe1d4a,0x3e195be03e667c66,0x3e419b373e888e93,0x3cfb49ba3de1bc2e,0x3d9cecf93e22abb6,0xbdb5f8dabbc90f88
.quad 0xbd16c32c3d48fb30,0xbe541501bdfab273,0xbe195be0bd7b2b74,0xbea5129fbe72b651,0xbe8586cebe2f10a2,0xbeddbe79beb263ef,0xbebca7afbe8e9a22,0xbf099f4ebee900b7
.quad 0x3f8000003f800000,0x3f8000003f800000,0x3f7dfa383f7e1324,0x3f7dc68c3f7de0b1,0x3f77f1103f7853f8,0x3f7724173f778bc5,0x3f6dfcf23f6ed89e,0x3f6c36243f6d1c1d
.quad 0x3f6046213f61c598,0x3f5d2d533f5ebe05,0x3f4f04173f514d3d,0x3f4a4c873f4cae79,0x3f3a7ca43f3daef9,0x3f33e7bc3f373a23,0x3f2302d33f273656,0x3f1a62933f1ebc12
.quad 0x3f08f59b3f0e39da,0x3efc5d273f039c3d,0x3ed97cb93ee63375,0x3ebf926f3ecc9b8b,0x3e9d9e783eac7cd4,0x3e7ee6e13e8e9a22,0x3e3e853e3e605c13,0x3df475c03e1c76de
.quad 0x3d7b2b743dc8bd36,0xbc490e903cc90ab0,0xbd83db0abcc90ab0,0xbe1324cabdd53db9,0xbe419b37be164083,0xbe8b9507be6c9a7f,0xbe9f1cdfbe888e93,0xbecb2aaebeb554ec
.quad 0xbedae880bec3ef15,0xbf039c3dbef15aea,0xbf099f4ebefc5d27,0xbf1f599fbf14b039,0xbf239da9bf187fc0,0xbf385216bf2e3bde,0xbf3b0629bf3085bb,0xbf4e1689bf44e3f5
.quad 0xbf4f7a1fbf45e403,0xbf604621bf584853,0xbf60a6cfbf584853,0xbf6e8ff8bf6816a8,0xbf6e46bebf676bd8,0xbf78b47bbf740bdd,0xbf7822d1bf731447,0xbf7e868bbf7bf531
.quad 0xbf7e1324bf7b14be,0xbf7fec43bf7fb10f,0xbf7fffb1bf7f4e6d,0xbf7cdf6cbf7f2f9d,0xbf7de0b1bf7fb10f,0xbf756d97bf7a7302,0xbf77beb7bf7c3b28,0xbf69b7e4bf718f57
.quad 0xbf6db293bf74fa0b,0xbf59f26abf64aa59,0xbf5fe4e9bf6a09a7,0xbf466354bf53fac3,0xbf4e8d90bf5b941a,0xbf2f61a5bf3fc767,0xbf39f2acbf49d112,0xbf1553b7bf286605
.quad 0x3f8000003f800000,0x3f8000003f800000,0x3f7d906e3f7dabcc,0x3f7d57de3f7d7474,0x3f764d973f76ba07,0x3f756d973f75dec6,0x3f6a5ad93f6b4b0c,0x3f686b393f696591
.quad 0x3f59f26a3f5b941a,0x3f5695e53f584853,0x3f4564393f47de65,0x3f404c5c3f42de29,0x3f2d14693f3085bb,0x3f26050a3f299415,0x3f11796b3f15f6d9,0x3f084b923f0cead0
.quad 0x3ee633753ef15aea,0x3ecf7bca3edae880,0x3ea5129f3eb263ef,0x3e8a11f73e97a117,0x3e419b373e605c13,0x3e0395023e22abb6,0x3d55880e3dafb680,0xbc7b514b3c96c9b6
.quad 0xbdafb680bd48fb30,0xbe22abb6bdfab273,0xbe636c83be3b6ecf,0xbe9920febe8586ce,0xbeb554ecbea09ae5,0xbeddbe79bec9b953,0xbef58035bee0924f,0xbf0ee0dbbf04f484
.quad 0xbf187fc0bf0e39da,0xbf2beb4abf226799,0xbf33587abf299415,0xbf456439bf3ca003,0xbf4ac77fbf41d870,0xbf5ac450bf531849,0xbf5e5aa6bf5695e5,0xbf6b99fbbf655e0b
.quad 0xbf6db293bf676bd8,0xbf778bc5bf731447,0xbf788486bf740bdd,0xbf7e5a38bf7bf531,0xbf7e9bc9bf7c3b28,0xbf7fe129bf7fd397,0xbf7fdaafbf7fd397,0xbf7c187abf7e9bc9
.quad 0xbf7c3b28bf7ec46d,0xbf731447bf7853f8,0xbf73ced9bf791298,0xbf650479bf6d1c1d,0xbf66beccbf6ed89e,0xbf5233c6bf5d2d53,0xbf554aa4bf604621,0xbf3b0629bf48d8b3
.quad 0xbf3fc767bf4d9f02,0xbf1ff6cbbf3085bb,0xbf269de3bf373a23,0xbf019573bf14b039,0xbf0a48adbf1d7fd1,0xbec1071ebeebcbbb,0xbed6a399bf00e7e4,0xbe75c35abea986c4
.quad 0,0,0x3e0077453dfab273,0x3e06b26e3e039502,0x3e7ee6e13e78cfcc,0x3e8586ce3e827dc0,0x3ebca7af3eb8442a,0x3ec5625c3ec1071e
.quad 0x3ef6e0cb3ef15aea,0x3f00e7e43efc5d27,0x3f16999f3f13682a,0x3f1ce11f3f19c200,0x3f2f61a53f2beb4a,0x3f36206c3f32c8c9,0x3f4564393f41d870,0x3f4c35783f48d8b3
.quad 0x3f5848533f54db31,0x3f5ebe053f5b941a,0x3f67c1873f64aa59,0x3f6d67a13f6aab7b,0x3f73913f3f710908,0x3f77f1103f75dec6,0x3f7b87b23f79c79d,0x3f7e2b723f7cfe73
.quad 0x3f7f84ab3f7ec46d,0x3f7ffb113f7fec43,0x3f7f78083f7fec43,0x3f7d57de3f7e9bc9,0x3f7b61fc3f7d3aac,0x3f764d973f791298,0x3f73530e3f76ba07,0x3f6afb8c3f6f6830
.quad 0x3f676bd83f6c835e,0x3f5b941a3f61c598,0x3f57dc7f3f5ebe05,0x3f485bca3f5064af,0x3f44e3f53f4d9f02,0x3f31a81d3f3b8f3b,0x3f2ecef73f396842,0x3f17de123f239da9
.quad 0x3f15f6d93f226799,0x3ef6e0cb3f08f59b,0x3ef580353f08f59b,0x3eb9bb1e3ed8106b,0x3ebb31a03edae880,0x3e72b6513e9aa086,0x3e7bdba43ea09ae5,0x3ddb7d373e354098
.quad 0x3dfab2733e47c5c2,0xbcc90ab03d48fb30,0xbb490fc63d96a905,0xbe1f917bbda3308c,0xbe039502bd48fb30,0xbe919dddbe541501,0xbe80f8c0be2f10a2,0xbed0eb2abea986c4
.quad 0xbebe1d4abe94a031,0xbf064b82bee63375,0xbef840c8becf7bca,0xbf21cbfbbf0f8784,0xbf173c07bf039c3d,0xbf3a7ca4bf299415,0xbf2ff3e6bf1d7fd1,0xbf4fefa8bf40d0da
.quad 0,0,0x3e0cec4a3e09cf86,0x3e1324ca3e1008b7,0x3e8b95073e888e93,0x3e919ddd3e8e9a22,0x3ece0bea3ec9b953,0x3ed6a3993ed25a09
.quad 0x3f064b823f039c3d,0x3f0b9a6b3f08f59b,0x3f2302d33f1ff6cb,0x3f28fd413f26050a,0x3f3ca0033f396842,0x3f42de293f3fc767,0x3f52a6493f4f7a1f,0x3f58b3a13f55b993
.quad 0x3f64aa593f61c598,0x3f6a09a73f676bd8,0x3f7254703f6ff573,0x3f76841b3f748422,0x3f7b61fc3f79c79d,0x3f7de0b13f7cbfc9,0x3f7fa6e33f7f0e58,0x3f7ff84a3f7ff4e6
.quad 0x3f7f0e583f7fb10f,0x3f7cbfc93f7e1324,0x3f799b433f7baccd,0x3f74484b3f772417,0x3f6f68303f731447,0x3f66becc3f6b4b0c,0x3f60a6cf3f660f88,0x3f546b3b3f5ac450
.quad 0x3f4d9f023f54db31,0x3f3daef93f45e403,0x3f36ad7f3f3fc767,0x3f2302d33f2d1469,0x3f1c420c3f273656,0x3f04f4843f10d3cd,0x3efdbabb3f0b9a6b,0x3ec8477c3ee363fa
.quad 0x3ebe1d4a3edae880,0x3e827dc03ea09ae5,0x3e75c35a3e9aa086,0x3de7fa9a3e354098,0x3dd53db93e2f10a2,0xbcfb49ba3d16c32c,0xbd0a342f3d16c32c,0xbe3228d4bdd53db9
.quad 0xbe2f10a2bdc8bd36,0xbea09ae5be78cfcc,0xbe9c1fafbe6c9a7f,0xbee4cbfebec1071e,0xbeddbe79beb8442a,0xbf121eb0bf00e7e4,0xbf0d9281bef6e0cb,0xbf2ecef7bf1ebc12
.quad 0xbf299415bf187fc0,0xbf47de65bf396842,0xbf425b89bf32c8c9,0xbf5cc7d1bf5064af,0xbf577026bf49d112,0xbf6d1c1dbf633c5a,0xbf686b39bf5d2d53,0xbf788486bf718f57
.quad 0x3f8000003f800000,0x3f8000003f800000,0x3f7d1cdd3f7d3aac,0x3f7cdf6c3f7cfe73,0x3f7484223f74fa0b,0x3f73913f3f740bdd,0x3f6667713f676bd8,0x3f644fac3f655e0b
.quad 0x3f5318493f54db31,0x3f4f7a1f3f514d3d,0x3f3b06293f3daef9,0x3f3592e73f385216,0x3f1ebc123f226799,0x3f173c073f1b02c6,0x3efdbabb3f039c3d,0x3eea66813ef41f07
.quad 0x3eb8442a3ec3ef15,0x3ea09ae53eac7cd4,0x3e5d4b1a3e78cfcc,0x3e25c58c3e419b37,0x3d8a200a3dc8bd36,0x3bc90f883d16c32c,0xbda973babd48fb30,0xbe195be0bdee3876
.quad 0xbe6c9a7fbe47c5c2,0xbe9aa086be888e93,0xbebf926fbeac7cd4,0xbee4cbfebed25a09,0xbf0242b1bef15aea,0xbf14b039bf0b9a6b,0xbf21cbfbbf187fc0,0xbf33587abf2ac082
.quad 0xbf3daef9bf3504f3,0xbf4d9f02bf45e403,0xbf554aa4bf4d9f02,0xbf62df7bbf5c61c7,0xbf6816a8bf61c598,0xbf7294f8bf6db293,0xbf75a67bbf710908,0xbf7c5d3abf796e4e
.quad 0xbf7dabccbf7b14be,0xbf7ffb11bf7f4e6d,0xbf7ff84abf7fb10f,0xbf7d57debf7f2f9d,0xbf7c7eb0bf7ec46d,0xbf748422bf791298,0xbf73530ebf7853f8,0xbf65b710bf6d1c1d
.quad 0xbf64aa59bf6c835e,0xbf514d3dbf5b941a,0xbf50d937bf5b941a,0xbf37c655bf44e3f5,0xbf385216bf45e403,0xbf19c200bf299415,0xbf1ba299bf2beb4a,0xbeeff7fbbf0a48ad
.quad 0xbef6e0cbbf0e39da,0xbea68f12becf7bca,0xbeb0eacbbedae880,0xbe3228d4be8586ce,0xbe4dee60be94a031,0xbc96c9b6bde1bc2e,0xbd55880ebe164083,0x3e0cec4a3d2fe007
.quad 0x3f8000003f800000,0x3f8000003f800000,0x3f7c9f8a3f7cbfc9,0x3f7c5d3a3f7c7eb0,0x3f7294f83f731447,0x3f718f573f721352,0x3f62241a3f633c5a,0x3f5fe4e93f6106f2
.quad 0x3f4bbbf83f4d9f02,0x3f47de653f49d112,0x3f2ff3e63f32c8c9,0x3f2a2a803f2d1469,0x3f0f87843f13682a,0x3f07a1363f0b9a6b,0x3ed6a3993ee0924f,0x3ec27b553ecc9b8b
.quad 0x3e888e933e94a031,0x3e605c133e78cfcc,0x3ddb7d373e09cf86,0x3d55880e3da3308c,0xbd621469bcc90ab0,0xbdee3876bdafb680,0xbe5d4b1abe3b6ecf,0xbe901c2cbe7ee6e1
.quad 0xbebe1d4abeac7cd4,0xbee0924fbecf7bca,0xbf044889bef6e0cb,0xbf1553b7bf0cead0,0xbf26050abf1d7fd1,0xbf36206cbf2e3bde,0xbf436051bf3b8f3b,0xbf51c0c2bf4ac77f
.quad 0xbf5b941abf54db31,0xbf676bd8bf61c598,0xbf6dfcf2bf68bf3c,0xbf76841bbf7294f8,0xbf7a1e84bf76ba07,0xbf7e9bc9bf7cbfc9,0xbf7fa6e3bf7e70b0,0xbf7f7808bf7ffec4
.quad 0xbf7e70b0bf7fb10f,0xbf791298bf7c3b28,0xbf76841bbf7a7302,0xbf6b99fbbf718f57,0xbf6816a8bf6ed89e,0xbf577026bf604621,0xbf5389c7bf5d2d53,0xbf3d27b8bf48d8b3
.quad 0xbf396842bf45e403,0xbf1d7fd1bf2beb4a,0xbf1a6293bf299415,0xbef2bd43bf0a48ad,0xbeee9479bf08f59b,0xbea395c5bec9b953,0xbea21887bec9b953,0xbe1f917bbe72b651
.quad 0xbe22abb6be78cfcc,0x3c490e90bd96a905,0x3b490fc6bdafb680,0x3e3857ec3dbc3ac3,0x3e28defc3d96a905,0x3eaf713a3e827dc0,0x3ea5129f3e6c9a7f,0x3efdbabb3ed25a09
.quad 0,0,0x3e195be03e164083,0x3e1f917b3e1c76de,0x3e97a1173e94a031,0x3e9d9e783e9aa086,0x3edf28a93edae880,0x3ee79a5d3ee363fa
.quad 0x3f10d3cd3f0e39da,0x3f15f6d93f13682a,0x3f2ecef73f2beb4a,0x3f34768f3f31a81d,0x3f48d8b33f45e403,0x3f4e8d903f4bbbf8,0x3f5e5aa63f5b941a,0x3f6398ac3f6106f2
.quad 0x3f6ed89e3f6c835e,0x3f7314473f710908,0x3f79f35e3f7853f8,0x3f7c9f8a3f7b61fc,0x3f7f6ac73f7ec46d,0x3f7ffec43f7fd397,0x3f7f1f493f7fb10f,0x3f7d1cdd3f7e4323
.quad 0x3f7912983f7b14be,0x3f740bdd3f76ba07,0x3f6d67a13f710908,0x3f6504793f696591,0x3f5c61c73f61c598,0x3f5064af3f5695e5,0x3f4663543f4d9f02,0x3f36ad7f3f3ebc1b
.quad 0x3f2beb4a3f3504f3,0x3f187fc03f226799,0x3f0d92813f187fc0,0x3eed30633f0242b1,0x3ed8106b3ef15aea,0x3ea395c53ebe1d4a,0x3e901c2c3eac7cd4,0x3e2bf8043e667c66
.quad 0x3e09cf863e47c5c2,0x3c490e903d96a905,0xbc7b514b3d48fb30,0xbe1324cabda3308c,0xbe28defcbdc8bd36,0xbe97a117be6c9a7f,0xbe9f1cdfbe78cfcc,0xbee1fb6abec1071e
.quad 0xbee63375bec3ef15,0xbf13682abf039c3d,0xbf140c5fbf039c3d,0xbf3238aabf239da9,0xbf31a81dbf226799,0xbf4cae79bf3fc767,0xbf4b41fabf3daef9,0xbf62241abf577026
.quad 0xbf604621bf54db31,0xbf721352bf6a09a7,0xbf703b37bf676bd8,0xbf7c187abf772417,0xbf7ac516bf74fa0b,0xbf7ff4e6bf7e70b0,0xbf7fa6e3bf7d3aac,0xbf7d906ebf7fc38f
.quad 0,0,0x3e25c58c3e22abb6,0x3e2bf8043e28defc,0x3ea395c53ea09ae5,0x3ea986c43ea68f12,0x3eeff7fb3eebcbbb,0x3ef840c83ef41f07
.quad 0x3f1b02c63f187fc0,0x3f1ff6cb3f1d7fd1,0x3f39f2ac3f373a23,0x3f3f41fc3f3ca003,0x3f53fac33f514d3d,0x3f591e6a3f5695e5,0x3f686b393f660f88,0x3f6cd0073f6aab7b
.quad 0x3f76ba073f74fa0b,0x3f79c79d3f7853f8,0x3f7e868b3f7dabcc,0x3f7fa6e33f7f2f9d,0x3f7f9c183f7fec43,0x3f7e43233f7f0e58,0x3f79f35e3f7baccd,0x3f75a67b3f77f110
.quad 0x3f6db2933f710908,0x3f660f883f6a09a7,0x3f5b2c793f604621,0x3f4fefa83f55b993,0x3f42de293f49d112,0x3f33e7bc3f3b8f3b,0x3f256bcb3f2e3bde,0x3f12c39a3f1c420c
.quad 0x3f039c3d3f0e39da,0x3edae8803ef15aea,0x3ebca7af3ed53641,0x3e8a11f73ea395c5,0x3e5a39973e888e93,0x3dd53db93e22abb6,0x3d55880e3de1bc2e,0xbd83db0abbc90f88
.quad 0xbde1bc2ebd48fb30,0xbe6c9a7fbe2f10a2,0xbe8a11f7be541501,0xbec8477cbea986c4,0xbed8106bbeb8442a,0xbf0a48adbef6e0cb,0xbf102dd5bf00e7e4,0xbf2c800fbf1ebc12
.quad 0xbf3085bbbf226799,0xbf49d112bf3daef9,0xbf4c3578bf3fc767,0xbf61668abf577026,0xbf628210bf584853,0xbf7294f8bf6b4b0c,0xbf72d4ebbf6b4b0c,0xbf7cdf6cbf78b47b
.quad 0xbf7cbfc9bf7853f8,0xbf7ffb11bf7f4e6d,0xbf7fffb1bf7f0e58,0xbf7bd14dbf7eea9d,0xbf7c7eb0bf7f4e6d,0xbf708066bf778bc5,0xbf725470bf791298,0xbf5e5aa6bf696591
.quad 0x3f8000003f800000,0x3f8000003f800000,0x3f7c187a3f7c3b28,0x3f7bd14d3f7bf531,0x3f7080663f710908,0x3f6f68303f6ff573,0x3f5d924d3f5ebe05,0x3f5b2c793f5c61c7
.quad 0x3f43e2003f45e403,0x3f3fc7673f41d870,0x3f24381a3f273656,0x3f1e1e223f212ff9,0x3eff17b23f039c3d,0x3eee94793ef6e0cb,0x3eadf73c3eb8442a,0x3e9920fe3ea395c5
.quad 0x3e2f10a23e47c5c2,0x3dfab2733e164083,0xbb490fc63cc90ab0,0xbd6ea038bcfb49ba,0xbe354098be164083,0xbe72b651be541501,0xbeb0eacbbea09ae5,0xbed0eb2abec1071e
.quad 0xbf00e7e4bef15aea,0xbf10d3cdbf08f59b,0xbf256bcbbf1d7fd1,0xbf34768fbf2d1469,0xbf44e3f5bf3daef9,0xbf5233c6bf4bbbf8,0xbf5e5aa6bf584853,0xbf6912aebf63f473
.quad 0xbf710908bf6c835e,0xbf7853f8bf74fa0b,0xbf7c5d3abf79c79d,0xbf7f7808bf7e4323,0xbf7ffec4bf7fb10f,0xbf7e4323bf7f84ab,0xbf7bd14dbf7e1324,0xbf74bf62bf78b47b
.quad 0xbf6ff573bf74fa0b,0xbf633c5abf6a09a7,0xbf5cc7d1bf64aa59,0xbf4a4c87bf53fac3,0xbf42de29bf4d9f02,0xbf2ac082bf373a23,0xbf2302d3bf3085bb,0xbf05a02cbf14b039
.quad 0xbefc5d27bf0e39da,0xbeb8442abedae880,0xbeab0201becf7bca,0xbe3e853ebe8586ce,0xbe28defcbe78cfcc,0xbbc90f88bdafb680,0x3c16cb58bd96a905,0x3e3228d43dbc3ac3
.quad 0x3e3b6ecf3dc8bd36,0x3eb263ef3e888e93,0x3eb3dca53e888e93,0x3f02ef9f3eddbe79,0x3f0242b13edae880,0x3f2866053f15f6d9,0x3f269de33f13682a,0x3f485bca3f385216
.quad 0x3f8000003f800000,0x3f8000003f800000,0x3f7b87b23f7baccd,0x3f7b3bab3f7b61fc,0x3f6e46be3f6ed89e,0x3f6d1c1d3f6db293,0x3f58b3a13f59f26a,0x3f5627fe3f577026
.quad 0x3f3b8f3b3f3daef9,0x3f373a233f396842,0x3f17de123f1b02c6,0x3f11796b3f14b039,0x3eddbe793ee63375,0x3ecc9b8b3ed53641,0x3e8402703e8e9a22,0x3e5d4b1a3e72b651
.quad 0x3d96a9053dc8bd36,0x3cc90ab03d48fb30,0xbde7fa9abdafb680,0xbe2bf804be1008b7,0xbe97a117be888e93,0xbeb554ecbea68f12,0xbeeff7fbbee0924f,0xbf06f686beff17b2
.quad 0xbf1ff6cbbf187fc0,0xbf2e3bdebf273656,0xbf425b89bf3b8f3b,0xbf4f0417bf48d8b3,0xbf5df6bebf584853,0xbf6816a8bf633c5a,0xbf71d19fbf6db293,0xbf788486bf756d97
.quad 0xbf7d3aacbf7b14be,0xbf7fb10fbf7ec46d,0xbf7fcbe2bf7ffb11,0xbf7d57debf7eea9d,0xbf796e4ebf7c3b28,0xbf718f57bf75dec6,0xbf6a5ad9bf6ff573,0xbf5cc7d1bf63f473
.quad 0xbf531849bf5b941a,0xbf3fc767bf49d112,0xbf34768fbf3fc767,0xbf1ba299bf286605,0xbf0f8784bf1d7fd1,0xbee363fabf00e7e4,0xbecb2aaebeebcbbb,0xbe870adabea986c4
.quad 0xbe605c13be94a031,0xbd96a905be164083,0xbd0a342fbde1bc2e,0x3df475c03d2fe007,0x3e1c76de3d96a905,0x3e9d9e783e6c9a7f,0x3eab02013e827dc0,0x3ef840c83ed25a09
.quad 0x3f00e7e43edae880,0x3f24d2253f13682a,0x3f27ce613f15f6d9,0x3f4760853f385216,0x3f48d8b33f396842,0x3f6282103f5695e5,0x3f62df7b3f5695e5,0x3f75341d3f6d1c1d
.quad 0,0,0x3e3228d43e2f10a2,0x3e3857ec3e354098,0x3eaf713a3eac7cd4,0x3eb554ec3eb263ef,0x3f003a063efc5d27,0x3f0448893f0242b1
.quad 0x3f24d2253f226799,0x3f2994153f273656,0x3f4463373f41d870,0x3f4955213f46e22a,0x3f5df6be3f5b941a,0x3f6282103f604621,0x3f70c5013f6ed89e,0x3f74484b3f7294f8
.quad 0x3f7c3b283f7b14be,0x3f7e13243f7d3aac,0x3f7fffb13f7fec43,0x3f7f90b13f7fe129,0x3f7bf5313f7d3aac,0x3f78b47b3f7a7302,0x3f703b373f731447,0x3f69b7e43f6d1c1d
.quad 0x3f5d2d533f61c598,0x3f5318493f584853,0x3f4360513f49d112,0x3f3592e73f3ca003,0x3f239da93f2beb4a,0x3f121eb03f1b02c6,0x3efdbabb3f08f59b,0x3ed3c8673ee900b7
.quad 0x3eac7cd43ec3ef15,0x3e78cfcc3e94a031,0x3e2bf8043e605c13,0x3d83db0a3dee3876,0xbbc90f883d48fb30,0xbdee3876bd7b2b74,0xbe3857ecbdfab273,0xbe9620d2be72b651
.quad 0xbeb263efbe94a031,0xbeebcbbbbecf7bca,0xbf019573bee63375,0xbf1ce11fbf0f8784,0xbf26050abf187fc0,0xbf3ebc1bbf32c8c9,0xbf456439bf396842,0xbf5a5ba0bf5064af
.quad 0xbf5ebe05bf54db31,0xbf6ed89ebf676bd8,0xbf714c7abf6a09a7,0xbf7b87b2bf772417,0xbf7c7eb0bf7853f8,0xbf7ffec4bf7f0e58,0xbf7ffd39bf7f4e6d,0xbf7c187abf7eea9d
.quad 0xbf7baccdbf7ec46d,0xbf6ff573bf76ba07,0xbf6faf1bbf76ba07,0xbf5bfb34bf66becc,0xbf5c61c7bf676bd8,0xbf40d0dabf4f7a1f,0xbf425b89bf514d3d,0xbf1f599fbf31a81d
.quad 0,0,0x3e3e853e3e3b6ecf,0x3e44b0b93e419b37,0x3ebb31a03eb8442a,0x3ec1071e3ebe1d4a,0x3f084b923f064b82,0x3f0c42c93f0a48ad
.quad 0x3f2e3bde3f2beb4a,0x3f32c8c93f3085bb,0x3f4e16893f4bbbf8,0x3f52a6493f5064af,0x3f66becc3f64aa59,0x3f6aab7b3f68bf3c,0x3f77583a3f75dec6,0x3f79f35e3f78b47b
.quad 0x3f7f4e6d3f7ec46d,0x3f7fec433f7fb10f,0x3f7e5a383f7f0e58,0x3f7c5d3a3f7d7474,0x3f7484223f76ba07,0x3f6f68303f721352,0x3f62241a3f660f88,0x3f5988ad3f5df6be
.quad 0x3f47de653f4d9f02,0x3f3b8f3b3f41d870,0x3f269de33f2e3bde,0x3f16999f3f1ebc12,0x3eff17b23f08f59b,0x3ed8106b3eebcbbb,0x3ea80b1f3ebe1d4a,0x3e75c35a3e919ddd
.quad 0x3e1640833e47c5c2,0x3d48fb303dc8bd36,0xbd2351cb3c490e90,0xbe1324cabdbc3ac3,0xbe667c66be2f10a2,0xbea986c4be8e9a22,0xbece0beabeb263ef,0xbf019573bee900b7
.quad 0xbf10d3cdbf039c3d,0xbf299415bf1d7fd1,0xbf3592e7bf299415,0xbf4b41fabf40d0da,0xbf53fac3bf49d112,0xbf655e0bbf5d2d53,0xbf6afb8cbf633c5a,0xbf76ef5bbf718f57
.quad 0xbf79c79dbf74fa0b,0xbf7f4e6dbf7d3aac,0xbf7fdaafbf7e70b0,0xbf7e2b72bf7fc38f,0xbf7cfe73bf7f4e6d,0xbf73913fbf791298,0xbf714c7abf778bc5,0xbf5fe4e9bf696591
.quad 0xbf5d2d53bf676bd8,0xbf43e200bf514d3d,0xbf4154e1bf4f7a1f,0xbf209393bf31a81d,0xbf1ebc12bf3085bb,0xbeee9479bf0b9a6b,0xbeed3063bf0b9a6b,0xbe931f35bec1071e
.quad 0x35cccccd35cccccd,0x35cccccd35cccccd,0x35cccc8e35cccccd,0x35ccca9435cccbd0,0x35cccbd035cccccd,0x35ccc3eb35ccc8da,0x35ccca9435cccccd,0x35ccb8d135ccc3eb
.quad 0x35ccc8da35cccccd,0x35cca94635ccbd02,0x35ccc6a235cccccd,0x35cc954b35ccb421,0x35ccc3eb35cccccd,0x35cc7ce035cca946,0x35ccc0b635cccccd,0x35cc600635cc9c72
.quad 0x35ccbd0235cccccd,0x35cc3ebe35cc8da6,0x35ccb8d135cccccd,0x35cc190735cc7ce0,0x35ccb42135cccccd,0x35cbeee435cc6a23,0x35ccaef335cccccd,0x35cbc05435cc556c
.quad 0x35cca94635cccccd,0x35cb8d5a35cc3ebe,0x35cca31b35cccccd,0x35cb55f535cc2618,0x35cc9c7235cccccd,0x35cb1a2735cc0b7a,0x35cc954b35cccccd,0x35cad9f235cbeee4
.quad 0x35cc8da635cccccd,0x35ca955635cbd057,0x35cc858235cccccd,0x35ca4c5635cbafd4,0x35cc7ce035cccccd,0x35c9fef335cb8d5a,0x35cc73c135cccccd,0x35c9ad2f35cb68e9
.quad 0x35cc6a2335cccccd,0x35c9570a35cb4283,0x35cc600635cccccd,0x35c8fc8935cb1a27,0x35cc556c35cccccd,0x35c89dab35caefd6,0x35cc4a5435cccccd,0x35c83a7335cac390
.quad 0x35cc3ebe35cccccd,0x35c7d2e435ca9556,0x35cc32aa35cccccd,0x35c7670035ca6529,0x35cc261835cccccd,0x35c6f6c835ca3307,0x35cc190735cccccd,0x35c6824135c9fef3
.quad 0x35cc0b7a35cccccd,0x35c6096a35c9c8ed,0x35cbfd6e35cccccd,0x35c58c4935c990f4,0x35cbeee435cccccd,0x35c50adf35c9570a,0x35cbdfdd35cccccd,0x35c4852f35c91b30
.quad 0x35cccccd35cccccd,0x35cccccd35cccccd,0x35ccc6a235ccc8da,0x35ccc0b635ccc3eb,0x35ccb42135ccbd02,0x35cc9c7235cca946,0x35cc954b35cca946,0x35cc600635cc7ce0
.quad 0x35cc6a2335cc8da6,0x35cc0b7a35cc3ebe,0x35cc32aa35cc6a23,0x35cb9ed535cbeee4,0x35cbeee435cc3ebe,0x35cb1a2735cb8d5a,0x35cb9ed535cc0b7a,0x35ca7d7e35cb1a27
.quad 0x35cb428335cbd057,0x35c9c8ed35ca9556,0x35cad9f235cb8d5a,0x35c8fc8935c9fef3,0x35ca652935cb4283,0x35c8186a35c9570a,0x35c9e42e35caefd6,0x35c71cab35c89dab
.quad 0x35c9570a35ca9556,0x35c6096a35c7d2e4,0x35c8bdc635ca3307,0x35c4dec835c6f6c8,0x35c8186a35c9c8ed,0x35c39ce835c6096a,0x35c7670035c9570a,0x35c243ef35c50adf
.quad 0x35c6a99335c8dd65,0x35c0d40735c3fb3c,0x35c5e02f35c85c01,0x35bf4d5a35c2da99,0x35c50adf35c7d2e4,0x35bdb01735c1a90f,0x35c429b035c74213,0x35bbfc7035c066b8
.quad 0x35c33cb135c6a993,0x35ba329635bf13b1,0x35c243ef35c6096a,0x35b852c135bdb017,0x35c13f7935c5619f,0x35b65d2835bc3c09,0x35c02f5f35c4b238,0x35b4520835bab7a7
.quad 0x35bf13b135c3fb3c,0x35b2319e35b92313,0x35bdec8135c33cb1,0x35affc2a35b77e6f,0x35bcb9e035c276a0,0x35adb1ef35b5c9e1,0x35bb7be135c1a90f,0x35ab533235b4058e
.quad 0x35ba329635c0d407,0x35a8e03a35b2319e,0x35b8de1435bff78f,0x35a6595335b04e38,0x35b77e6f35bf13b1,0x35a3bec835ae5b88,0x35b613bd35be2876,0x35a110e735ac59b8
.quad 0,0,0x31a0d96b00000000,0x3271455a3220d93a,0x3220d93a00000000,0x32f142bd32a0d873,0x3271455a00000000,0x3334eec832f142bd
.quad 0x32a0d87300000000,0x337138463320d559,0x32c90dd600000000,0x3396be44334907c8,0x32f142bd00000000,0x33b4dd2033713846,0x330cbb8700000000,0x33d2f811338cb338
.quad 0x3320d55900000000,0x33f10e6e33a0c8f3,0x3334eec800000000,0x34078fc833b4dd20,0x334907c800000000,0x3416956933c8ef90,0x335d204b00000000,0x342597c633dd000f
.quad 0x3371384600000000,0x3434968b33f10e6e,0x3382a7d600000000,0x3443916634028d3d,0x338cb33800000000,0x34528804340c9200,0x3396be4400000000,0x34617a1034169569
.quad 0x33a0c8f300000000,0x347067393420975e,0x33aad33e00000000,0x347f4f2b342a97c7,0x33b4dd2000000000,0x348718ca3434968b,0x33bee69300000000,0x348e8710343e9392
.quad 0x33c8ef9000000000,0x3495f23f34488ec2,0x33d2f81100000000,0x349d5a2e34528804,0x33dd000f00000000,0x34a4beb3345c7f3e,0x33e7078600000000,0x34ac1fa534667457
.quad 0x33f10e6e00000000,0x34b37cdc34706739,0x33fb14c100000000,0x34bad62f347a57c9,0x34028d3d00000000,0x34c22b74348222f8,0x34078fc800000000,0x34c97c83348718ca
.quad 0x340c920000000000,0x34d0c934348c0d4f,0x341193e200000000,0x34d8115e3491007a,0x3416956900000000,0x34df54d83495f23f,0x341b969400000000,0x34e6937a349ae293
.quad 0,0,0x32c90dd632a0d873,0x330cbb8732f142bd,0x334907c83320d559,0x338cb33833713846,0x3396be4433713846,0x33d2f81133b4dd20
.quad 0x33c8ef9033a0c8f3,0x340c920033f10e6e,0x33fb14c133c8ef90,0x342f976034169569,0x3416956933f10e6e,0x345288043434968b,0x342f9760340c9200,0x34755fcc34528804
.quad 0x34488ec23420975e,0x348c0d4f34706739,0x34617a103434968b,0x349d5a2e348718ca,0x347a57c934488ec2,0x34ae94793495f23f,0x34899337345c7f3e,0x34bfba2834a4beb3
.quad 0x3495f23f34706739,0x34d0c93434b37cdc,0x34a2483f348222f8,0x34e1bf9934c22b74,0x34ae9479348c0d4f,0x34f29b5834d0c934,0x34bad62f3495f23f,0x3501ad3934df54d8
.quad 0x34c70ca3349fd168,0x3509fd7634edcd1c,0x34d3371a34a9aa67,0x35123d6934fc30c0,0x34df54d834b37cdc,0x351a6c1835053f42,0x34eb652134bd4866,0x3522888b350c5a95
.quad 0x34f7673d34c70ca3,0x352a91ce351369bb,0x3501ad3934d0c934,0x353286ed351a6c18,0x35079f0334da7db8,0x353a66f93521610f,0x350d88a234e429d0,0x3542310335284807
.quad 0x351369bb34edcd1c,0x3549e41f352f2067,0x351941f234f7673d,0x35517f653535e995,0x351f10ee35007bea,0x355901f0353ca2fc,0x3524d65535053f42,0x35606adb35434c06
.quad 0x352a91ce3509fd76,0x3567b9483549e41f,0x35304301350eb659,0x356eec5835506ab5,0x3535e995351369bb,0x357603343556df37,0x353b85343518176e,0x357cfd04355d4116
.quad 0x35cccccd35cccccd,0x35cccccd35cccccd,0x35ccb8d135ccbd02,0x35ccaef335ccb421,0x35cc7ce035cc8da6,0x35cc556c35cc6a23,0x35cc190735cc3ebe,0x35cbc05435cbeee4
.quad 0x35cb8d5a35cbd057,0x35caefd635cb4283,0x35cad9f235cb4283,0x35c9e42e35ca6529,0x35c9fef335ca9556,0x35c89dab35c9570a,0x35c8fc8935c9c8ed,0x35c71cab35c8186a
.quad 0x35c7d2e435c8dd65,0x35c5619f35c6a993,0x35c6824135c7d2e4,0x35c36d0935c50adf,0x35c50adf35c6a993,0x35c13f7935c33cb1,0x35c36d0935c5619f,0x35bed99335c13f79
.quad 0x35c1a90f35c3fb3c,0x35bc3c0935bf13b1,0x35bfbf4935c276a0,0x35b9679f35bcb9e0,0x35bdb01735c0d407,0x35b65d2835ba3296,0x35bb7be135bf13b1,0x35b31d8735b77e6f
.quad 0x35b9231335bd35e5,0x35afa9af35b49e13,0x35b6a62335bb3aec,0x35ac02a035b19232,0x35b4058e35b92313,0x35a8296b35ae5b88,0x35b141d735b6eeae,0x35a41f3135aafadc
.quad 0x35ae5b8835b49e13,0x359fe51e35a770fe,0x35ab533235b2319e,0x359b7c6d35a3bec8,0x35a8296b35afa9af,0x3596e669359fe51e,0x35a4ded435ad06a9,0x35922466359be4ed
.quad 0x35a1740f35aa48f4,0x358d37c93597bf2e,0x359de9c735a770fe,0x35882200359374de,0x359a40ae35a47f35,0x3582e487358f0707,0x3596797a35a1740f,0x357b01cb358a76bb
.quad 0x359294e9359e5003,0x356ff15b3585c511,0x358e93bb359b138d,0x35649af83580f32d,0x358a76bb3597bf2e,0x355901f03578046f,0x35863eb435945368,0x354d29a4356de6c2
.quad 0x35cccccd35cccccd,0x35cccccd35cccccd,0x35cca31b35cca946,0x35cc954b35cc9c72,0x35cc261835cc3ebe,0x35cbeee435cc0b7a,0x35cb55f535cb8d5a,0x35cad9f235cb1a27
.quad 0x35ca330735ca9556,0x35c9570a35c9c8ed,0x35c8bdc635c9570a,0x35c7670035c8186a,0x35c6f6c835c7d2e4,0x35c50adf35c6096a,0x35c4dec835c6096a,0x35c243ef35c39ce8
.quad 0x35c276a035c3fb3c,0x35bf13b135c0d407,0x35bfbf4935c1a90f,0x35bb7be135bdb017,0x35bcb9e035bf13b1,0x35b77e6f35ba3296,0x35b9679f35bc3c09,0x35b31d8735b65d28
.quad 0x35b5c9e135b92313,0x35ae5b8835b2319e,0x35b1e21f35b5c9e1,0x35a93b0635adb1ef,0x35adb1ef35b2319e,0x35a3bec835a8e03a,0x35a93b0635ae5b88,0x359de9c735a3bec8
.quad 0x35a47f3535aa48f4,0x3597bf2e359e5003,0x359f806a35a5fb4c,0x359142533598967c,0x359a40ae35a1740f,0x358a76bb359294e9,0x3594c224359cb4cd,0x35836014358c4e1d
.quad 0x358f07073597bf2e,0x3578046f3585c511,0x358911af359294e9,0x3568c245357df9b6,0x3582e487358d37c9,0x355901f0356ff15b,0x357904283587a9aa,0x3548cbf9356177b4
.quad 0x356bd9dd3581ec7b,0x3538292a35529394,0x355e4f8b3578046f,0x3527228835434c06,0x35506ab5356bd9dd,0x3515c14d3533a83f,0x35423103355f5d78,0x35040ee53523afa2
.quad 0x3533a83f35529394,0x34e429d0351369bb,0x3524d655354580a2,0x34bfba283502de37,0x3515c14d3538292a,0x349ae29334e429d0,0x35066f4c352a91ce,0x346b6e1134c22b74
.quad 0,0,0x3334eec83320d559,0x335d204b334907c8,0x33b4dd2033a0c8f3,0x33dd000f33c8ef90,0x34078fc833f10e6e,0x342597c634169569
.quad 0x3434968b3420975e,0x345c7f3e34488ec2,0x34617a1034488ec2,0x34899337347a57c9,0x348718ca34706739,0x34a4beb33495f23f,0x349d5a2e348c0d4f,0x34bfba2834ae9479
.quad 0x34b37cdc349fd168,0x34da7db834c70ca3,0x34c97c8334b37cdc,0x34f5019634df54d8,0x34df54d834c70ca3,0x35079f0334f7673d,0x34f5019634da7db8,0x351495b235079f03
.quad 0x35053f4234edcd1c,0x3521610f351369bb,0x350fe3b735007bea,0x352dfd61351f10ee,0x351a6c183509fd76,0x353a66f9352a91ce,0x3524d655351369bb,0x35469a3a3535e995
.quad 0x352f2067351cbf44,0x3552939435411588,0x3539484b3525fca2,0x355e4f8b354c12f5,0x35434c06352f2067,0x3569cab33556df37,0x354d29a43538292a,0x357501b2356177b4
.quad 0x3556df3735411588,0x357ff144356bd9dd,0x35606adb3549e41f,0x35854b1c35760334,0x3569cab335529394,0x358a76bb357ff144,0x3572fcea355b2291,0x358f79fb3584d0d5
.quad 0x357bffb535638fc3,0x3594536835898908,0x358268a9356bd9dd,0x35990197358e2017,0x3586b8043573ff99,0x359d832a359294e9,0x358aed14357bffb5,0x35a1d6d23596e669
.quad 0x358f07073581ec7b,0x35a5fb4c359b138d,0x359305113585c511,0x35a9ef63359f1b54,0x3596e66935898908,0x35adb1ef35a2fcc6,0x359aaa4d358d37c9,0x35b141d735a6b6f3
.quad 0,0,0x3382a7d633713846,0x3396be44338cb338,0x34028d3d33f10e6e,0x34169569340c9200,0x344391663434968b,0x34617a1034528804
.quad 0x348222f834706739,0x3495f23f348c0d4f,0x34a2483f3495f23f,0x34bad62f34ae9479,0x34c22b7434b37cdc,0x34df54d834d0c934,0x34e1bf9934d0c934,0x3501ad3934f29b58
.quad 0x35007bea34edcd1c,0x351369bb3509fd76,0x350fe3b735053f42,0x3524d655351a6c18,0x351f10ee351369bb,0x3535e995352a91ce,0x352dfd613521610f,0x35469a3a353a66f9
.quad 0x353ca2fc352f2067,0x3556df373549e41f,0x354afbc9353ca2fc,0x3566afbb355901f0,0x355901f03549e41f,0x357603343567b948,0x3566afbb3556df37,0x358268a935760334
.quad 0x3573ff9935638fc3,0x358989083581ec7b,0x3580760f356ff15b,0x35905ed935889a01,0x3586b804357bffb5,0x3596e669358f0707,0x358cc31e3583db51,0x359d1c2c35953084
.quad 0x359294e935898908,0x35a2fcc6359b138d,0x35982b04358f0707,0x35a8850735a0ad5c,0x359d832a35945368,0x35adb1ef35a5fb4c,0x35a29b2e35996c52,0x35b280af35aafadc
.quad 0x35a770fe359e5003,0x35b6eeae35afa9af,0x35ac02a035a2fcc6,0x35baf98335b4058e,0x35b04e3835a770fe,0x35be9eff35b80c6c,0x35b4520835abab1e,0x35c1dd2635bbbc62
.quad 0x35b80c6c35afa9af,0x35c4b23835bf13b1,0x35bb7be135b36b4e,0x35c71cab35c210c7,0x35be9eff35b6eeae,0x35c91b3035c4b238,0x35c1748035ba3296,0x35caacb235c6f6c8
.quad 0x35cccccd35cccccd,0x35cccccd35cccccd,0x35cc858235cc8da6,0x35cc73c135cc7ce0,0x35cbafd435cbd057,0x35cb68e935cb8d5a,0x35ca4c5635ca9556,0x35c9ad2f35c9fef3
.quad 0x35c85c0135c8dd65,0x35c7421335c7d2e4,0x35c5e02f35c6a993,0x35c429b035c50adf,0x35c2da9935c3fb3c,0x35c066b835c1a90f,0x35bf4d5a35c0d407,0x35bbfc7035bdb017
.quad 0x35bb3aec35bd35e5,0x35b6eeae35b92313,0x35b6a62335b92313,0x35b141d735b4058e,0x35b1923235b49e13,0x35aafadc35ae5b88,0x35ac02a035afa9af,0x35a41f3135a8296b
.quad 0x35a5fb4c35aa48f4,0x359cb4cd35a1740f,0x359f806a35a47f35,0x3594c224359a40ae,0x3598967c359e5003,0x358c4e1d359294e9,0x359142533597bf2e,0x35836014358a76bb
.quad 0x358989083590d0c3,0x3573ff993581ec7b,0x35816ffc35898908,0x35606adb3571f9a5,0x3571f9a53581ec7b,0x354c12f5355f5d78,0x35606adb3573ff99,0x35370998354c12f5
.quad 0x354e3fd435638fc3,0x3521610f3538292a,0x353b853435529394,0x350b2c303523afa2,0x3528480735411588,0x34e8fc95350eb659,0x351495b2352f2067,0x34bad62f34f29b58
.quad 0x35007bea351cbf44,0x348c0d4f34c70ca3,0x34d8115e3509fd76,0x34399548349ae293,0x34ae947934edcd1c,0x33b4dd20345c7f3e,0x34849e0a34c70ca3,0xb1a0d96b34028d3d
.quad 0x3434968b349fd168,0xb3c8ef903320d559,0x33bee69334706739,0xb4439166b34907c8,0x3220d93a3420975e,0xb491007ab40c9200,0xb396be4433a0c8f3,0xb4bfba28b4667457
.quad 0x35cccccd35cccccd,0x35cccccd35cccccd,0x35cc600635cc6a23,0x35cc4a5435cc556c,0x35cb1a2735cb4283,0x35cac39035caefd6,0x35c8fc8935c9570a,0x35c83a7335c89dab
.quad 0x35c6096a35c6a993,0x35c4b23835c5619f,0x35c243ef35c33cb1,0x35c02f5f35c13f79,0x35bdb01735bf13b1,0x35bab7a735bc3c09,0x35b852c135ba3296,0x35b4520835b65d28
.quad 0x35b2319e35b49e13,0x35ad06a935afa9af,0x35ab533235ae5b88,0x35a4ded435a8296b,0x35a3bec835a770fe,0x359be4ed359fe51e,0x359b7c6d359fe51e,0x359224663596e669
.quad 0x359294e93597bf2e,0x3587a9aa358d37c9,0x358911af358f0707,0x357904283582e487,0x357df9b63585c511,0x356177b4356ff15b,0x3568c2453578046f,0x3548cbf9355901f0
.quad 0x3552939435638fc3,0x352f206735411588,0x353b8534354e3fd4,0x351495b235284807,0x3523afa23538292a,0x34f29b58350eb659,0x350b2c303521610f,0x34bad62f34e8fc95
.quad 0x34e429d03509fd76,0x348222f834b37cdc,0x34b108e134e429d0,0x341193e2347a57c9,0x347a57c934b37cdc,0x32f142bd340c9200,0x341193e2348222f8,0xb3aad33e32f142bd
.quad 0x3320d5593420975e,0xb4488ec2b3a0c8f3,0xb382a7d633713846,0xb49d5a2eb43e9392,0xb42a97c7b320d559,0xb4d5a47eb495f23f,0xb4899337b40c9200,0xb5066f4cb4cbebe7
.quad 0xb4bd4866b4706739,0xb521610fb5007bea,0xb4f03484b4a9aa67,0xb53b8534b51a6c18,0xb51110bdb4da7db8,0xb554ba6cb533a83f,0xb5296d1fb5053f42,0xb56ce099b54c12f5
.quad 0,0,0x33aad33e33a0c8f3,0x33bee69333b4dd20,0x342a97c73420975e,0x343e93923434968b,0x347f4f2b34706739,0x348e8710348718ca
.quad 0x34a9aa67349fd168,0x34bd486634b37cdc,0x34d3371a34c70ca3,0x34eb652134df54d8,0x34fc30c034edcd1c,0x350c5a9535053f42,0x35123d693509fd76,0x3522888b351a6c18
.quad 0x3525fca2351cbf44,0x3538292a352f2067,0x3539484b352f2067,0x354d29a435434c06,0x354c12f535411588,0x356177b43556df37,0x355e4f8b35529394,0x357501b23569cab3
.quad 0x356ff15b35638fc3,0x3583db51357bffb5,0x3580760f3573ff99,0x358cc31e3586b804,0x35889a013581ec7b,0x35953084358f0707,0x35905ed935898908,0x359d1c2c3596e669
.quad 0x3597bf2e3590d0c3,0x35a47f35359e5003,0x359eb5dd3597bf2e,0x35ab533235a53e0d,0x35a53e0d359e5003,0x35b1923235abab1e,0x35ab533235a47f35,0x35b736c735b19232
.quad 0x35b0f10f35aa48f4,0x35bc3c0935b6eeae,0x35b613bd35afa9af,0x35c09d9b35bbbc62,0x35bab7a735b49e13,0x35c457ac35bff78f,0x35bed99335b92313,0x35c7670035c39ce8
.quad 0x35c276a035bd35e5,0x35c9c8ed35c6a993,0x35c58c4935c0d407,0x35cb7b6035c91b30,0x35c8186a35c3fb3c,0x35cc7ce035caefd6,0x35ca193c35c6a993,0x35cccc8e35cc2618
.quad 0x35cb8d5a35c8dd65,0x35cc6a2335ccbd02,0x35cc73c135ca9556,0x35cb55f535ccb421,0x35cccbd035cbd057,0x35c990f435cc0b7a,0x35cc954b35cc8da6,0x35c71cab35cac390
.quad 0,0,0x33d2f81133c8ef90,0x33e7078633dd000f,0x3452880434488ec2,0x34667457345c7f3e,0x349d5a2e3495f23f,0x34ac1fa534a4beb3
.quad 0x34d0c93434c70ca3,0x34e429d034da7db8,0x3501ad3934f7673d,0x350d88a235079f03,0x351a6c18351369bb,0x352848073521610f,0x353286ed352a91ce,0x35423103353a66f9
.quad 0x3549e41f35411588,0x355b229135529394,0x35606adb3556df37,0x3572fcea3569cab3,0x35760334356bd9dd,0x3584d0d5357ff144,0x35854b1c357ff144,0x358f79fb358a76bb
.quad 0x358f070735898908,0x35996c5235945368,0x35982b04359294e9,0x35a29b2e359d832a,0x35a0ad5c359b138d,0x35aafadc35a5fb4c,0x35a8850735a2fcc6,0x35b280af35adb1ef
.quad 0x35afa9af35aa48f4,0x35b9231335b49e13,0x35b613bd35b0f10f,0x35bed99335bab7a7,0x35bbbc6235b6eeae,0x35c39ce835bff78f,0x35c09d9b35bc3c09,0x35c7670035c457ac
.quad 0x35c4b23835c0d407,0x35ca330735c7d2e4,0x35c7f5e535c4b238,0x35cbfd6e35ca6529,0x35ca652935c7d2e4,0x35ccc3eb35cc0b7a,0x35cbfd6e35ca3307,0x35cc858235ccc3eb
.quad 0x35ccbd0235cbd057,0x35cb428335cc8da6,0x35cca31b35cca946,0x35c8fc8935cb68e9,0x35cbafd435ccbd02,0x35c5b67935c9570a,0x35c9e42e35cc0b7a,0x35c1748035c65a74
.quad 0x35c7421335ca9556,0x35bc3c0935c276a0,0x35c3cc4e35c85c01,0x35b613bd35bdb017,0x35bf868d35c5619f,0x35af037335b80c6c,0x35ba755835c1a90f,0x35a7142c35b19232
.quad 0x35cccccd35cccccd,0x35cccccd35cccccd,0x35cc32aa35cc3ebe,0x35cc190735cc2618,0x35ca652935ca9556,0x35c9fef335ca3307,0x35c7670035c7d2e4,0x35c6824135c6f6c8
.quad 0x35c33cb135c3fb3c,0x35c1a90f35c276a0,0x35bdec8135bf13b1,0x35bb7be135bcb9e0,0x35b77e6f35b92313,0x35b4058e35b5c9e1,0x35affc2a35b2319e,0x35ab533235adb1ef
.quad 0x35a770fe35aa48f4,0x35a1740f35a47f35,0x359de9c735a1740f,0x3596797a359a40ae,0x359374de3597bf2e,0x358a76bb358f0707,0x35882200358d37c9,0x357b01cb3582e487
.quad 0x3578046f3581ec7b,0x355f5d78356bd9dd,0x355e4f8b356bd9dd,0x3542310335506ab5,0x35434c0635529394,0x3523afa23533a83f,0x352722883538292a,0x35040ee53515c14d
.quad 0x3509fd76351cbf44,0x34c70ca334edcd1c,0x34d8115e35007bea,0x34849e0a34ae9479,0x349ae29334c70ca3,0x34028d3d345c7f3e,0x34399548348c0d4f,0xb1a0d96b33b4dd20
.quad 0x337138463420975e,0xb40c9200b320d559,0xb382a7d63320d559,0xb4899337b42a97c7,0xb43e9392b3a0c8f3,0xb4cbebe7b495f23f,0xb49d5a2eb4488ec2,0xb5066f4cb4d5a47e
.quad 0xb4da7db8b49fd168,0xb525fca2b509fd76,0xb50b2c30b4da7db8,0xb5446691b5284807,0xb5284807b509fd76,0xb56177b4b54580a2,0xb5446691b525fca2,0xb57cfd04b56177b4
.quad 0xb55f5d78b5411588,0xb58b6318b57bffb5,0xb5790428b55b2291,0xb59752fab58a76bb,0xb5889a01b573ff99,0xb5a23933b5960c2f,0xb593e451b585c511,0xb5ac02a0b5a0ad5c
.quad 0x35cccccd35cccccd,0x35cccccd35cccccd,0x35cbfd6e35cc0b7a,0x35cbdfdd35cbeee4,0x35c990f435c9c8ed,0x35c91b3035c9570a,0x35c58c4935c6096a,0x35c4852f35c50adf
.quad 0x35bff78f35c0d407,0x35be287635bf13b1,0x35b8de1435ba3296,0x35b613bd35b77e6f,0x35b04e3835b2319e,0x35ac59b835ae5b88,0x35a6595335a8e03a,0x35a110e735a3bec8
.quad 0x359b138d359e5003,0x359453683597bf2e,0x358e93bb359294e9,0x35863eb4358a76bb,0x3580f32d3585c511,0x356de6c23578046f,0x35649af8356ff15b,0x354d29a4355901f0
.quad 0x354580a235529394,0x352a91ce3538292a,0x3524d6553533a83f,0x35066f4c3515c14d,0x3502de37351369bb,0x34c22b7434e429d0,0x34bfba2834e429d0,0x346b6e11349ae293
.quad 0x34706739349fd168,0x33a0c8f33420975e,0x33bee6933434968b,0xb396be443220d93a,0xb34907c83320d559,0xb4667457b40c9200,0xb4439166b3c8ef90,0xb4bfba28b491007a
.quad 0xb4a9aa67b4706739,0xb5053f42b4da7db8,0xb4f03484b4bd4866,0xb5296d1fb51110bd,0xb51a6c18b5007bea,0xb54c12f5b533a83f,0xb53b8534b521610f,0xb56ce099b554ba6c
.quad 0xb55b2291b5411588,0xb585c511b573ff99,0xb5790428b55f5d78,0xb593e451b5889a01,0xb58a76bbb57bffb5,0xb5a0ad5cb5960c2f,0xb59752fab58b6318,0xb5ac02a0b5a23933
.quad 0xb5a2fcc6b597bf2e,0xb5b5c9e1b5ad06a9,0xb5ad5c81b5a2fcc6,0xb5bdec81b5b65d28,0xb5b65d28b5ad06a9,0xb5c457acb5be2876,0xb5bdec81b5b5c9e1,0xb5c8fc89b5c457ac
.quad 0,0,0x33fb14c133f10e6e,0x34078fc834028d3d,0x347a57c934706739,0x348718ca348222f8,0x34bad62f34b37cdc,0x34c97c8334c22b74
.quad 0x34f7673d34edcd1c,0x35053f4235007bea,0x351941f2351369bb,0x3524d655351f10ee,0x3535e995352f2067,0x35434c06353ca2fc,0x35517f653549e41f,0x35606adb355901f0
.quad 0x356bd9dd35638fc3,0x357bffb53573ff99,0x358268a9357bffb5,0x358aed143586b804,0x358e201735898908,0x3596e669359294e9,0x3599019735945368,0x35a1d6d2359d832a
.quad 0x35a2fcc6359e5003,0x35abab1e35a770fe,0x35ac02a035a770fe,0x35b4520835b04e38,0x35b4058e35afa9af,0x35bbbc6235b80c6c,0x35baf98335b6eeae,0x35c1dd2635be9eff
.quad 0x35c0d40735bd35e5,0x35c6a99335c3fb3c,0x35c58c4935c276a0,0x35ca193c35c8186a,0x35c91b3035c6a993,0x35cc261835caefd6,0x35cb7b6035c9c8ed,0x35cccc8e35cc7ce0
.quad 0x35cca94635cbd057,0x35cc0b7a35ccbd02,0x35cca31b35ccbd02,0x35c9e42e35cbafd4,0x35cb68e935cc8da6,0x35c65a7435c9570a,0x35c8fc8935cb4283,0x35c1748035c5b679
.quad 0x35c5619f35c8dd65,0x35bb3aec35c0d407,0x35c09d9b35c5619f,0x35b3b8a635bab7a7,0x35bab7a735c0d407,0x35aafadc35b36b4e,0x35b3b8a635bb3aec,0x35a110e735aafadc
.quad 0x35abab1e35b49e13,0x35960c2f35a1740f,0x35a29b2e35ad06a9,0x358a000c3596e669,0x3598967c35a47f35,0x357a0347358b6318,0x358dac1c359b138d,0x355e4f8b357df9b6
.quad 0,0,0x341193e2340c9200,0x341b969434169569,0x3491007a348c0d4f,0x349ae2933495f23f,0x34d8115e34d0c934,0x34e6937a34df54d8
.quad 0x350eb6593509fd76,0x3518176e351369bb,0x35304301352a91ce,0x353b85343535e995,0x35506ab53549e41f,0x355d41163556df37,0x356eec583567b948,0x357cfd0435760334
.quad 0x3585c5113581ec7b,0x358d37c935898908,0x35930511358f0707,0x359aaa4d3596e669,0x359f1b54359b138d,0x35a6b6f335a2fcc6,0x35a9ef6335a5fb4c,0x35b141d735adb1ef
.quad 0x35b36b4e35afa9af,0x35ba329635b6eeae,0x35bb7be135b80c6c,0x35c1748035be9eff,0x35c210c735bf13b1,0x35c6f6c835c4b238,0x35c71cab35c4b238,0x35caacb235c91b30
.quad 0x35ca955635c8dd65,0x35cc8da635cbd057,0x35cc73c135cb8d5a,0x35cc954b35cccbd0,0x35ccb42135ccbd02,0x35cac39035cc0b7a,0x35cb55f535cc6a23,0x35c71cab35c990f4
.quad 0x35c85c0135ca9556,0x35c1a90f35c5619f,0x35c3cc4e35c74213,0x35ba755835bf868d,0x35bdb01735c276a0,0x35b1923235b80c6c,0x35b613bd35bc3c09,0x35a7142c35af0373
.quad 0x35ad06a935b49e13,0x359b138d35a47f35,0x35a29b2e35abab1e,0x358dac1c3598967c,0x3596e66935a1740f,0x357df9b6358b6318,0x358a000c35960c2f,0x355e4f8b357a0347
.quad 0x3578046f35898908,0x353ca2fc355b2291,0x355a12843578046f,0x351941f2353a66f9,0x353a66f9355b2291,0x34e8fc953518176e,0x351941f2353ca2fc,0x349d5a2e34e8fc95
.quad 0x35cbd05735cccccd,0x35c3fb3c35c8dd65,0x35cbc05435cccccd,0x35c36d0935c89dab,0x35cbafd435cccccd,0x35c2da9935c85c01,0x35cb9ed535cccccd,0x35c243ef35c8186a
.quad 0x35cb8d5a35cccccd,0x35c1a90f35c7d2e4,0x35cb7b6035cccccd,0x35c109fb35c78b72,0x35cb68e935cccccd,0x35c066b835c74213,0x35cb55f535cccccd,0x35bfbf4935c6f6c8
.quad 0x35cb428335cccccd,0x35bf13b135c6a993,0x35cb2e9435cccccd,0x35be63f535c65a74,0x35cb1a2735cccccd,0x35bdb01735c6096a,0x35cb053d35cccccd,0x35bcf81d35c5b679
.quad 0x35caefd635cccccd,0x35bc3c0935c5619f,0x35cad9f235cccccd,0x35bb7be135c50adf,0x35cac39035cccccd,0x35bab7a735c4b238,0x35caacb235cccccd,0x35b9ef6135c457ac
.quad 0x35ca955635cccccd,0x35b9231335c3fb3c,0x35ca7d7e35cccccd,0x35b852c135c39ce8,0x35ca652935cccccd,0x35b77e6f35c33cb1,0x35ca4c5635cccccd,0x35b6a62335c2da99
.quad 0x35ca330735cccccd,0x35b5c9e135c276a0,0x35ca193c35cccccd,0x35b4e9ae35c210c7,0x35c9fef335cccccd,0x35b4058e35c1a90f,0x35c9e42e35cccccd,0x35b31d8735c13f79
.quad 0x35c9c8ed35cccccd,0x35b2319e35c0d407,0x35c9ad2f35cccccd,0x35b141d735c066b8,0x35c990f435cccccd,0x35b04e3835bff78f,0x35c9743e35cccccd,0x35af56c735bf868d
.quad 0x35c9570a35cccccd,0x35ae5b8835bf13b1,0x35c9395b35cccccd,0x35ad5c8135be9eff,0x35c91b3035cccccd,0x35ac59b835be2876,0x35c8fc8935cccccd,0x35ab533235bdb017
.quad 0x35b49e1335bd35e5,0x359e500335aa48f4,0x35b31d8735bc3c09,0x359b7c6d35a8296b,0x35b1923235bb3aec,0x3598967c35a5fb4c,0x35affc2a35ba3296,0x35959e8835a3bec8
.quad 0x35ae5b8835b92313,0x359294e935a1740f,0x35acb06535b80c6c,0x358f79fb359f1b54,0x35aafadc35b6eeae,0x358c4e1d359cb4cd,0x35a93b0635b5c9e1,0x358911af359a40ae
.quad 0x35a770fe35b49e13,0x3585c5113597bf2e,0x35a59ce035b36b4e,0x358268a935953084,0x35a3bec835b2319e,0x357df9b6359294e9,0x35a1d6d235b0f10f,0x3577041e358fec97
.quad 0x359fe51e35afa9af,0x356ff15b358d37c9,0x359de9c735ae5b88,0x3568c245358a76bb,0x359be4ed35ad06a9,0x356177b43587a9aa,0x3599d6b035abab1e,0x355a12843584d0d5
.quad 0x3597bf2e35aa48f4,0x355293943581ec7b,0x35959e8835a8e03a,0x354afbc9357df9b6,0x359374de35a770fe,0x35434c063578046f,0x3591425335a5fb4c,0x353b85343571f9a5
.quad 0x358f070735a47f35,0x3533a83f356bd9dd,0x358cc31e35a2fcc6,0x352bb6143565a5a1,0x358a76bb35a1740f,0x3523afa2355f5d78,0x35882200359fe51e,0x351b95de355901f0
.quad 0x3585c511359e5003,0x351369bb35529394,0x35836014359cb4cd,0x350b2c30354c12f5,0x3580f32d359b138d,0x3502de37354580a2,0x357cfd0435996c52,0x34f50196353edd2d
.quad 0x3578046f3597bf2e,0x34e429d03538292a,0x3572fcea35960c2f,0x34d3371a3531652e,0x356de6c235945368,0x34c22b74352a91ce,0x3568c245359294e9,0x34b108e13523afa2
.quad 0x3420975e00000000,0x34edcd1c349fd168,0x342597c600000000,0x34f5019634a4beb3,0x342a97c700000000,0x34fc30c034a9aa67,0x342f976000000000,0x3501ad3934ae9479
.quad 0x3434968b00000000,0x35053f4234b37cdc,0x3439954800000000,0x3508ce6734b86384,0x343e939200000000,0x350c5a9534bd4866,0x3443916600000000,0x350fe3b734c22b74
.quad 0x34488ec200000000,0x351369bb34c70ca3,0x344d8ba200000000,0x3516ec8c34cbebe7,0x3452880400000000,0x351a6c1834d0c934,0x345783e300000000,0x351de84a34d5a47e
.quad 0x345c7f3e00000000,0x3521610f34da7db8,0x34617a1000000000,0x3524d65534df54d8,0x3466745700000000,0x3528480734e429d0,0x346b6e1100000000,0x352bb61434e8fc95
.quad 0x3470673900000000,0x352f206734edcd1c,0x34755fcc00000000,0x353286ed34f29b58,0x347a57c900000000,0x3535e99534f7673d,0x347f4f2b00000000,0x3539484b34fc30c0
.quad 0x348222f800000000,0x353ca2fc35007bea,0x34849e0a00000000,0x353ff9963502de37,0x348718ca00000000,0x35434c0635053f42,0x3489933700000000,0x35469a3a35079f03
.quad 0x348c0d4f00000000,0x3549e41f3509fd76,0x348e871000000000,0x354d29a4350c5a95,0x3491007a00000000,0x35506ab5350eb659,0x3493798a00000000,0x3553a742351110bd
.quad 0x3495f23f00000000,0x3556df37351369bb,0x34986a9800000000,0x355a12843515c14d,0x349ae29300000000,0x355d41163518176e,0x349d5a2e00000000,0x35606adb351a6c18
.quad 0x35411588351cbf44,0x3581ec7b35638fc3,0x35469a3a3521610f,0x35854b1c3569cab3,0x354c12f53525fca2,0x35889a01356ff15b,0x35517f65352a91ce,0x358bd8c635760334
.quad 0x3556df37352f2067,0x358f0707357bffb5,0x355c32173533a83f,0x359224663580f32d,0x356177b43538292a,0x359530843583db51,0x3566afbb353ca2fc,0x35982b043586b804
.quad 0x356bd9dd35411588,0x359b138d35898908,0x3570f5cb354580a2,0x359de9c7358c4e1d,0x357603343549e41f,0x35a0ad5c358f0707,0x357b01cb354e3fd4,0x35a35df93591b389
.quad 0x357ff14435529394,0x35a5fb4c35945368,0x358268a93556df37,0x35a885073596e669,0x3584d0d5355b2291,0x35aafadc35996c52,0x35873101355f5d78,0x35ad5c81359be4ed
.quad 0x3589890835638fc3,0x35afa9af359e5003,0x358bd8c63567b948,0x35b1e21f35a0ad5c,0x358e2017356bd9dd,0x35b4058e35a2fcc6,0x35905ed9356ff15b,0x35b613bd35a53e0d
.quad 0x359294e93573ff99,0x35b80c6c35a770fe,0x3594c2243578046f,0x35b9ef6135a99568,0x3596e669357bffb5,0x35bbbc6235abab1e,0x35990197357ff144,0x35bd733935adb1ef
.quad 0x359b138d3581ec7b,0x35bf13b135afa9af,0x359d1c2c3583db51,0x35c09d9b35b19232,0x359f1b543585c511,0x35c210c735b36b4e,0x35a110e73587a9aa,0x35c36d0935b534da
.quad 0x35a2fcc635898908,0x35c4b23835b6eeae,0x35a4ded4358b6318,0x35c5e02f35b898a3,0x35a6b6f3358d37c9,0x35c6f6c835ba3296,0x35a88507358f0707,0x35c7f5e535bbbc62
.quad 0x3581ec7b3590d0c3,0x3541158835638fc3,0x357b01cb358d37c9,0x3534c922355901f0,0x3571f9a535898908,0x35284807354e3fd4,0x3568c2453585c511,0x351b95de35434c06
.quad 0x355f5d783581ec7b,0x350eb6593538292a,0x3555cd14357bffb5,0x3501ad39352cd9f0,0x354c12f53573ff99,0x34e8fc953521610f,0x35423103356bd9dd,0x34ce5acd3515c14d
.quad 0x3538292a35638fc3,0x34b37cdc3509fd76,0x352dfd61355b2291,0x34986a9834fc30c0,0x3523afa235529394,0x347a57c934e429d0,0x351941f23549e41f,0x3443916634cbebe7
.quad 0x350eb65935411588,0x340c920034b37cdc,0x35040ee53538292a,0x33aad33e349ae293,0x34f29b58352f2067,0x32f142bd348222f8,0x34dce98c3525fca2,0xb2c90dd634528804
.quad 0x34c70ca3351cbf44,0xb3a0c8f33420975e,0x34b108e1351369bb,0xb4078fc833dd000f,0x349ae2933509fd76,0xb43e939233713846,0x34849e0a35007bea,0xb4755fcc3220d93a
.quad 0x345c7f3e34edcd1c,0xb495f23fb320d559,0x342f976034da7db8,0xb4b108e1b3b4dd20,0x34028d3d34c70ca3,0xb4cbebe7b40c9200,0x33aad33e34b37cdc,0xb4e6937ab43e9392
.quad 0x3320d559349fd168,0xb5007beab4706739,0xb1a0d96b348c0d4f,0xb50d88a2b491007a,0xb34907c834706739,0xb51a6c18b4a9aa67,0xb3bee69334488ec2,0xb5272288b4c22b74
.quad 0xb40c92003420975e,0xb533a83fb4da7db8,0xb439954833f10e6e,0xb53ff996b4f29b58,0xb466745733a0c8f3,0xb54c12f5b5053f42,0xb48993373320d559,0xb557f0d6b51110bd
.quad 0x34edcd1c351cbf44,0x3420975e349fd168,0x34ce5acd350eb659,0x33aad33e347a57c9,0x34ae947935007bea,0x3220d93a3434968b,0x348e871034e429d0,0xb382a7d633dd000f
.quad 0x345c7f3e34c70ca3,0xb40c92003320d559,0x341b969434a9aa67,0xb45783e3b2f142bd,0x33b4dd20348c0d4f,0xb491007ab3c8ef90,0x32c90dd6345c7f3e,0xb4b5f068b42a97c7
.quad 0xb320d5593420975e,0xb4da7db8b4706739,0xb3d2f81133c8ef90,0xb4fe9498b49ae293,0xb42a97c73320d559,0xb51110bdb4bd4866,0xb46b6e11b2a0d873,0xb522888bb4df54d8
.quad 0xb495f23fb3a0c8f3,0xb533a83fb5007bea,0xb4b5f068b40c9200,0xb5446691b51110bd,0xb4d5a47eb4488ec2,0xb554ba6cb521610f,0xb4f50196b48222f8,0xb5649af8b531652e
.quad 0xb509fd76b49fd168,0xb573ff99b5411588,0xb51941f2b4bd4866,0xb5816ffcb5506ab5,0xb5284807b4da7db8,0xb5889a01b55f5d78,0xb5370998b4f7673d,0xb58f79fbb56de6c2
.quad 0xb54580a2b509fd76,0xb5960c2fb57bffb5,0xb553a742b518176e,0xb59c4d0eb584d0d5,0xb56177b4b525fca2,0xb5a23933b58b6318,0xb56eec58b533a83f,0xb5a7cd68b591b389
.quad 0xb57bffb5b5411588,0xb5ad06a9b597bf2e,0xb584563cb54e3fd4,0xb5b1e21fb59d832a,0xb58a76bbb55b2291,0xb5b65d28b5a2fcc6,0xb5905ed9b567b948,0xb5ba7558b5a8296b
.quad 0xb5960c2fb573ff99,0xb5be2876b5ad06a9,0xb59b7c6db57ff144,0xb5c17480b5b19232,0xb5a0ad5cb585c511,0xb5c457acb5b5c9e1,0xb5a59ce0b58b6318,0xb5c6d06bb5b9abba
.quad 0x359e50033590d0c3,0x35b49e1335aa48f4,0x35a1d6d235945368,0x35b7c5a735adb1ef,0x35a53e0d3597bf2e,0x35bab7a735b0f10f,0x35a88507359b138d,0x35bd733935b4058e
.quad 0x35abab1e359e5003,0x35bff78f35b6eeae,0x35aeafb335a1740f,0x35c243ef35b9abba,0x35b1923235a47f35,0x35c457ac35bc3c09,0x35b4520835a770fe,0x35c6322c35be9eff
.quad 0x35b6eeae35aa48f4,0x35c7d2e435c0d407,0x35b9679f35ad06a9,0x35c9395b35c2da99,0x35bbbc6235afa9af,0x35ca652935c4b238,0x35bdec8135b2319e,0x35cb55f535c65a74
.quad 0x35bff78f35b49e13,0x35cc0b7a35c7d2e4,0x35c1dd2635b6eeae,0x35cc858235c91b30,0x35c39ce835b92313,0x35ccc3eb35ca3307,0x35c5367c35bb3aec,0x35ccc6a235cb1a27
.quad 0x35c6a99335bd35e5,0x35cc8da635cbd057,0x35c7f5e535bf13b1,0x35cc190735cc556c,0x35c91b3035c0d407,0x35cb68e935cca946,0x35ca193c35c276a0,0x35ca7d7e35cccbd0
.quad 0x35caefd635c3fb3c,0x35c9570a35ccbd02,0x35cb9ed535c5619f,0x35c7f5e535cc7ce0,0x35cc261835c6a993,0x35c65a7435cc0b7a,0x35cc858235c7d2e4,0x35c4852f35cb68e9
.quad 0x35ccbd0235c8dd65,0x35c276a035ca9556,0x35cccc8e35c9c8ed,0x35c02f5f35c990f4,0x35ccb42135ca9556,0x35bdb01735c85c01,0x35cc73c135cb4283,0x35baf98335c6f6c8
.quad 0x35cc0b7a35cbd057,0x35b80c6c35c5619f,0x35cb7b6035cc3ebe,0x35b4e9ae35c39ce8,0x35cac39035cc8da6,0x35b1923235c1a90f,0x35c9e42e35ccbd02,0x35ae06f135bf868d
.quad 0x35c3fb3c35bd35e5,0x35cbd05735c8dd65,0x35c6322c35bff78f,0x35cc858235ca6529,0x35c8186a35c276a0,0x35cccbd035cb8d5a,0x35c9ad2f35c4b238,0x35cca31b35cc556c
.quad 0x35caefd635c6a993,0x35cc0b7a35ccbd02,0x35cbdfdd35c85c01,0x35cb053d35ccc3eb,0x35cc7ce035c9c8ed,0x35c990f435cc6a23,0x35ccc6a235caefd6,0x35c7af6935cbafd4
.quad 0x35ccbd0235cbd057,0x35c5619f35ca9556,0x35cc600635cc6a23,0x35c2a8d835c91b30,0x35cbafd435ccbd02,0x35bf868d35c74213,0x35caacb235ccc8da,0x35bbfc7035c50adf
.quad 0x35c9570a35cc8da6,0x35b80c6c35c276a0,0x35c7af6935cc0b7a,0x35b3b8a635bf868d,0x35c5b67935cb4283,0x35af037335bc3c09,0x35c36d0935ca3307,0x35a9ef6335b898a3
.quad 0x35c0d40735c8dd65,0x35a47f3535b49e13,0x35bdec8135c74213,0x359eb5dd35b04e38,0x35bab7a735c5619f,0x3598967c35abab1e,0x35b736c735c33cb1,0x3592246635a6b6f3
.quad 0x35b36b4e35c0d407,0x358b631835a1740f,0x35af56c735be2876,0x3584563c359be4ed,0x35aafadc35bb3aec,0x357a034735960c2f,0x35a6595335b80c6c,0x356ad291358fec97
.quad 0x35a1740f35b49e13,0x355b229135898908,0x359c4d0e35b0f10f,0x354afbc93582e487,0x3596e66935ad06a9,0x353a66f93578046f,0x3591425335a8e03a,0x35296d1f3569cab3
.quad 0x358b631835a47f35,0x3518176e355b2291,0x35854b1c359fe51e,0x35066f4c354c12f5,0x357df9b6359b138d,0x34e8fc95353ca2fc,0x3570f5cb35960c2f,0x34c49c48352cd9f0
.quad 0xb420975e1ae1e84f,0xb4edcd1cb49fd168,0xb4755fccb3a0c8f3,0xb50d88a2b4cbebe7,0xb4a4beb3b420975e,0xb523afa2b4f7673d,0xb4ce5acdb4706739,0xb539484bb51110bd
.quad 0xb4f7673db49fd168,0xb54e3fd4b525fca2,0xb50fe3b7b4c70ca3,0xb5628401b53a66f9,0xb523afa2b4edcd1c,0xb5760334b54e3fd4,0xb5370998b509fd76,0xb584563cb56177b4
.quad 0xb549e41fb51cbf44,0xb58d37c9b573ff99,0xb55c3217b52f2067,0xb5959e88b582e487,0xb56de6c2b5411588,0xb59d832ab58b6318,0xb57ef5ccb5529394,0xb5a4ded4b59374de
.quad 0xb587a9aab5638fc3,0xb5abab1eb59b138d,0xb58f79fbb573ff99,0xb5b1e21fb5a23933,0xb596e669b581ec7b,0xb5b77e6fb5a8e03a,0xb59de9c7b5898908,0xb5bc7b2fb5af0373
.quad 0xb5a47f35b590d0c3,0xb5c0d407b5b49e13,0xb5aaa21db597bf2e,0xb5c4852fb5b9abba,0xb5b04e38b59e5003,0xb5c78b72b5be2876,0xb5b57f95b5a47f35,0xb5c9e42eb5c210c7
.quad 0xb5ba3296b5aa48f4,0xb5cb8d5ab5c5619f,0xb5be63f5b5afa9af,0xb5cc8582b5c8186a,0xb5c210c7b5b49e13,0xb5cccbd0b5ca3307,0xb5c5367cb5b92313,0xb5cc6006b5cbafd4
.quad 0xb5c7d2e4b5bd35e5,0xb5cb4283b5cc8da6,0xb5c9e42eb5c0d407,0xb5c9743eb5cccbd0,0xb5cb68e9b5c3fb3c,0xb5c6f6c8b5cc6a23,0xb5cc6006b5c6a993,0xb5c3cc4eb5cb68e9
.quad 0xb5ccc8dab5c8dd65,0xb5bff78fb5c9c8ed,0xb5cca31bb5ca9556,0xb5bb7be1b5c78b72,0xb5cbeee4b5cbd057,0xb5b65d28b5c4b238,0xb5caacb2b5cc8da6,0xb5b09fdab5c13f79
.quad 0xb5411588b51cbf44,0xb581ec7bb5638fc3,0xb557f0d6b533a83f,0xb58cc31eb57a0347,0xb56de6c2b549e41f,0xb596e669b587a9aa,0xb5816ffcb55f5d78,0xb5a0496eb591b389
.quad 0xb58b6318b573ff99,0xb5a8e03ab59b138d,0xb594c224b583db51,0xb5b09fdab5a3bec8,0xb59d832ab58d37c9,0xb5b77e6fb5abab1e,0xb5a59ce0b5960c2f,0xb5bd7339b5b2cf52
.quad 0xb5ad06a9b59e5003,0xb5c276a0b5b92313,0xb5b3b8a6b5a5fb4c,0xb5c68241b5be9eff,0xb5b9abbab5ad06a9,0xb5c990f4b5c33cb1,0xb5bed993b5b36b4e,0xb5cb9ed5b5c6f6c8
.quad 0xb5c33cb1b5b92313,0xb5cca946b5c9c8ed,0xb5c6d06bb5be2876,0xb5ccaef3b5cbafd4,0xb5c990f4b5c276a0,0xb5cbafd4b5cca946,0xb5cb7b60b5c6096a,0xb5c9ad2fb5ccb421
.quad 0xb5cc8da6b5c8dd65,0xb5c6a993b5cbd057,0xb5ccc6a2b5caefd6,0xb5c2a8d8b5c9fef3,0xb5cc2618b5cc3ebe,0xb5bdb017b5c74213,0xb5caacb2b5ccc8da,0xb5b7c5a7b5c39ce8
.quad 0xb5c85c01b5cc8da6,0xb5b0f10fb5bf13b1,0xb5c5367cb5cb8d5a,0xb5a93b06b5b9abba,0xb5c13f79b5c9c8ed,0xb5a0ad5cb5b36b4e,0xb5bc7b2fb5c74213,0xb59752fab5ac59b8
.quad 0xb5b6eeaeb5c3fb3c,0xb58d37c9b5a47f35,0xb5b09fdab5bff78f,0xb58268a9b59be4ed,0xb5a99568b5bb3aec,0xb56de6c2b59294e9,0xb5a1d6d2b5b5c9e1,0xb555cd14b5889a01
.quad 0xb5996c52b5afa9af,0xb53ca2fcb57bffb5,0xb5905ed9b5a8e03a,0xb522888bb565a5a1,0xb586b804b5a1740f,0xb5079f03b54e3fd4,0xb5790428b5996c52,0xb4d8115eb535e995
.quad 0x35cbd05735cccccd,0x35c3fb3c35c8dd65,0x35ca7d7e35cc8da6,0x35c02f5f35c65a74,0x35c89dab35cbd057,0x35bbbc6235c33cb1,0x35c6322c35ca9556,0x35b6a62335bf868d
.quad 0x35c33cb135c8dd65,0x35b0f10f35bb3aec,0x35bfbf4935c6a993,0x35aaa21d35b65d28,0x35bbbc6235c3fb3c,0x35a3bec835b0f10f,0x35b736c735c0d407,0x359c4d0e35aafadc
.quad 0x35b2319e35bd35e5,0x3594536835a47f35,0x35acb06535b92313,0x358bd8c6359d832a,0x35a6b6f335b49e13,0x3582e48735960c2f,0x35a0496e35afa9af,0x3572fcea358e2017
.quad 0x35996c5235aa48f4,0x355f5d783585c511,0x3592246635a47f35,0x354afbc9357a0347,0x358a76bb359e5003,0x3535e9953567b948,0x358268a93597bf2e,0x352039303554ba6c
.quad 0x3573ff993590d0c3,0x3509fd7635411588,0x3562840135898908,0x34e6937a352cd9f0,0x35506ab53581ec7b,0x34b863843518176e,0x353dc04f3573ff99,0x348993373502de37
.quad 0x352a91ce35638fc3,0x3434968b34da7db8,0x3516ec8c35529394,0x33aad33e34ae9479,0x3502de3735411588,0xb220d93a348222f8,0x34dce98c352f2067,0xb3d2f811342a97c7
.quad 0x34b37cdc351cbf44,0xb4488ec233a0c8f3,0x348993373509fd76,0xb493798ab220d93a,0x343e939234edcd1c,0xb4c22b74b3c8ef90,0x33d2f81134c70ca3,0xb4f03484b43e9392
.quad 0x32a0d873349fd168,0xb50eb659b48c0d4f,0xb382a7d634706739,0xb524d655b4b86384,0xb41695693420975e,0xb53a66f9b4e429d0,0xb46b6e1133a0c8f3,0xb54f5584b5079f03
.quad 0x35b49e1335bd35e5,0x359e500335aa48f4,0x35ae06f135b80c6c,0x3594c22435a23933,0x35a6b6f335b2319e,0x358a76bb35996c52,0x359eb5dd35abab1e,0x357ef5cc358fec97
.quad 0x35960c2f35a47f35,0x3567b9483585c511,0x358cc31e359cb4cd,0x354f558435760334,0x3582e48735945368,0x3535e995355f5d78,0x3570f5cb358b6318,0x351b95de3547b357
.quad 0x355b22913581ec7b,0x35007bea352f2067,0x35446691356ff15b,0x34c97c833515c14d,0x352cd9f0355b2291,0x3491007a34f7673d,0x351495b2354580a2,0x342f976034c22b74
.quad 0x34f7673d352f2067,0x33713846348c0d4f,0x34c49c483518176e,0xb35d204b342a97c7,0x3491007a35007bea,0xb42a97c733713846,0x3439954834d0c934,0xb48e8710b34907c8
.quad 0x33a0c8f3349fd168,0xb4c70ca3b420975e,0xb2c90dd6345c7f3e,0xb4fe9498b48718ca,0xb4028d3d33f10e6e,0xb51a6c18b4bd4866,0xb46b6e1132a0d873,0xb534c922b4f29b58
.quad 0xb4a9aa67b3a0c8f3,0xb54e3fd4b51369bb,0xb4dce98cb434968b,0xb566afbbb52cd9f0,0xb5079f03b48c0d4f,0xb57df9b6b54580a2,0xb5203930b4bd4866,0xb58a000cb55d4116
.quad 0xb538292ab4edcd1c,0xb5945368b573ff99,0xb54f5584b50eb659,0xb59de9c7b584d0d5,0xb565a5a1b525fca2,0xb5a6b6f3b58f0707,0xb57b01cbb53ca2fc,0xb5aeafb3b598967c
.quad 0xb587a9aab5529394,0xb5b5c9e1b5a1740f,0xb5914253b567b948,0xb5bbfc70b5a99568,0xb59a40aeb57bffb5,0xb5c13f79b5b0f10f,0xb5a29b2eb587a9aa,0xb5c58c49b5b77e6f
.quad 0xb59e5003b590d0c3,0xb5b49e13b5aa48f4,0xb5a7cd68b59b138d,0xb5bbfc70b5b2cf52,0xb5b04e38b5a47f35,0xb5c210c7b5ba3296,0xb5b7c5a7b5ad06a9,0xb5c6d06bb5c066b8
.quad 0xb5be2876b5b49e13,0xb5ca3307b5c5619f,0xb5c36d09b5bb3aec,0xb5cc32aab5c91b30,0xb5c78b72b5c0d407,0xb5cccbd0b5cb8d5a,0xb5ca7d7eb5c5619f,0xb5cbfd6eb5ccb421
.quad 0xb5cc3ebeb5c8dd65,0xb5c9c8edb5cc8da6,0xb5cccc8eb5cb4283,0xb5c6322cb5cb1a27,0xb5cc2618b5cc8da6,0xb5c13f79b5c85c01,0xb5ca4c56b5ccbd02,0xb5baf983b5c457ac
.quad 0xb5c74213b5cbd057,0xb5b36b4eb5bf13b1,0xb5c30be1b5c9c8ed,0xb5aaa21db5b898a3,0xb5bdb017b5c6a993,0xb5a0ad5cb5b0f10f,0xb5b736c7b5c276a0,0xb5959e88b5a8296b
.quad 0xb5afa9afb5bd35e5,0xb5898908b59e5003,0xb5a7142cb5b6eeae,0xb5790428b59374de,0xb59d832ab5afa9af,0xb55d4116b587a9aa,0xb5930511b5a770fe,0xb53ff996b5760334
.quad 0xb587a9aab59e5003,0xb521610fb55b2291,0xb577041eb5945368,0xb501ad39b53edd2d,0xb55d4116b5898908,0xb4c22b74b521610f,0xb5423103b57bffb5,0xb47f4f2bb502de37
.quad 0xb525fca2b5638fc3,0xb3f10e6eb4c70ca3,0xb508ce67b549e41f,0x3271455ab48718ca,0xb4d5a47eb52f2067,0x34169569b40c9200,0xb4986a98b51369bb,0x348e8710b220d93a
.quad 0xb434968bb4edcd1c,0x34d0c93433f10e6e,0xb35d204bb4b37cdc,0x3508ce67347a57c9,0x338cb338b4706739,0x3528480734bd4866,0x34439166b3f10e6e,0x35469a3a34fc30c0
.quad 0xb5c3fb3cb5bd35e5,0xb5cbd057b5c8dd65,0xb5c87d14b5c33cb1,0xb5cccc8eb5cbafd4,0xb5cb68e9b5c7d2e4,0xb5cbeee4b5ccc8da,0xb5ccb8d1b5caefd6,0xb5c9395bb5cc2618
.quad 0xb5cc6a23b5cc8da6,0xb5c4b238b5c9c8ed,0xb5ca7d7eb5cca946,0xb5be63f5b5c5b679,0xb5c6f6c8b5cb4283,0xb5b65d28b5bff78f,0xb5c1dd26b5c85c01,0xb5acb065b5b898a3
.quad 0xb5bb3aecb5c3fb3c,0xb5a1740fb5afa9af,0xb5b31d87b5be2876,0xb594c224b5a53e0d,0xb5a99568b5b6eeae,0xb586b804b5996c52,0xb59eb5ddb5ae5b88,0xb56eec58b58c4e1d
.quad 0xb59294e9b5a47f35,0xb54e3fd4b57bffb5,0xb5854b1cb5996c52,0xb52bb614b55d4116,0xb56de6c2b58d37c9,0xb5079f03b53ca2fc,0xb54f5584b57ff144,0xb4c49c48b51a6c18
.quad 0xb52f2067b5638fc3,0xb4706739b4edcd1c,0xb50d88a2b54580a2,0xb3aad33eb4a4beb3,0xb4d5a47eb525fca2,0x338cb338b434968b,0xb48e8710b5053f42,0x34617a10b2f142bd
.quad 0xb40c9200b4c70ca3,0x34bd486633f10e6e,0x31a0d96bb48222f8,0x35040ee5348718ca,0x34169569b3f10e6e,0x3528480734d0c934,0x3493798a32a0d873,0x354afbc9350c5a95
.quad 0x34da7db83420975e,0x356bd9dd352f2067,0x350fe3b73495f23f,0x35854b1c35506ab5,0x3531652e34da7db8,0x359374de356ff15b,0x35517f65350eb659,0x35a0496e3586b804
.quad 0x356ff15b352f2067,0x35abab1e35945368,0x35863eb4354e3fd4,0x35b57f9535a0ad5c,0x359374de356bd9dd,0x35bdb01735abab1e,0x359f806a3583db51,0x35c429b035b534da
.quad 0x3581ec7b3590d0c3,0x3541158835638fc3,0x356ad2913585c511,0x3522888b3547b357,0x35506ab53573ff99,0x3502de37352a91ce,0x3534c922355b2291,0x34c49c48350c5a95
.quad 0x3518176e35411588,0x348222f834da7db8,0x34f501963525fca2,0x33fb14c1349ae293,0x34b863843509fd76,0xb220d93a3434968b,0x34755fcc34da7db8,0xb41193e2334907c8
.quad 0x33f10e6e349fd168,0xb48c0d4fb3a0c8f3,0xb1a0d96b34488ec2,0xb4ce5acdb4528804,0xb4028d3d33a0c8f3,0xb5079f03b4a9aa67,0xb47f4f2bb320d559,0xb5272288b4e8fc95
.quad 0xb4bd4866b420975e,0xb54580a2b51369bb,0xb4f9cc4bb48c0d4f,0xb5628401b531652e,0xb51a6c18b4c70ca3,0xb57df9b6b54e3fd4,0xb5370998b5007bea,0xb58bd8c6b569cab3
.quad 0xb5529394b51cbf44,0xb597bf2eb581ec7b,0xb56ce099b538292a,0xb5a29b2eb58e2017,0xb582e487b5529394,0xb5ac59b8b5996c52,0xb58e93bbb56bd9dd,0xb5b4e9aeb5a3bec8
.quad 0xb5996c52b581ec7b,0xb5bc3c09b5ad06a9,0xb5a35df9b58d37c9,0xb5c243efb5b534da,0xb5ac59b8b597bf2e,0xb5c6f6c8b5bc3c09,0xb5b45208b5a1740f,0xb5ca4c56b5c210c7
.quad 0xb5bb3aecb5aa48f4,0xb5cc3ebeb5c6a993,0xb5c109fbb5b2319e,0xb5ccca94b5c9fef3,0xb5c5b679b5b92313,0xb5cbeee4b5cc0b7a,0xb5c9395bb5bf13b1,0xb5c9ad2fb5cccbd0
.quad 0xb5cb8d5ab5c3fb3c,0xb5c6096ab5cc3ebe,0xb5ccaef3b5c7d2e4,0xb5c109fbb5ca6529,0xb5cc9c72b5ca9556,0xb5bab7a7b5c74213,0xb5cb55f5b5cc3ebe,0xb5b31d87b5c2da99
.quad 0x34edcd1c351cbf44,0x3420975e349fd168,0x34a734c134f7673d,0x31a0d96b342a97c7,0x343e939234b37cdc,0xb416956932a0d873,0x3334eec8345c7f3e,0xb4986a98b4028d3d
.quad 0xb3c8ef9033a0c8f3,0xb4e429d0b48c0d4f,0xb4755fccb3713846,0xb516ec8cb4d5a47e,0xb4c22b74b4488ec2,0xb53a66f9b50eb659,0xb5040ee5b4a9aa67,0xb55c3217b531652e
.quad 0xb525fca2b4edcd1c,0xb57bffb5b5529394,0xb5469a3ab518176e,0xb58cc31eb571f9a5,0xb565a5a1b538292a,0xb59a40aeb587a9aa,0xb5816ffcb556df37,0xb5a65953b5953084
.quad 0xb58f0707b573ff99,0xb5b0f10fb5a1740f,0xb59b7c6db587a9aa,0xb5b9ef61b5ac59b8,0xb5a6b6f3b5945368,0xb5c13f79b5b5c9e1,0xb5b09fdab59fe51e,0xb5c6d06bb5bdb017
.quad 0xb5b92313b5aa48f4,0xb5ca9556b5c3fb3c,0xb5c02f5fb5b36b4e,0xb5cc8582b5c89dab,0xb5c5b679b5bb3aec,0xb5cc9c72b5cb8d5a,0xb5c9ad2fb5c1a90f,0xb5cad9f2b5ccc3eb
.quad 0xb5cc0b7ab5c6a993,0xb5c74213b5cc3ebe,0xb5cccc8eb5ca3307,0xb5c1dd26b5c9fef3,0xb5cbeee4b5cc3ebe,0xb5bab7a7b5c6096a,0xb5c9743eb5ccc8da,0xb5b1e21fb5c066b8
.quad 0xb5c5619fb5cbd057,0xb5a770feb5b92313,0xb5bfbf49b5c9570a,0xb59b7c6db5b04e38,0xb5b898a3b5c5619f,0xb58e2017b5a5fb4c,0xb5affc2ab5bff78f,0xb57ef5ccb59a40ae
.quad 0xb5a5fb4cb5b92313,0xb55f5d78b58d37c9,0xb59aaa4db5b0f10f,0xb53dc04fb57df9b6,0xb58e2017b5a770fe,0xb51a6c18b55f5d78,0xb580760fb59cb4cd,0xb4eb6521b53edd2d
.size sf_tab, 63488
k_end:
.section .rodata,"a"
.p2align 6
.amdhsa_kernel recurrent_scan__spectral_gfnet__glu_gated_geglu__prompt_kernel
  .amdhsa_next_free_vgpr 256
  .amdhsa_next_free_sgpr 102
  .amdhsa_accum_offset 256
  .amdhsa_group_segment_fixed_size 0
  .amdhsa_kernarg_size 80
  .amdhsa_user_sgpr_count 2
  .amdhsa_user_sgpr_kernarg_segment_ptr 1
  .amdhsa_system_sgpr_workgroup_id_x 1
.end_amdhsa_kernel
.text
```
